```python
import torch

def _softmax(x, axis=-1):
    return torch.softmax(x, dim=axis)
def _gelu(x):
    return torch.nn.functional.gelu(x, approximate="tanh")
def _silu(x):
    return torch.nn.functional.silu(x)
def _sigmoid(x):
    return torch.sigmoid(x)
def _layernorm(x, axis=-1, eps=1e-5):
    m = x.mean(dim=axis, keepdim=True)
    v = x.var(dim=axis, keepdim=True, unbiased=False)
    return (x - m) / torch.sqrt(v + eps)
def _scatter_add(tgt, idx, src, axis=0):
    return tgt.clone().index_add_(axis, idx, src)
def _segment_sum(src, seg, n):
    out = torch.zeros((n,) + src.shape[1:], dtype=src.dtype)
    return out.index_add_(0, seg, src)
def _pad(x, pw):
    flat = tuple(v for pair in reversed(pw) for v in pair)
    return torch.nn.functional.pad(x, flat)

kernel_name = 'interleave_layers__grouped_kv_mqa__moe_arch_mod__prompt'

def setup_inputs():

    _w = (lambda a: (lambda t: t.to(torch.bfloat16) if t.is_floating_point() else t)(torch.as_tensor(a)))
    def _A_setup():
        B, S, D, H = 1, 2048, 640, 32
        Dh = D // H
        return {
            "x": _w((lambda *s: torch.randn(*s, dtype=torch.bfloat16) * 0.05)(B, S, D)),
            "wq": _w((lambda *s: torch.randn(*s, dtype=torch.bfloat16) * 0.05)(D, H * Dh)),
            "wk": _w((lambda *s: torch.randn(*s, dtype=torch.bfloat16) * 0.05)(D, Dh)),
            "wv": _w((lambda *s: torch.randn(*s, dtype=torch.bfloat16) * 0.05)(D, Dh)),
            "wo": _w((lambda *s: torch.randn(*s, dtype=torch.bfloat16) * 0.05)(H * Dh, D)),
        }
    _A_in = _A_setup()

    def _B_setup():
        B, S, D, F, C = 1, 2048, 640, 1728, 2
        return {
            "x": _w((lambda *s: torch.randn(*s, dtype=torch.bfloat16) * 0.05)(B, S, D)),
            "w_r": _w((lambda *s: torch.randn(*s, dtype=torch.bfloat16) * 0.05)(D)),
            "w_gate": _w((lambda *s: torch.randn(*s, dtype=torch.bfloat16) * 0.05)(D, F)),
            "w_up": _w((lambda *s: torch.randn(*s, dtype=torch.bfloat16) * 0.05)(D, F)),
            "w_down": _w((lambda *s: torch.randn(*s, dtype=torch.bfloat16) * 0.05)(F, D)),
        }
    _B_in = _B_setup()

    return {
        "A_x": _A_in["x"],
        "A_wq": _A_in["wq"],
        "A_wk": _A_in["wk"],
        "A_wv": _A_in["wv"],
        "A_wo": _A_in["wo"],
        "B_x": _B_in["x"],
        "B_w_r": _B_in["w_r"],
        "B_w_gate": _B_in["w_gate"],
        "B_w_up": _B_in["w_up"],
        "B_w_down": _B_in["w_down"],
    }

def reference(A_x, A_wq, A_wk, A_wv, A_wo, B_x, B_w_r, B_w_gate, B_w_up, B_w_down):
    def _A_ref(x, wq, wk, wv, wo):
        B, S, D = x.shape
        H = 32
        Dh = D // H
        q = (lambda x, *d: x.permute(*d))((x @ wq).reshape(B, S, H, Dh), 0, 2, 1, 3)
        k = x @ wk
        v = x @ wv
        scores = torch.einsum("bhqd,bkd->bhqk", q, k) * (Dh ** -0.5)
        p = _softmax(scores, axis=-1)
        o = torch.einsum("bhqk,bkd->bhqd", p, v)
        return (lambda x, *d: x.permute(*d))(o, 0, 2, 1, 3).reshape(B, S, H * Dh) @ wo

    def _B_ref(x, w_r, w_gate, w_up, w_down):
        B, S, D = x.shape
        C = 2
        r = x @ w_r
        idx = torch.argsort(-r, axis=-1)[:, :C]
        idx_e = (lambda x, n, axis: torch.repeat_interleave(x, n, dim=axis))(idx.reshape(B, C, 1), D, axis=2)
        x_sel = (lambda x, i, axis: torch.take_along_dim(x, i, dim=axis))(x, idx_e, axis=1)
        g = _silu(x_sel @ w_gate)
        u = x_sel @ w_up
        y = (g * u) @ w_down
        r_sel = _sigmoid((lambda x, i, axis: torch.take_along_dim(x, i, dim=axis))(r, idx, axis=1))
        y = y * r_sel.reshape(B, C, 1)
        b_off = (torch.arange(B) * S).reshape(B, 1)
        flat_idx = (idx + b_off).reshape(B * C)
        zero = (x * 0.0).reshape(B * S, D)
        upd = _scatter_add(zero, flat_idx, y.reshape(B * C, D), axis=0)
        return x + upd.reshape(B, S, D)

    x = A_x
    x = x + _A_ref(_layernorm(x, axis=-1), A_wq, A_wk, A_wv, A_wo)
    x = x + _B_ref(_layernorm(x, axis=-1), B_w_r, B_w_gate, B_w_up, B_w_down)
    x = x + _A_ref(_layernorm(x, axis=-1), A_wq, A_wk, A_wv, A_wo)
    x = x + _B_ref(_layernorm(x, axis=-1), B_w_r, B_w_gate, B_w_up, B_w_down)
    return x
```

```asm
; @launch grid=(256,1,1) block=(256,1,1) lds=163840
.amdgcn_target "amdgcn-amd-amdhsa--gfx950"
.text
.globl interleave_layers__grouped_kv_mqa__moe_arch_mod__prompt_kernel
.p2align 8
.type interleave_layers__grouped_kv_mqa__moe_arch_mod__prompt_kernel,@function
interleave_layers__grouped_kv_mqa__moe_arch_mod__prompt_kernel:
    s_cmp_ge_u32 s2, 256
    s_cbranch_scc1 L_exit2
    s_load_dwordx16 s[68:83], s[0:1], 0
    s_load_dwordx8 s[84:91], s[0:1], 64
    s_load_dwordx2 s[92:93], s[0:1], 96
    v_and_b32 v1, 63, v0
    v_lshrrev_b32 v5, 6, v0
    v_and_b32 v2, 31, v0
    v_bfe_u32 v3, v0, 5, 1
    v_readfirstlane_b32 s3, v5
    v_lshlrev_b32 v4, 4, v1
    s_and_b32 s52, s2, 7
    s_lshr_b32 s53, s2, 5
    s_lshl_b32 s53, s53, 3
    s_or_b32 s4, s52, s53
    s_bfe_u32 s5, s2, 0x20003
    s_mul_i32 s25, s3, 36864
    s_mov_b32 s7, 0
    s_mov_b32 s24, 0
    v_add_u32 v254, 4096, v4
    v_add_u32 v255, 8192, v4
    s_mov_b32 s58, 52429
    s_lshl_b32 s59, s3, 2
    s_mul_i32 s57, s3, 204800
    s_mul_i32 s56, s5, 320
    s_add_u32 s57, s57, s56
    v_add_u32 v8, 0, v1
    v_mul_lo_u32 v9, v8, s58
    v_lshrrev_b32 v10, 22, v9
    v_lshrrev_b32 v9, 20, v9
    v_mul_u32_u24 v9, 960, v9
    v_lshl_add_u32 v9, v8, 4, v9
    v_subrev_u32 v9, 0, v9
    v_add_u32 v208, s57, v9
    v_or_b32 v10, s59, v10
    v_xor_b32 v9, v8, v10
    v_lshlrev_b32 v9, 4, v9
    v_subrev_u32 v213, 0, v9
    v_add_u32 v8, 64, v1
    v_mul_lo_u32 v9, v8, s58
    v_lshrrev_b32 v10, 22, v9
    v_lshrrev_b32 v9, 20, v9
    v_mul_u32_u24 v9, 960, v9
    v_lshl_add_u32 v9, v8, 4, v9
    v_subrev_u32 v9, 1024, v9
    v_add_u32 v209, s57, v9
    v_or_b32 v10, s59, v10
    v_xor_b32 v9, v8, v10
    v_lshlrev_b32 v9, 4, v9
    v_subrev_u32 v214, 1024, v9
    v_add_u32 v8, 128, v1
    v_mul_lo_u32 v9, v8, s58
    v_lshrrev_b32 v10, 22, v9
    v_lshrrev_b32 v9, 20, v9
    v_mul_u32_u24 v9, 960, v9
    v_lshl_add_u32 v9, v8, 4, v9
    v_subrev_u32 v9, 2048, v9
    v_add_u32 v210, s57, v9
    v_or_b32 v10, s59, v10
    v_xor_b32 v9, v8, v10
    v_lshlrev_b32 v9, 4, v9
    v_subrev_u32 v215, 2048, v9
    v_add_u32 v8, 192, v1
    v_mul_lo_u32 v9, v8, s58
    v_lshrrev_b32 v10, 22, v9
    v_lshrrev_b32 v9, 20, v9
    v_mul_u32_u24 v9, 960, v9
    v_lshl_add_u32 v9, v8, 4, v9
    v_subrev_u32 v9, 3072, v9
    v_add_u32 v211, s57, v9
    v_or_b32 v10, s59, v10
    v_xor_b32 v9, v8, v10
    v_lshlrev_b32 v9, 4, v9
    v_subrev_u32 v216, 3072, v9
    v_add_u32 v8, 256, v1
    v_mul_lo_u32 v9, v8, s58
    v_lshrrev_b32 v10, 22, v9
    v_lshrrev_b32 v9, 20, v9
    v_mul_u32_u24 v9, 960, v9
    v_lshl_add_u32 v9, v8, 4, v9
    v_subrev_u32 v9, 0, v9
    v_add_u32 v212, s57, v9
    v_or_b32 v10, s59, v10
    v_xor_b32 v9, v8, v10
    v_lshlrev_b32 v9, 4, v9
    v_subrev_u32 v217, 0, v9
    s_mul_i32 s52, s4, 40960
    s_mul_i32 s53, s3, 10240
    s_add_u32 s54, s52, s53
    s_add_u32 s55, s54, 5120
    s_mul_i32 s53, s3, 6400
    v_add_u32 v7, s53, v4
    s_mul_i32 s53, s3, 320
    s_add_u32 m0, s25, 23040
    s_waitcnt lgkmcnt(0)
    s_load_dword s6, s[92:93], 0
    s_mov_b32 s12, s68
    s_mov_b32 s13, s69
    s_mov_b32 s14, 2621440
    s_mov_b32 s15, 0x20000
    buffer_load_dwordx4 v213, s[12:15], s54 offen offset:0 lds
    buffer_load_dwordx4 v214, s[12:15], s54 offen offset:1024 lds
    buffer_load_dwordx4 v215, s[12:15], s54 offen offset:2048 lds
    buffer_load_dwordx4 v216, s[12:15], s54 offen offset:3072 lds
    s_add_u32 m0, m0, 4096
    s_nop 0
    buffer_load_dwordx4 v217, s[12:15], s54 offen lds
    s_add_u32 m0, m0, 1024
    s_nop 0
    buffer_load_dwordx4 v213, s[12:15], s55 offen offset:0 lds
    buffer_load_dwordx4 v214, s[12:15], s55 offen offset:1024 lds
    buffer_load_dwordx4 v215, s[12:15], s55 offen offset:2048 lds
    buffer_load_dwordx4 v216, s[12:15], s55 offen offset:3072 lds
    s_add_u32 m0, m0, 4096
    s_nop 0
    buffer_load_dwordx4 v217, s[12:15], s55 offen lds
    s_mov_b32 m0, s25
    s_mov_b32 s16, s70
    s_mov_b32 s17, s71
    s_mov_b32 s18, 819200
    s_mov_b32 s19, 0x20000
    s_lshr_b32 s57, s2, 3
    s_lshl_b32 s57, s57, 2
    s_add_u32 s57, s57, s3
    s_mul_i32 s57, s57, 6400
    buffer_load_dwordx4 a[240:243], v4, s[16:19], s57 offen offset:0
    buffer_load_dwordx4 a[244:247], v4, s[16:19], s57 offen offset:1024
    buffer_load_dwordx4 a[248:251], v4, s[16:19], s57 offen offset:2048
    buffer_load_dwordx4 a[252:255], v4, s[16:19], s57 offen offset:3072
    buffer_load_dwordx4 a[240:243], v254, s[16:19], s57 offen offset:0
    buffer_load_dwordx4 a[244:247], v254, s[16:19], s57 offen offset:1024
    buffer_load_dwordx4 a[248:251], v254, s[16:19], s57 offen offset:2048
    s_lshr_b32 s56, s2, 3
    s_cmp_lt_u32 s56, 16
    s_cselect_b32 s20, s72, s74
    s_cselect_b32 s21, s73, s75
    s_mov_b32 s22, 25600
    s_mov_b32 s23, 0x20000
    s_and_b32 s56, s56, 15
    s_lshl_b32 s56, s56, 2
    s_add_u32 s56, s56, s3
    s_mul_i32 s56, s56, 400
    s_mov_b64 exec, 0x1ffffff
    buffer_load_dwordx4 a[252:255], v4, s[20:23], s56 offen
    s_mov_b64 exec, -1
    s_mov_b32 s8, s92
    s_mov_b32 s9, s93
    s_mov_b32 s10, 268435456
    s_mov_b32 s11, 0x20000
    s_mov_b32 s64, 262144
    s_mov_b32 s65, 2686976
    s_mov_b32 s66, 4096
    v_mul_u32_u24 v15, 336, v3
    v_lshl_add_u32 v15, v2, 4, v15
    v_mov_b32 v5, 1073741824
    v_cmp_lt_u32 vcc, 20, v2
    s_mul_i32 s52, s3, 24576
    v_add_u32 v14, s52, v4
    v_cndmask_b32 v15, v15, v5, vcc
    v_bfe_u32 v5, v1, 3, 2
    v_and_b32 v6, 7, v1
    v_lshlrev_b32 v7, 11, v5
    v_lshl_add_u32 v7, v3, 9, v7
    v_lshl_add_u32 v7, v6, 4, v7
    v_add_u32 v126, 147456, v7
    v_lshlrev_b32 v7, 9, v5
    v_lshl_add_u32 v7, v3, 8, v7
    v_lshl_add_u32 v7, v6, 3, v7
    v_add_u32 v127, 155648, v7
    v_bfe_u32 v5, v1, 2, 2
    v_lshl_add_u32 v5, v3, 3, v5
    v_bfe_u32 v7, v1, 4, 1
    v_and_b32 v8, 3, v1
    v_lshl_add_u32 v6, v7, 2, v8
    v_mul_u32_u24 v9, 320, v5
    v_add_u32 v9, s25, v9
    v_add_u32 v9, 12800, v9
    v_add_u32 v10, v6, v7
    v_lshl_add_u32 v226, v10, 3, v9
    v_lshrrev_b32 v10, 1, v6
    v_mul_u32_u24 v10, 80, v10
    v_and_b32 v8, 1, v6
    v_mad_u32_u24 v10, v8, 40, v10
    v_add3_u32 v227, v10, v9, 32
    v_mul_u32_u24 v9, 40, v5
    v_min_u32 v10, 4, v6
    v_lshlrev_b32 v10, 3, v10
    v_mov_b32 v8, 6400
    v_cmp_lt_u32 vcc, 5, v6
    v_add_u32 v9, s25, v9
    v_mul_u32_u24 v7, 40, v1
    v_cndmask_b32 v10, v10, v8, vcc
    v_add_u32 v228, v9, v10
    s_add_u32 s52, s25, 6400
    v_add_u32 v7, s52, v7
    s_add_u32 s52, s25, 34304
    v_lshl_add_u32 v229, v2, 2, s52
    s_getreg_b32 s53, hwreg(HW_REG_XCC_ID, 0, 4)
    s_lshl_b32 s54, s4, 2
    s_add_u32 s54, s54, s5
    s_lshl_b32 s54, s54, 6
    s_add_u32 s54, s54, 69632
    v_mov_b32 v8, 0x3f80
    v_mov_b32 v101, 0
    v_mov_b32 v103, 0
    v_mov_b32 v105, 0
    s_mul_i32 s55, s3, 20
    v_lshrrev_b32 v5, 3, v2
    v_mul_u32_u24 v6, 36864, v5
    v_and_b32 v9, 7, v2
    v_mul_u32_u24 v9, 1280, v9
    v_add3_u32 v6, v6, v9, s55
    v_and_b32 v9, 3, v2
    v_lshl_or_b32 v5, v5, 2, v9
    v_subrev_u32 v6, s55, v6
    v_add_u32 v6, 23040, v6
    v_add_u32 v9, s55, v3
    v_add_u32 v10, 0, v9
    v_xor_b32 v10, v10, v5
    v_lshl_add_u32 v56, v10, 4, v6
    v_add_u32 v10, 2, v9
    v_xor_b32 v10, v10, v5
    v_lshl_add_u32 v57, v10, 4, v6
    v_add_u32 v10, 4, v9
    v_xor_b32 v10, v10, v5
    v_lshl_add_u32 v58, v10, 4, v6
    v_add_u32 v10, 6, v9
    v_xor_b32 v10, v10, v5
    v_lshl_add_u32 v59, v10, 4, v6
    v_add_u32 v10, 8, v9
    v_xor_b32 v10, v10, v5
    v_lshl_add_u32 v60, v10, 4, v6
    v_add_u32 v10, 10, v9
    v_xor_b32 v10, v10, v5
    v_lshl_add_u32 v61, v10, 4, v6
    v_add_u32 v10, 12, v9
    v_xor_b32 v10, v10, v5
    v_lshl_add_u32 v62, v10, 4, v6
    v_add_u32 v10, 14, v9
    v_xor_b32 v10, v10, v5
    v_lshl_add_u32 v63, v10, 4, v6
    v_add_u32 v10, 16, v9
    v_xor_b32 v10, v10, v5
    v_lshl_add_u32 v64, v10, 4, v6
    v_add_u32 v10, 18, v9
    v_xor_b32 v10, v10, v5
    v_lshl_add_u32 v65, v10, 4, v6
    s_waitcnt lgkmcnt(0)
    s_add_u32 s6, s6, 1
    s_lshl_b32 s52, s6, 4
    s_or_b32 s39, s52, s53
    v_mov_b32 v5, s39
    v_mov_b32 v6, 0
    s_mov_b64 exec, 1
    buffer_store_dword v5, v6, s[8:11], s54 offen sc1
    s_mov_b64 exec, -1
    v_mov_b32 v66, v7
    v_mov_b32 v67, v8
    s_lshl_b32 s34, s2, 2
    s_add_u32 s34, s34, s3
    s_min_u32 s52, s34, 799
    s_mul_i32 s53, s52, 52429
    s_lshr_b32 s53, s53, 21
    s_mul_i32 s54, s53, 40
    s_sub_u32 s36, s52, s54
    s_mul_i32 s54, s53, 52429
    s_lshr_b32 s54, s54, 18
    s_mul_i32 s55, s54, 5
    s_sub_u32 s35, s53, s55
    s_lshl_b32 s60, s36, 1
    s_add_u32 s60, s60, 0
    s_mul_i32 s61, s60, 52429
    s_lshr_b32 s61, s61, 18
    s_mul_i32 s62, s61, 5
    s_sub_u32 s60, s60, s62
    s_lshl_b32 s62, s60, 3
    s_mov_b32 s32, 0x18140400
    s_mov_b32 s33, 0x10
    s_lshr_b64 s[32:33], s[32:33], s62
    s_and_b32 s32, s32, 0xff
    s_mul_i32 s61, s61, 40
    s_add_u32 s56, s61, s32
    s_cmp_eq_u32 s60, 4
    s_cselect_b32 s57, 20, 8
    s_lshl_b32 s60, s36, 1
    s_add_u32 s60, s60, 1
    s_mul_i32 s61, s60, 52429
    s_lshr_b32 s61, s61, 18
    s_mul_i32 s62, s61, 5
    s_sub_u32 s60, s60, s62
    s_lshl_b32 s62, s60, 3
    s_mov_b32 s32, 0x18140400
    s_mov_b32 s33, 0x10
    s_lshr_b64 s[32:33], s[32:33], s62
    s_and_b32 s32, s32, 0xff
    s_mul_i32 s61, s61, 40
    s_add_u32 s58, s61, s32
    s_cmp_eq_u32 s60, 4
    s_cselect_b32 s59, 20, 8
    v_cmp_eq_u32 vcc, 1, v3
    v_mov_b32 v8, s56
    v_mov_b32 v9, s58
    v_cndmask_b32 v8, v8, v9, vcc
    v_mov_b32 v9, s57
    v_mov_b32 v10, s59
    v_cndmask_b32 v9, v9, v10, vcc
    v_bfe_u32 v10, v1, 4, 1
    v_mad_u32_u24 v8, v9, v10, v8
    v_bfe_u32 v10, v1, 2, 2
    v_add_u32 v8, v8, v10
    v_mul_u32_u24 v8, 1280, v8
    s_cmp_eq_u32 s35, 4
    s_cselect_b32 s56, 80, 16
    s_mul_i32 s57, s35, 80
    s_cselect_b32 s57, 64, s57
    s_mul_i32 s58, s54, 320
    s_add_u32 s57, s57, s58
    v_and_b32 v10, 3, v1
    v_mad_u32_u24 v8, v10, s56, v8
    v_add_u32 v230, s57, v8
    v_subrev_u32 v5, s25, v226
    s_mul_i32 s52, s3, 80
    v_add_u32 v5, s52, v5
    s_add_u32 s52, s3, 0
    s_and_b32 s52, s52, 3
    s_mul_i32 s52, s52, 36864
    v_add_u32 v218, s52, v5
    v_add_u32 v222, s52, v4
    s_add_u32 s52, s3, 1
    s_and_b32 s52, s52, 3
    s_mul_i32 s52, s52, 36864
    v_add_u32 v219, s52, v5
    v_add_u32 v223, s52, v4
    s_add_u32 s52, s3, 2
    s_and_b32 s52, s52, 3
    s_mul_i32 s52, s52, 36864
    v_add_u32 v220, s52, v5
    v_add_u32 v224, s52, v4
    s_add_u32 s52, s3, 3
    s_and_b32 s52, s52, 3
    s_mul_i32 s52, s52, 36864
    v_add_u32 v221, s52, v5
    v_add_u32 v225, s52, v4
    s_mul_i32 s53, s3, 6400
    v_add_u32 v7, s53, v4
    s_mov_b32 m0, s25
    s_cmp_ge_u32 s5, 2
    s_cbranch_scc1 L6a_1
    s_cmp_eq_u32 s5, 0
    s_cselect_b32 s20, s72, s74
    s_cselect_b32 s21, s73, s75
    s_mov_b32 s22, 25600
    s_mov_b32 s23, 0x20000
    s_mov_b32 s56, 4096
    buffer_load_dwordx4 v7, s[20:23], 0 offen offset:0 lds
    buffer_load_dwordx4 v7, s[20:23], 0 offen offset:1024 lds
    buffer_load_dwordx4 v7, s[20:23], 0 offen offset:2048 lds
    buffer_load_dwordx4 v7, s[20:23], 0 offen offset:3072 lds
    s_add_u32 m0, m0, 4096
    s_nop 0
    buffer_load_dwordx4 v7, s[20:23], s56 offen offset:0 lds
    buffer_load_dwordx4 v7, s[20:23], s56 offen offset:1024 lds
    s_mov_b64 exec, 0xffff
    buffer_load_dwordx4 v7, s[20:23], s56 offen offset:2048 lds
    s_mov_b64 exec, -1
L6a_1:
    s_mov_b32 s20, s80
    s_mov_b32 s21, s81
    s_mov_b32 s22, 1280
    s_mov_b32 s23, 0x20000
    v_lshlrev_b32 v7, 1, v1
    s_mul_i32 s53, s3, 320
    buffer_load_ushort v100, v7, s[20:23], s53 offen offset:0
    buffer_load_ushort v102, v7, s[20:23], s53 offen offset:128
    buffer_load_ushort v104, v7, s[20:23], s53 offen offset:256
    s_waitcnt vmcnt(12)
    s_barrier
    ds_read_b128 v[16:19], v56
    ds_read_b128 v[20:23], v57
    ds_read_b128 v[24:27], v58
    ds_read_b128 v[28:31], v59
    ds_read_b128 v[32:35], v60
    ds_read_b128 v[36:39], v61
    ds_read_b128 v[40:43], v62
    ds_read_b128 v[44:47], v63
    ds_read_b128 v[48:51], v64
    ds_read_b128 v[52:55], v65
    s_add_u32 m0, s25, 12800
    s_mov_b32 s59, 0
    buffer_load_dwordx4 v208, s[16:19], s59 offen offset:0 lds
    buffer_load_dwordx4 v209, s[16:19], s59 offen offset:1024 lds
    buffer_load_dwordx4 v210, s[16:19], s59 offen offset:2048 lds
    buffer_load_dwordx4 v211, s[16:19], s59 offen offset:3072 lds
    s_add_u32 m0, m0, 4096
    s_nop 0
    buffer_load_dwordx4 v212, s[16:19], s59 offen lds
    s_waitcnt vmcnt(5)
    v_lshl_or_b32 v100, v100, 16, v67
    v_lshl_or_b32 v102, v102, 16, v67
    v_lshl_or_b32 v104, v104, 16, v67
    ds_write_b64 v66, v[100:101]
    ds_write_b64 v66, v[102:103] offset:2560
    s_mov_b64 exec, 0xffffffff
    ds_write_b64 v66, v[104:105] offset:5120
    s_mov_b64 exec, -1
    s_waitcnt lgkmcnt(0)
    ds_read_b64_tr_b16 v[128:129], v228 offset:0
    ds_read_b64_tr_b16 v[130:131], v228 offset:160
    ds_read_b64_tr_b16 v[132:133], v228 offset:640
    ds_read_b64_tr_b16 v[134:135], v228 offset:800
    ds_read_b64_tr_b16 v[136:137], v228 offset:1280
    ds_read_b64_tr_b16 v[138:139], v228 offset:1440
    ds_read_b64_tr_b16 v[140:141], v228 offset:1920
    ds_read_b64_tr_b16 v[142:143], v228 offset:2080
    ds_read_b64_tr_b16 v[144:145], v228 offset:2560
    ds_read_b64_tr_b16 v[146:147], v228 offset:2720
    ds_read_b64_tr_b16 v[148:149], v228 offset:3200
    ds_read_b64_tr_b16 v[150:151], v228 offset:3360
    ds_read_b64_tr_b16 v[152:153], v228 offset:3840
    ds_read_b64_tr_b16 v[154:155], v228 offset:4000
    ds_read_b64_tr_b16 v[156:157], v228 offset:4480
    ds_read_b64_tr_b16 v[158:159], v228 offset:4640
    ds_read_b64_tr_b16 v[160:161], v228 offset:5120
    ds_read_b64_tr_b16 v[162:163], v228 offset:5280
    ds_read_b64_tr_b16 v[164:165], v228 offset:5760
    ds_read_b64_tr_b16 v[166:167], v228 offset:5920
    s_mov_b32 s52, 0x3f803f80
    v_mov_b32 v5, 0
    v_mov_b32 v6, 0
    s_waitcnt lgkmcnt(0)
    v_dot2_f32_bf16 v5, v128, s52, v5
    v_dot2_f32_bf16 v6, v129, s52, v6
    v_dot2_f32_bf16 v5, v130, s52, v5
    v_dot2_f32_bf16 v6, v131, s52, v6
    v_dot2_f32_bf16 v5, v132, s52, v5
    v_dot2_f32_bf16 v6, v133, s52, v6
    v_dot2_f32_bf16 v5, v134, s52, v5
    v_dot2_f32_bf16 v6, v135, s52, v6
    v_dot2_f32_bf16 v5, v136, s52, v5
    v_dot2_f32_bf16 v6, v137, s52, v6
    v_dot2_f32_bf16 v5, v138, s52, v5
    v_dot2_f32_bf16 v6, v139, s52, v6
    v_dot2_f32_bf16 v5, v140, s52, v5
    v_dot2_f32_bf16 v6, v141, s52, v6
    v_dot2_f32_bf16 v5, v142, s52, v5
    v_dot2_f32_bf16 v6, v143, s52, v6
    v_dot2_f32_bf16 v5, v144, s52, v5
    v_dot2_f32_bf16 v6, v145, s52, v6
    v_dot2_f32_bf16 v5, v146, s52, v5
    v_dot2_f32_bf16 v6, v147, s52, v6
    v_dot2_f32_bf16 v5, v148, s52, v5
    v_dot2_f32_bf16 v6, v149, s52, v6
    v_dot2_f32_bf16 v5, v150, s52, v5
    v_dot2_f32_bf16 v6, v151, s52, v6
    v_dot2_f32_bf16 v5, v152, s52, v5
    v_dot2_f32_bf16 v6, v153, s52, v6
    v_dot2_f32_bf16 v5, v154, s52, v5
    v_dot2_f32_bf16 v6, v155, s52, v6
    v_dot2_f32_bf16 v5, v156, s52, v5
    v_dot2_f32_bf16 v6, v157, s52, v6
    v_dot2_f32_bf16 v5, v158, s52, v5
    v_dot2_f32_bf16 v6, v159, s52, v6
    v_dot2_f32_bf16 v5, v160, s52, v5
    v_dot2_f32_bf16 v6, v161, s52, v6
    v_dot2_f32_bf16 v5, v162, s52, v5
    v_dot2_f32_bf16 v6, v163, s52, v6
    v_dot2_f32_bf16 v5, v164, s52, v5
    v_dot2_f32_bf16 v6, v165, s52, v6
    v_dot2_f32_bf16 v5, v166, s52, v5
    v_dot2_f32_bf16 v6, v167, s52, v6
    s_add_u32 m0, s25, 17920
    s_mov_b32 s59, 20480
    buffer_load_dwordx4 v208, s[16:19], s59 offen offset:0 lds
    buffer_load_dwordx4 v209, s[16:19], s59 offen offset:1024 lds
    buffer_load_dwordx4 v210, s[16:19], s59 offen offset:2048 lds
    buffer_load_dwordx4 v211, s[16:19], s59 offen offset:3072 lds
    s_add_u32 m0, m0, 4096
    s_nop 0
    buffer_load_dwordx4 v212, s[16:19], s59 offen lds
    s_nop 2
    v_add_f32 v5, v5, v6
    v_mov_b32 v6, v5
    s_nop 1
    v_permlane32_swap_b32 v5, v6
    s_nop 0
    v_add_f32 v5, v5, v6
    ds_write_b32 v229, v5
    v_mov_b32 v6, 0
    v_mov_b32 v7, 0
    v_mfma_f32_32x32x16_bf16 v[64:79], v[128:131], v[16:19], 0
    v_dot2_f32_bf16 v6, v16, v16, v6
    v_dot2_f32_bf16 v7, v17, v17, v7
    v_dot2_f32_bf16 v6, v18, v18, v6
    v_dot2_f32_bf16 v7, v19, v19, v7
    v_mfma_f32_32x32x16_bf16 v[64:79], v[132:135], v[20:23], v[64:79]
    v_dot2_f32_bf16 v6, v20, v20, v6
    v_dot2_f32_bf16 v7, v21, v21, v7
    v_dot2_f32_bf16 v6, v22, v22, v6
    v_dot2_f32_bf16 v7, v23, v23, v7
    v_mfma_f32_32x32x16_bf16 v[64:79], v[136:139], v[24:27], v[64:79]
    v_dot2_f32_bf16 v6, v24, v24, v6
    v_dot2_f32_bf16 v7, v25, v25, v7
    v_dot2_f32_bf16 v6, v26, v26, v6
    v_dot2_f32_bf16 v7, v27, v27, v7
    v_mfma_f32_32x32x16_bf16 v[64:79], v[140:143], v[28:31], v[64:79]
    v_dot2_f32_bf16 v6, v28, v28, v6
    v_dot2_f32_bf16 v7, v29, v29, v7
    v_dot2_f32_bf16 v6, v30, v30, v6
    v_dot2_f32_bf16 v7, v31, v31, v7
    v_mfma_f32_32x32x16_bf16 v[64:79], v[144:147], v[32:35], v[64:79]
    v_dot2_f32_bf16 v6, v32, v32, v6
    v_dot2_f32_bf16 v7, v33, v33, v7
    v_dot2_f32_bf16 v6, v34, v34, v6
    v_dot2_f32_bf16 v7, v35, v35, v7
    v_mfma_f32_32x32x16_bf16 v[64:79], v[148:151], v[36:39], v[64:79]
    v_dot2_f32_bf16 v6, v36, v36, v6
    v_dot2_f32_bf16 v7, v37, v37, v7
    v_dot2_f32_bf16 v6, v38, v38, v6
    v_dot2_f32_bf16 v7, v39, v39, v7
    v_mfma_f32_32x32x16_bf16 v[64:79], v[152:155], v[40:43], v[64:79]
    v_dot2_f32_bf16 v6, v40, v40, v6
    v_dot2_f32_bf16 v7, v41, v41, v7
    v_dot2_f32_bf16 v6, v42, v42, v6
    v_dot2_f32_bf16 v7, v43, v43, v7
    v_mfma_f32_32x32x16_bf16 v[64:79], v[156:159], v[44:47], v[64:79]
    v_dot2_f32_bf16 v6, v44, v44, v6
    v_dot2_f32_bf16 v7, v45, v45, v7
    v_dot2_f32_bf16 v6, v46, v46, v6
    v_dot2_f32_bf16 v7, v47, v47, v7
    v_mfma_f32_32x32x16_bf16 v[64:79], v[160:163], v[48:51], v[64:79]
    v_dot2_f32_bf16 v6, v48, v48, v6
    v_dot2_f32_bf16 v7, v49, v49, v7
    v_dot2_f32_bf16 v6, v50, v50, v6
    v_dot2_f32_bf16 v7, v51, v51, v7
    v_mfma_f32_32x32x16_bf16 v[64:79], v[164:167], v[52:55], v[64:79]
    v_dot2_f32_bf16 v6, v52, v52, v6
    v_dot2_f32_bf16 v7, v53, v53, v7
    v_dot2_f32_bf16 v6, v54, v54, v6
    v_dot2_f32_bf16 v7, v55, v55, v7
    s_lshl_b32 s52, s3, 4
    s_add_u32 s52, s52, 159744
    v_lshlrev_b32 v8, 6, v2
    v_add_f32 v7, v6, v7
    v_add_u32 v9, s52, v8
    v_add_u32 v8, 159744, v8
    v_mov_b32 v6, v7
    s_mul_i32 s52, s3, 3072
    s_add_u32 s52, s52, 147456
    v_permlane32_swap_b32 v6, v7
    v_add_u32 v10, s52, v4
    s_min_u32 s52, s3, 2
    s_lshl_b32 s53, s52, 10
    s_add_u32 s53, s53, 147456
    v_add_f32 v78, v6, v7
    ds_write_b128 v10, v[64:67] offset:0
    ds_write_b128 v10, v[68:71] offset:1024
    ds_write_b128 v10, v[72:75] offset:2048
    s_mov_b64 exec, 0xffffffff
    ds_write_b128 v9, v[76:79]
    s_mov_b64 exec, -1
    v_add_u32 v9, s53, v4
    s_waitcnt lgkmcnt(0)
    s_barrier
    ds_read_b128 v[80:83], v8 offset:0
    ds_read_b128 v[84:87], v8 offset:16
    ds_read_b128 v[88:91], v8 offset:32
    ds_read_b128 v[92:95], v8 offset:48
    ds_read_b128 v[64:67], v9 offset:0
    ds_read_b128 v[68:71], v9 offset:3072
    ds_read_b128 v[72:75], v9 offset:6144
    ds_read_b128 v[76:79], v9 offset:9216
    s_add_u32 m0, s25, 23040
    s_mov_b32 s59, 40960
    buffer_load_dwordx4 v208, s[16:19], s59 offen offset:0 lds
    buffer_load_dwordx4 v209, s[16:19], s59 offen offset:1024 lds
    buffer_load_dwordx4 v210, s[16:19], s59 offen offset:2048 lds
    buffer_load_dwordx4 v211, s[16:19], s59 offen offset:3072 lds
    s_add_u32 m0, m0, 4096
    s_nop 0
    buffer_load_dwordx4 v212, s[16:19], s59 offen lds
    s_min_u32 s52, s3, 2
    s_lshl_b32 s52, s52, 5
    s_add_u32 s52, s52, 34304
    v_lshl_add_u32 v5, v3, 4, s52
    v_add_u32 v6, 73728, v5
    v_mov_b32 v7, 34404
    v_mov_b32 v10, 108132
    ds_read_b128 v[100:103], v5 offset:0
    ds_read_b128 v[104:107], v5 offset:36864
    ds_read_b128 v[108:111], v6 offset:0
    ds_read_b128 v[112:115], v6 offset:36864
    ds_read_b32 v56, v7 offset:0
    ds_read_b32 v57, v7 offset:36864
    ds_read_b32 v58, v10 offset:0
    ds_read_b32 v59, v10 offset:36864
    s_waitcnt lgkmcnt(12)
    v_pk_add_f32 v[80:81], v[80:81], v[84:85]
    v_pk_add_f32 v[82:83], v[82:83], v[86:87]
    v_pk_add_f32 v[88:89], v[88:89], v[92:93]
    v_pk_add_f32 v[90:91], v[90:91], v[94:95]
    v_pk_add_f32 v[80:81], v[80:81], v[88:89]
    v_pk_add_f32 v[82:83], v[82:83], v[90:91]
    v_mul_f32 v12, 986500301, v80
    v_mul_f32 v5, 986500301, v82
    v_fma_f32 v5, -v12, v12, v5
    v_max_f32 v5, 0, v5
    v_add_f32 v6, 925353388, v5
    v_rsq_f32 v13, v6
    s_waitcnt lgkmcnt(0)
    v_pk_add_f32 v[100:101], v[100:101], v[104:105]
    v_pk_add_f32 v[102:103], v[102:103], v[106:107]
    v_pk_add_f32 v[108:109], v[108:109], v[112:113]
    v_pk_add_f32 v[110:111], v[110:111], v[114:115]
    v_pk_add_f32 v[244:245], v[100:101], v[108:109]
    v_pk_add_f32 v[246:247], v[102:103], v[110:111]
    v_pk_add_f32 v[64:65], v[64:65], v[68:69]
    v_pk_add_f32 v[66:67], v[66:67], v[70:71]
    v_pk_add_f32 v[72:73], v[72:73], v[76:77]
    v_pk_add_f32 v[74:75], v[74:75], v[78:79]
    v_pk_add_f32 v[112:113], v[64:65], v[72:73]
    v_pk_add_f32 v[114:115], v[66:67], v[74:75]
    v_add_f32 v56, v56, v57
    v_add_f32 v58, v58, v59
    v_add_f32 v248, v56, v58
    v_mov_b32 v11, v13
    v_fma_f32 v112, -v12, v244, v112
    v_fma_f32 v113, -v12, v245, v113
    v_fma_f32 v114, -v12, v246, v114
    v_fma_f32 v115, -v12, v247, v115
    v_mul_f32 v56, v112, v11
    v_mul_f32 v57, v113, v11
    v_mul_f32 v58, v114, v11
    v_mul_f32 v59, v115, v11
    s_cmp_ge_u32 s5, 2
    s_cbranch_scc1 Lk_2
    s_cmp_eq_u32 s3, 3
    s_cbranch_scc1 Lk_2
    s_lshl_b32 s52, s3, 9
    s_add_u32 s52, s52, 161792
    s_cmp_eq_u32 s5, 1
    s_cbranch_scc1 Lkv_3
    v_cvt_pk_bf16_f32 v60, v56, v57
    v_cvt_pk_bf16_f32 v61, v58, v59
    v_lshl_add_u32 v5, v1, 3, s52
    ds_write_b64 v5, v[60:61]
    s_branch Lk_2
Lkv_3:
    s_cmp_lg_u32 s3, 2
    s_cbranch_scc1 Lk_4
    v_cmp_eq_u32 vcc, 1, v3
    s_nop 1
    v_cndmask_b32 v56, v56, 1.0, vcc
Lk_4:
    v_cvt_pk_bf16_f32 v60, v56, v57
    v_cvt_pk_bf16_f32 v61, v58, v59
    v_and_b32 v5, 0x13, v2
    v_bfe_u32 v6, v2, 2, 1
    v_lshl_add_u32 v5, v6, 3, v5
    v_bfe_u32 v6, v2, 3, 1
    v_lshl_add_u32 v5, v6, 2, v5
    v_lshlrev_b32 v5, 1, v5
    v_lshl_add_u32 v5, v3, 8, v5
    v_add_u32 v5, s52, v5
    ds_write_b16 v5, v60
    ds_write_b16_d16_hi v5, v60 offset:64
    ds_write_b16 v5, v61 offset:128
    ds_write_b16_d16_hi v5, v61 offset:192
Lk_2:
    s_waitcnt vmcnt(10)
    s_waitcnt lgkmcnt(0)
    s_barrier
    s_cmp_ge_u32 s5, 2
    s_cbranch_scc1 Lk_5
    s_cmp_lg_u32 s3, 0
    s_cbranch_scc1 Lk_5
    s_cmp_eq_u32 s5, 1
    s_cbranch_scc1 Lk_6
    v_lshlrev_b32 v5, 3, v1
    v_add_u32 v5, 161792, v5
    ds_read_b64 v[56:57], v5
    ds_read_b64 v[58:59], v5 offset:512
    ds_read_b64 v[60:61], v5 offset:1024
    s_lshl_b32 s52, s4, 10
    s_add_u32 s52, s52, s64
    s_lshr_b32 s53, s4, 1
    s_lshl_b32 s53, s53, 10
    s_and_b32 s54, s4, 1
    s_lshl_b32 s54, s54, 3
    s_add_u32 s53, s53, s54
    s_add_u32 s53, s53, s64
    s_add_u32 s53, s53, 65536
    s_waitcnt lgkmcnt(0)
    buffer_store_dwordx4 v[56:59], v4, s[8:11], s52 offen sc1
    buffer_store_dwordx2 v[60:61], v4, s[8:11], s53 offen sc1
    s_branch Lk_5
Lk_6:
    v_min_u32 v5, 23, v2
    v_lshlrev_b32 v5, 6, v5
    v_lshl_add_u32 v5, v3, 4, v5
    v_add_u32 v5, 161792, v5
    ds_read_b128 v[56:59], v5
    ds_read_b128 v[60:63], v5 offset:32
    s_mul_i32 s52, s4, 1344
    s_add_u32 s52, s52, s64
    s_add_u32 s52, s52, 98304
    s_waitcnt lgkmcnt(0)
    buffer_store_dwordx4 v[56:59], v15, s[8:11], s52 offen sc1
    buffer_store_dwordx4 v[60:63], v15, s[8:11], s52 offen offset:672 sc1
Lk_5:
    ds_read_b64_tr_b16 a[0:1], v218 offset:0
    ds_read_b64_tr_b16 a[2:3], v218 offset:1280
    ds_read_b64_tr_b16 a[40:41], v219 offset:0
    ds_read_b64_tr_b16 a[42:43], v219 offset:1280
    ds_read_b64_tr_b16 a[80:81], v220 offset:0
    ds_read_b64_tr_b16 a[82:83], v220 offset:1280
    ds_read_b64_tr_b16 a[120:121], v221 offset:0
    ds_read_b64_tr_b16 a[122:123], v221 offset:1280
    ds_read_b64_tr_b16 v[168:169], v227 offset:0
    ds_read_b64_tr_b16 v[170:171], v227 offset:1280
    s_add_u32 m0, s25, 28160
    s_mov_b32 s59, 61440
    buffer_load_dwordx4 v208, s[16:19], s59 offen offset:0 lds
    buffer_load_dwordx4 v209, s[16:19], s59 offen offset:1024 lds
    buffer_load_dwordx4 v210, s[16:19], s59 offen offset:2048 lds
    buffer_load_dwordx4 v211, s[16:19], s59 offen offset:3072 lds
    s_add_u32 m0, m0, 4096
    s_nop 0
    buffer_load_dwordx4 v212, s[16:19], s59 offen lds
    s_mov_b32 s20, s76
    s_mov_b32 s21, s77
    s_mov_b32 s22, 819200
    s_mov_b32 s23, 0x20000
    s_add_u32 m0, s25, 33280
    s_nop 0
    buffer_load_dwordx4 v230, s[20:23], 0 offen lds
    v_mov_b32 v92, 0x3f803f80
    v_mov_b32 v93, 0x3f803f80
    v_mov_b32 v94, 0x3f803f80
    v_mov_b32 v95, 0x3f803f80
    ds_write_b128 v222, v[16:19] offset:0
    ds_write_b128 v222, v[20:23] offset:1024
    ds_write_b128 v222, v[24:27] offset:2048
    ds_write_b128 v222, v[28:31] offset:3072
    ds_write_b128 v222, v[32:35] offset:4096
    ds_write_b128 v222, v[36:39] offset:5120
    ds_write_b128 v222, v[40:43] offset:6144
    ds_write_b128 v222, v[44:47] offset:7168
    ds_write_b128 v222, v[48:51] offset:8192
    ds_write_b128 v222, v[52:55] offset:9216
    s_waitcnt vmcnt(11)
    s_waitcnt lgkmcnt(0)
    s_barrier
    ds_read_b64_tr_b16 a[4:5], v218 offset:5120
    ds_read_b64_tr_b16 a[6:7], v218 offset:6400
    ds_read_b64_tr_b16 a[44:45], v219 offset:5120
    ds_read_b64_tr_b16 a[46:47], v219 offset:6400
    s_add_u32 m0, s25, 12800
    s_mov_b32 s59, 81920
    buffer_load_dwordx4 v208, s[16:19], s59 offen offset:0 lds
    ds_read_b64_tr_b16 a[84:85], v220 offset:5120
    ds_read_b64_tr_b16 a[86:87], v220 offset:6400
    ds_read_b64_tr_b16 a[124:125], v221 offset:5120
    ds_read_b64_tr_b16 a[126:127], v221 offset:6400
    buffer_load_dwordx4 v209, s[16:19], s59 offen offset:1024 lds
    ds_read_b64_tr_b16 v[172:173], v227 offset:5120
    ds_read_b64_tr_b16 v[174:175], v227 offset:6400
    ds_read_b128 v[56:59], v223 offset:0
    ds_read_b128 v[60:63], v224 offset:0
    buffer_load_dwordx4 v210, s[16:19], s59 offen offset:2048 lds
    ds_read_b128 v[64:67], v225 offset:0
    ds_read_b128 v[68:71], v223 offset:1024
    ds_read_b128 v[72:75], v224 offset:1024
    ds_read_b128 v[76:79], v225 offset:1024
    buffer_load_dwordx4 v211, s[16:19], s59 offen offset:3072 lds
    s_add_u32 m0, m0, 4096
    s_nop 0
    buffer_load_dwordx4 v212, s[16:19], s59 offen lds
    s_cmp_lg_u32 s3, 0
    s_cbranch_scc1 Lkf_7
    s_lshl_b32 s52, s2, 6
    s_add_u32 s52, s52, s66
    s_waitcnt vmcnt(11)
    v_mov_b32 v5, s6
    v_mov_b32 v6, 0
    s_mov_b64 exec, 1
    buffer_store_dword v5, v6, s[8:11], s52 offen sc1
    s_mov_b64 exec, -1
Lkf_7:
    s_waitcnt vmcnt(11)
    s_waitcnt lgkmcnt(0)
    s_barrier
    v_mfma_f32_32x32x16_bf16 a[240:255], v[168:171], v[16:19], 0
    ds_read_b64_tr_b16 a[8:9], v218 offset:10240
    ds_read_b64_tr_b16 a[10:11], v218 offset:11520
    ds_read_b64_tr_b16 a[48:49], v219 offset:10240
    v_mfma_f32_32x32x16_bf16 v[96:111], a[0:3], v[16:19], 0
    s_add_u32 m0, s25, 17920
    s_mov_b32 s59, 102400
    buffer_load_dwordx4 v208, s[16:19], s59 offen offset:0 lds
    v_mfma_f32_32x32x16_bf16 a[160:175], a[0:3], v[92:95], 0
    ds_read_b64_tr_b16 a[50:51], v219 offset:11520
    ds_read_b64_tr_b16 a[88:89], v220 offset:10240
    v_mfma_f32_32x32x16_bf16 v[96:111], a[40:43], v[56:59], v[96:111]
    ds_read_b64_tr_b16 a[90:91], v220 offset:11520
    buffer_load_dwordx4 v209, s[16:19], s59 offen offset:1024 lds
    v_mfma_f32_32x32x16_bf16 a[160:175], a[40:43], v[92:95], a[160:175]
    ds_read_b64_tr_b16 a[128:129], v221 offset:10240
    ds_read_b64_tr_b16 a[130:131], v221 offset:11520
    v_mfma_f32_32x32x16_bf16 v[96:111], a[80:83], v[60:63], v[96:111]
    ds_read_b64_tr_b16 v[176:177], v227 offset:10240
    buffer_load_dwordx4 v210, s[16:19], s59 offen offset:2048 lds
    v_mfma_f32_32x32x16_bf16 a[160:175], a[80:83], v[92:95], a[160:175]
    ds_read_b64_tr_b16 v[178:179], v227 offset:11520
    ds_read_b128 v[80:83], v223 offset:2048
    v_mfma_f32_32x32x16_bf16 v[96:111], a[120:123], v[64:67], v[96:111]
    ds_read_b128 v[84:87], v224 offset:2048
    buffer_load_dwordx4 v211, s[16:19], s59 offen offset:3072 lds
    v_mfma_f32_32x32x16_bf16 a[160:175], a[120:123], v[92:95], a[160:175]
    ds_read_b128 v[88:91], v225 offset:2048
    s_add_u32 m0, m0, 4096
    v_mfma_f32_32x32x16_bf16 a[224:239], v[168:171], v[92:95], 0
    s_nop 0
    buffer_load_dwordx4 v212, s[16:19], s59 offen lds
    s_waitcnt vmcnt(11)
    s_waitcnt lgkmcnt(0)
    s_barrier
    v_mfma_f32_32x32x16_bf16 a[240:255], v[172:175], v[20:23], a[240:255]
    ds_read_b64_tr_b16 a[12:13], v218 offset:15360
    ds_read_b64_tr_b16 a[14:15], v218 offset:16640
    ds_read_b64_tr_b16 a[52:53], v219 offset:15360
    v_mfma_f32_32x32x16_bf16 v[96:111], a[4:7], v[20:23], v[96:111]
    s_add_u32 m0, s25, 23040
    s_mov_b32 s59, 122880
    buffer_load_dwordx4 v208, s[16:19], s59 offen offset:0 lds
    v_mfma_f32_32x32x16_bf16 a[160:175], a[4:7], v[92:95], a[160:175]
    ds_read_b64_tr_b16 a[54:55], v219 offset:16640
    ds_read_b64_tr_b16 a[92:93], v220 offset:15360
    v_mfma_f32_32x32x16_bf16 v[96:111], a[44:47], v[68:71], v[96:111]
    ds_read_b64_tr_b16 a[94:95], v220 offset:16640
    buffer_load_dwordx4 v209, s[16:19], s59 offen offset:1024 lds
    v_mfma_f32_32x32x16_bf16 a[160:175], a[44:47], v[92:95], a[160:175]
    ds_read_b64_tr_b16 a[132:133], v221 offset:15360
    ds_read_b64_tr_b16 a[134:135], v221 offset:16640
    v_mfma_f32_32x32x16_bf16 v[96:111], a[84:87], v[72:75], v[96:111]
    ds_read_b64_tr_b16 v[180:181], v227 offset:15360
    buffer_load_dwordx4 v210, s[16:19], s59 offen offset:2048 lds
    v_mfma_f32_32x32x16_bf16 a[160:175], a[84:87], v[92:95], a[160:175]
    ds_read_b64_tr_b16 v[182:183], v227 offset:16640
    ds_read_b128 v[56:59], v223 offset:3072
    v_mfma_f32_32x32x16_bf16 v[96:111], a[124:127], v[76:79], v[96:111]
    ds_read_b128 v[60:63], v224 offset:3072
    buffer_load_dwordx4 v211, s[16:19], s59 offen offset:3072 lds
    v_mfma_f32_32x32x16_bf16 a[160:175], a[124:127], v[92:95], a[160:175]
    ds_read_b128 v[64:67], v225 offset:3072
    s_add_u32 m0, m0, 4096
    v_mfma_f32_32x32x16_bf16 a[224:239], v[172:175], v[92:95], a[224:239]
    s_nop 0
    buffer_load_dwordx4 v212, s[16:19], s59 offen lds
    s_waitcnt vmcnt(10)
    s_waitcnt lgkmcnt(0)
    s_barrier
    v_mfma_f32_32x32x16_bf16 a[240:255], v[176:179], v[24:27], a[240:255]
    ds_read_b64_tr_b16 a[16:17], v218 offset:0
    ds_read_b64_tr_b16 a[18:19], v218 offset:1280
    ds_read_b64_tr_b16 a[56:57], v219 offset:0
    v_mfma_f32_32x32x16_bf16 v[96:111], a[8:11], v[24:27], v[96:111]
    s_add_u32 m0, s25, 28160
    s_mov_b32 s59, 143360
    buffer_load_dwordx4 v208, s[16:19], s59 offen offset:0 lds
    v_mfma_f32_32x32x16_bf16 a[160:175], a[8:11], v[92:95], a[160:175]
    ds_read_b64_tr_b16 a[58:59], v219 offset:1280
    ds_read_b64_tr_b16 a[96:97], v220 offset:0
    v_mfma_f32_32x32x16_bf16 v[96:111], a[48:51], v[80:83], v[96:111]
    ds_read_b64_tr_b16 a[98:99], v220 offset:1280
    buffer_load_dwordx4 v209, s[16:19], s59 offen offset:1024 lds
    v_mfma_f32_32x32x16_bf16 a[160:175], a[48:51], v[92:95], a[160:175]
    ds_read_b64_tr_b16 a[136:137], v221 offset:0
    ds_read_b64_tr_b16 a[138:139], v221 offset:1280
    v_mfma_f32_32x32x16_bf16 v[96:111], a[88:91], v[84:87], v[96:111]
    ds_read_b64_tr_b16 v[184:185], v227 offset:0
    buffer_load_dwordx4 v210, s[16:19], s59 offen offset:2048 lds
    v_mfma_f32_32x32x16_bf16 a[160:175], a[88:91], v[92:95], a[160:175]
    ds_read_b64_tr_b16 v[186:187], v227 offset:1280
    ds_read_b128 v[68:71], v223 offset:4096
    v_mfma_f32_32x32x16_bf16 v[96:111], a[128:131], v[88:91], v[96:111]
    ds_read_b128 v[72:75], v224 offset:4096
    buffer_load_dwordx4 v211, s[16:19], s59 offen offset:3072 lds
    v_mfma_f32_32x32x16_bf16 a[160:175], a[128:131], v[92:95], a[160:175]
    ds_read_b128 v[76:79], v225 offset:4096
    s_add_u32 m0, m0, 4096
    v_mfma_f32_32x32x16_bf16 a[224:239], v[176:179], v[92:95], a[224:239]
    s_nop 0
    buffer_load_dwordx4 v212, s[16:19], s59 offen lds
    s_waitcnt vmcnt(10)
    s_waitcnt lgkmcnt(0)
    s_barrier
    v_mfma_f32_32x32x16_bf16 a[240:255], v[180:183], v[28:31], a[240:255]
    ds_read_b64_tr_b16 a[20:21], v218 offset:5120
    ds_read_b64_tr_b16 a[22:23], v218 offset:6400
    ds_read_b64_tr_b16 a[60:61], v219 offset:5120
    v_mfma_f32_32x32x16_bf16 v[96:111], a[12:15], v[28:31], v[96:111]
    s_add_u32 m0, s25, 12800
    s_mov_b32 s59, 163840
    buffer_load_dwordx4 v208, s[16:19], s59 offen offset:0 lds
    v_mfma_f32_32x32x16_bf16 a[160:175], a[12:15], v[92:95], a[160:175]
    ds_read_b64_tr_b16 a[62:63], v219 offset:6400
    ds_read_b64_tr_b16 a[100:101], v220 offset:5120
    v_mfma_f32_32x32x16_bf16 v[96:111], a[52:55], v[56:59], v[96:111]
    ds_read_b64_tr_b16 a[102:103], v220 offset:6400
    buffer_load_dwordx4 v209, s[16:19], s59 offen offset:1024 lds
    v_mfma_f32_32x32x16_bf16 a[160:175], a[52:55], v[92:95], a[160:175]
    ds_read_b64_tr_b16 a[140:141], v221 offset:5120
    ds_read_b64_tr_b16 a[142:143], v221 offset:6400
    v_mfma_f32_32x32x16_bf16 v[96:111], a[92:95], v[60:63], v[96:111]
    ds_read_b64_tr_b16 v[188:189], v227 offset:5120
    buffer_load_dwordx4 v210, s[16:19], s59 offen offset:2048 lds
    v_mfma_f32_32x32x16_bf16 a[160:175], a[92:95], v[92:95], a[160:175]
    ds_read_b64_tr_b16 v[190:191], v227 offset:6400
    ds_read_b128 v[80:83], v223 offset:5120
    v_mfma_f32_32x32x16_bf16 v[96:111], a[132:135], v[64:67], v[96:111]
    ds_read_b128 v[84:87], v224 offset:5120
    buffer_load_dwordx4 v211, s[16:19], s59 offen offset:3072 lds
    v_mfma_f32_32x32x16_bf16 a[160:175], a[132:135], v[92:95], a[160:175]
    ds_read_b128 v[88:91], v225 offset:5120
    s_add_u32 m0, m0, 4096
    v_mfma_f32_32x32x16_bf16 a[224:239], v[180:183], v[92:95], a[224:239]
    s_nop 0
    buffer_load_dwordx4 v212, s[16:19], s59 offen lds
    s_waitcnt vmcnt(10)
    s_waitcnt lgkmcnt(0)
    s_barrier
    v_mfma_f32_32x32x16_bf16 a[240:255], v[184:187], v[32:35], a[240:255]
    ds_read_b64_tr_b16 a[24:25], v218 offset:10240
    ds_read_b64_tr_b16 a[26:27], v218 offset:11520
    ds_read_b64_tr_b16 a[64:65], v219 offset:10240
    v_mfma_f32_32x32x16_bf16 v[96:111], a[16:19], v[32:35], v[96:111]
    s_add_u32 m0, s25, 17920
    s_mov_b32 s59, 184320
    buffer_load_dwordx4 v208, s[16:19], s59 offen offset:0 lds
    v_mfma_f32_32x32x16_bf16 a[160:175], a[16:19], v[92:95], a[160:175]
    ds_read_b64_tr_b16 a[66:67], v219 offset:11520
    ds_read_b64_tr_b16 a[104:105], v220 offset:10240
    v_mfma_f32_32x32x16_bf16 v[96:111], a[56:59], v[68:71], v[96:111]
    ds_read_b64_tr_b16 a[106:107], v220 offset:11520
    buffer_load_dwordx4 v209, s[16:19], s59 offen offset:1024 lds
    v_mfma_f32_32x32x16_bf16 a[160:175], a[56:59], v[92:95], a[160:175]
    ds_read_b64_tr_b16 a[144:145], v221 offset:10240
    ds_read_b64_tr_b16 a[146:147], v221 offset:11520
    v_mfma_f32_32x32x16_bf16 v[96:111], a[96:99], v[72:75], v[96:111]
    ds_read_b64_tr_b16 v[192:193], v227 offset:10240
    buffer_load_dwordx4 v210, s[16:19], s59 offen offset:2048 lds
    v_mfma_f32_32x32x16_bf16 a[160:175], a[96:99], v[92:95], a[160:175]
    ds_read_b64_tr_b16 v[194:195], v227 offset:11520
    ds_read_b128 v[56:59], v223 offset:6144
    v_mfma_f32_32x32x16_bf16 v[96:111], a[136:139], v[76:79], v[96:111]
    ds_read_b128 v[60:63], v224 offset:6144
    buffer_load_dwordx4 v211, s[16:19], s59 offen offset:3072 lds
    v_mfma_f32_32x32x16_bf16 a[160:175], a[136:139], v[92:95], a[160:175]
    ds_read_b128 v[64:67], v225 offset:6144
    s_add_u32 m0, m0, 4096
    v_mfma_f32_32x32x16_bf16 a[224:239], v[184:187], v[92:95], a[224:239]
    s_nop 0
    buffer_load_dwordx4 v212, s[16:19], s59 offen lds
    s_waitcnt vmcnt(10)
    s_waitcnt lgkmcnt(0)
    s_barrier
    v_mfma_f32_32x32x16_bf16 a[240:255], v[188:191], v[36:39], a[240:255]
    ds_read_b64_tr_b16 a[28:29], v218 offset:15360
    v_mfma_f32_32x32x16_bf16 v[96:111], a[20:23], v[36:39], v[96:111]
    ds_read_b64_tr_b16 a[30:31], v218 offset:16640
    ds_read_b64_tr_b16 a[68:69], v219 offset:15360
    v_mfma_f32_32x32x16_bf16 a[160:175], a[20:23], v[92:95], a[160:175]
    ds_read_b64_tr_b16 a[70:71], v219 offset:16640
    v_mfma_f32_32x32x16_bf16 v[96:111], a[60:63], v[80:83], v[96:111]
    ds_read_b64_tr_b16 a[108:109], v220 offset:15360
    ds_read_b64_tr_b16 a[110:111], v220 offset:16640
    v_mfma_f32_32x32x16_bf16 a[160:175], a[60:63], v[92:95], a[160:175]
    ds_read_b64_tr_b16 a[148:149], v221 offset:15360
    v_mfma_f32_32x32x16_bf16 v[96:111], a[100:103], v[84:87], v[96:111]
    ds_read_b64_tr_b16 a[150:151], v221 offset:16640
    ds_read_b64_tr_b16 v[196:197], v227 offset:15360
    v_mfma_f32_32x32x16_bf16 a[160:175], a[100:103], v[92:95], a[160:175]
    ds_read_b64_tr_b16 v[198:199], v227 offset:16640
    v_mfma_f32_32x32x16_bf16 v[96:111], a[140:143], v[88:91], v[96:111]
    ds_read_b128 v[68:71], v223 offset:7168
    ds_read_b128 v[72:75], v224 offset:7168
    v_mfma_f32_32x32x16_bf16 a[160:175], a[140:143], v[92:95], a[160:175]
    v_mfma_f32_32x32x16_bf16 a[224:239], v[188:191], v[92:95], a[224:239]
    ds_read_b128 v[76:79], v225 offset:7168
    s_mul_i32 s52, s4, 40960
    v_mul_u32_u24 v5, 1280, v2
    v_lshl_add_u32 v6, v3, 3, v5
    v_lshl_add_u32 v5, v3, 4, v5
    s_mul_i32 s56, s5, 320
    s_mul_i32 s57, s3, 80
    s_add_u32 s56, s56, s57
    s_add_u32 s56, s56, s52
    buffer_load_dwordx4 v[116:119], v5, s[12:15], s56 offen
    buffer_load_dwordx4 v[120:123], v5, s[12:15], s56 offen offset:32
    buffer_load_dwordx2 v[124:125], v6, s[12:15], s56 offen offset:64
    s_waitcnt vmcnt(8)
    s_waitcnt lgkmcnt(0)
    s_barrier
    v_mfma_f32_32x32x16_bf16 a[240:255], v[192:195], v[40:43], a[240:255]
    ds_read_b64_tr_b16 a[32:33], v218 offset:0
    v_mfma_f32_32x32x16_bf16 v[96:111], a[24:27], v[40:43], v[96:111]
    ds_read_b64_tr_b16 a[34:35], v218 offset:1280
    ds_read_b64_tr_b16 a[72:73], v219 offset:0
    v_mfma_f32_32x32x16_bf16 a[160:175], a[24:27], v[92:95], a[160:175]
    ds_read_b64_tr_b16 a[74:75], v219 offset:1280
    v_mfma_f32_32x32x16_bf16 v[96:111], a[64:67], v[56:59], v[96:111]
    ds_read_b64_tr_b16 a[112:113], v220 offset:0
    ds_read_b64_tr_b16 a[114:115], v220 offset:1280
    v_mfma_f32_32x32x16_bf16 a[160:175], a[64:67], v[92:95], a[160:175]
    ds_read_b64_tr_b16 a[152:153], v221 offset:0
    v_mfma_f32_32x32x16_bf16 v[96:111], a[104:107], v[60:63], v[96:111]
    ds_read_b64_tr_b16 a[154:155], v221 offset:1280
    ds_read_b64_tr_b16 v[200:201], v227 offset:0
    v_mfma_f32_32x32x16_bf16 a[160:175], a[104:107], v[92:95], a[160:175]
    ds_read_b64_tr_b16 v[202:203], v227 offset:1280
    v_mfma_f32_32x32x16_bf16 v[96:111], a[144:147], v[64:67], v[96:111]
    ds_read_b128 v[80:83], v223 offset:8192
    ds_read_b128 v[84:87], v224 offset:8192
    v_mfma_f32_32x32x16_bf16 a[160:175], a[144:147], v[92:95], a[160:175]
    v_mfma_f32_32x32x16_bf16 a[224:239], v[192:195], v[92:95], a[224:239]
    ds_read_b128 v[88:91], v225 offset:8192
    s_waitcnt vmcnt(3)
    s_waitcnt lgkmcnt(0)
    s_barrier
    v_mfma_f32_32x32x16_bf16 a[240:255], v[196:199], v[44:47], a[240:255]
    ds_read_b64_tr_b16 a[36:37], v218 offset:5120
    v_mfma_f32_32x32x16_bf16 v[96:111], a[28:31], v[44:47], v[96:111]
    ds_read_b64_tr_b16 a[38:39], v218 offset:6400
    ds_read_b64_tr_b16 a[76:77], v219 offset:5120
    v_mfma_f32_32x32x16_bf16 a[160:175], a[28:31], v[92:95], a[160:175]
    ds_read_b64_tr_b16 a[78:79], v219 offset:6400
    v_mfma_f32_32x32x16_bf16 v[96:111], a[68:71], v[68:71], v[96:111]
    ds_read_b64_tr_b16 a[116:117], v220 offset:5120
    ds_read_b64_tr_b16 a[118:119], v220 offset:6400
    v_mfma_f32_32x32x16_bf16 a[160:175], a[68:71], v[92:95], a[160:175]
    ds_read_b64_tr_b16 a[156:157], v221 offset:5120
    v_mfma_f32_32x32x16_bf16 v[96:111], a[108:111], v[72:75], v[96:111]
    ds_read_b64_tr_b16 a[158:159], v221 offset:6400
    ds_read_b64_tr_b16 v[204:205], v227 offset:5120
    v_mfma_f32_32x32x16_bf16 a[160:175], a[108:111], v[92:95], a[160:175]
    ds_read_b64_tr_b16 v[206:207], v227 offset:6400
    v_mfma_f32_32x32x16_bf16 v[96:111], a[148:151], v[76:79], v[96:111]
    ds_read_b128 v[56:59], v223 offset:9216
    ds_read_b128 v[60:63], v224 offset:9216
    v_mfma_f32_32x32x16_bf16 a[160:175], a[148:151], v[92:95], a[160:175]
    v_mfma_f32_32x32x16_bf16 a[224:239], v[196:199], v[92:95], a[224:239]
    ds_read_b128 v[64:67], v225 offset:9216
    v_mfma_f32_32x32x16_bf16 a[240:255], v[200:203], v[48:51], a[240:255]
    v_mfma_f32_32x32x16_bf16 v[96:111], a[32:35], v[48:51], v[96:111]
    v_mfma_f32_32x32x16_bf16 a[160:175], a[32:35], v[92:95], a[160:175]
    v_mfma_f32_32x32x16_bf16 v[96:111], a[72:75], v[80:83], v[96:111]
    v_mfma_f32_32x32x16_bf16 a[160:175], a[72:75], v[92:95], a[160:175]
    v_mfma_f32_32x32x16_bf16 v[96:111], a[112:115], v[84:87], v[96:111]
    v_mfma_f32_32x32x16_bf16 a[160:175], a[112:115], v[92:95], a[160:175]
    v_mfma_f32_32x32x16_bf16 v[96:111], a[152:155], v[88:91], v[96:111]
    v_mfma_f32_32x32x16_bf16 a[160:175], a[152:155], v[92:95], a[160:175]
    v_mfma_f32_32x32x16_bf16 a[224:239], v[200:203], v[92:95], a[224:239]
    v_mov_b32 v251, v2
    v_and_b32 v250, 7, v1
    s_lshl_b32 s60, s3, 3
    v_add_u32 v250, s60, v250
    s_mul_i32 s60, s5, 204800
    s_mul_i32 s61, s3, 40960
    s_add_u32 s60, s60, s61
    s_lshl_b32 s61, s4, 10
    s_add_u32 s60, s60, s61
    s_add_u32 s60, s60, 1048576
    s_lshl_b32 s52, s3, 10
    s_add_u32 s52, s52, 12800
    v_add_u32 v6, s52, v4
    v_add_u32 v7, 73728, v6
    s_waitcnt lgkmcnt(0)
    v_mfma_f32_32x32x16_bf16 a[240:255], v[204:207], v[52:55], a[240:255]
    v_mfma_f32_32x32x16_bf16 v[96:111], a[36:39], v[52:55], v[96:111]
    v_mfma_f32_32x32x16_bf16 a[160:175], a[36:39], v[92:95], a[160:175]
    v_mfma_f32_32x32x16_bf16 v[96:111], a[76:79], v[56:59], v[96:111]
    v_mfma_f32_32x32x16_bf16 a[160:175], a[76:79], v[92:95], a[160:175]
    v_mfma_f32_32x32x16_bf16 v[96:111], a[116:119], v[60:63], v[96:111]
    v_mfma_f32_32x32x16_bf16 a[160:175], a[116:119], v[92:95], a[160:175]
    v_mfma_f32_32x32x16_bf16 v[96:111], a[156:159], v[64:67], v[96:111]
    v_mfma_f32_32x32x16_bf16 a[160:175], a[156:159], v[92:95], a[160:175]
    v_mfma_f32_32x32x16_bf16 a[224:239], v[204:207], v[92:95], a[224:239]
    s_cmp_lt_u32 s4, 10
    s_cbranch_scc1 L_wqf
L_wqf_ret:
    s_nop 9
    ds_write_b128 v222, a[240:243] offset:12800
    ds_write_b128 v222, a[244:247] offset:13824
    ds_write_b128 v222, a[248:251] offset:14848
    ds_write_b128 v222, a[252:255] offset:15872
    ds_write_b128 v222, a[224:227] offset:23040
    ds_write_b128 v222, a[228:231] offset:24064
    ds_write_b128 v222, a[232:235] offset:25088
    ds_write_b128 v222, a[236:239] offset:26112
    v_accvgpr_read_b32 v224, a160
    v_accvgpr_read_b32 v225, a161
    v_accvgpr_read_b32 v226, a162
    v_accvgpr_read_b32 v227, a163
    v_accvgpr_read_b32 v228, a164
    v_accvgpr_read_b32 v229, a165
    v_accvgpr_read_b32 v230, a166
    v_accvgpr_read_b32 v231, a167
    v_accvgpr_read_b32 v232, a168
    v_accvgpr_read_b32 v233, a169
    v_accvgpr_read_b32 v234, a170
    v_accvgpr_read_b32 v235, a171
    v_accvgpr_read_b32 v236, a172
    v_accvgpr_read_b32 v237, a173
    v_accvgpr_read_b32 v238, a174
    v_accvgpr_read_b32 v239, a175
    s_waitcnt lgkmcnt(0)
    s_barrier
    ds_read_b128 v[56:59], v6 offset:0
    ds_read_b128 v[60:63], v6 offset:36864
    ds_read_b128 v[64:67], v7 offset:0
    ds_read_b128 v[68:71], v7 offset:36864
    ds_read_b128 v[72:75], v6 offset:10240
    ds_read_b128 v[76:79], v6 offset:47104
    ds_read_b128 v[80:83], v7 offset:10240
    ds_read_b128 v[84:87], v7 offset:47104
    s_waitcnt lgkmcnt(4)
    v_pk_add_f32 v[56:57], v[56:57], v[60:61]
    v_pk_add_f32 v[58:59], v[58:59], v[62:63]
    v_pk_add_f32 v[64:65], v[64:65], v[68:69]
    v_pk_add_f32 v[66:67], v[66:67], v[70:71]
    v_pk_add_f32 v[112:113], v[56:57], v[64:65]
    v_pk_add_f32 v[114:115], v[58:59], v[66:67]
    s_waitcnt lgkmcnt(0)
    v_pk_add_f32 v[72:73], v[72:73], v[76:77]
    v_pk_add_f32 v[74:75], v[74:75], v[78:79]
    v_pk_add_f32 v[80:81], v[80:81], v[84:85]
    v_pk_add_f32 v[82:83], v[82:83], v[86:87]
    v_pk_add_f32 v[240:241], v[72:73], v[80:81]
    v_pk_add_f32 v[242:243], v[74:75], v[82:83]
L_qpost:
    v_lshrrev_b32 v5, 1, v2
    s_lshl_b32 s52, s3, 4
    v_add_u32 v5, s52, v5
    v_mov_b32 v6, s4
    v_cmp_eq_u32 vcc, 1, v3
    v_and_b32 v7, 1, v2
    v_and_b32 v8, 3, v2
    v_cndmask_b32 v5, v5, v6, vcc
    v_cndmask_b32 v7, v7, v8, vcc
    v_lshrrev_b32 v6, 3, v5
    v_and_b32 v5, 7, v5
    v_lshl_add_u32 v5, v6, 5, v5
    v_lshl_add_u32 v5, v7, 3, v5
    v_lshlrev_b32 v10, 6, v5
    buffer_load_dword v9, v10, s[8:11], s66 offen sc1
    v_mul_f32 v6, 1051011932, v11
    v_mul_f32 v7, v6, v12
    v_pk_mul_f32 v[96:97], v[96:97], v[6:7] op_sel_hi:[1,0]
    v_pk_mul_f32 v[98:99], v[98:99], v[6:7] op_sel_hi:[1,0]
    v_pk_mul_f32 v[100:101], v[100:101], v[6:7] op_sel_hi:[1,0]
    v_pk_mul_f32 v[102:103], v[102:103], v[6:7] op_sel_hi:[1,0]
    v_pk_mul_f32 v[104:105], v[104:105], v[6:7] op_sel_hi:[1,0]
    v_pk_mul_f32 v[106:107], v[106:107], v[6:7] op_sel_hi:[1,0]
    v_pk_mul_f32 v[108:109], v[108:109], v[6:7] op_sel_hi:[1,0]
    v_pk_mul_f32 v[110:111], v[110:111], v[6:7] op_sel_hi:[1,0]
    v_pk_mul_f32 v[112:113], v[112:113], v[6:7] op_sel_hi:[1,0]
    v_pk_mul_f32 v[114:115], v[114:115], v[6:7] op_sel_hi:[1,0]
    v_pk_fma_f32 v[96:97], v[224:225], v[6:7], v[96:97] op_sel:[0,1,0] op_sel_hi:[1,1,1] neg_lo:[0,1,0] neg_hi:[0,1,0]
    v_pk_fma_f32 v[98:99], v[226:227], v[6:7], v[98:99] op_sel:[0,1,0] op_sel_hi:[1,1,1] neg_lo:[0,1,0] neg_hi:[0,1,0]
    v_pk_fma_f32 v[100:101], v[228:229], v[6:7], v[100:101] op_sel:[0,1,0] op_sel_hi:[1,1,1] neg_lo:[0,1,0] neg_hi:[0,1,0]
    v_pk_fma_f32 v[102:103], v[230:231], v[6:7], v[102:103] op_sel:[0,1,0] op_sel_hi:[1,1,1] neg_lo:[0,1,0] neg_hi:[0,1,0]
    v_pk_fma_f32 v[104:105], v[232:233], v[6:7], v[104:105] op_sel:[0,1,0] op_sel_hi:[1,1,1] neg_lo:[0,1,0] neg_hi:[0,1,0]
    v_pk_fma_f32 v[106:107], v[234:235], v[6:7], v[106:107] op_sel:[0,1,0] op_sel_hi:[1,1,1] neg_lo:[0,1,0] neg_hi:[0,1,0]
    v_pk_fma_f32 v[108:109], v[236:237], v[6:7], v[108:109] op_sel:[0,1,0] op_sel_hi:[1,1,1] neg_lo:[0,1,0] neg_hi:[0,1,0]
    v_pk_fma_f32 v[110:111], v[238:239], v[6:7], v[110:111] op_sel:[0,1,0] op_sel_hi:[1,1,1] neg_lo:[0,1,0] neg_hi:[0,1,0]
    v_pk_fma_f32 v[112:113], v[240:241], v[6:7], v[112:113] op_sel:[0,1,0] op_sel_hi:[1,1,1] neg_lo:[0,1,0] neg_hi:[0,1,0]
    v_pk_fma_f32 v[114:115], v[242:243], v[6:7], v[114:115] op_sel:[0,1,0] op_sel_hi:[1,1,1] neg_lo:[0,1,0] neg_hi:[0,1,0]
    v_cvt_pk_bf16_f32 v56, v96, v97
    v_cvt_pk_bf16_f32 v57, v98, v99
    v_cvt_pk_bf16_f32 v58, v100, v101
    v_cvt_pk_bf16_f32 v59, v102, v103
    v_cvt_pk_bf16_f32 v60, v104, v105
    v_cvt_pk_bf16_f32 v61, v106, v107
    v_cvt_pk_bf16_f32 v62, v108, v109
    v_cvt_pk_bf16_f32 v63, v110, v111
    v_cvt_pk_bf16_f32 v64, v112, v113
    v_cvt_pk_bf16_f32 v65, v114, v115
    s_lshl_b32 s52, s3, 11
    s_add_u32 s52, s52, 147456
    s_lshl_b32 s53, s3, 9
    s_add_u32 s53, s53, 155648
    v_lshl_add_u32 v7, v3, 5, v251
    v_lshl_add_u32 v5, v7, 4, s52
    v_lshl_add_u32 v6, v7, 3, s53
    ds_write_b128 v5, v[56:59]
    ds_write_b128 v5, v[60:63] offset:1024
    ds_write_b64 v6, v[64:65]
    s_lshl_b32 s52, s3, 14
    s_add_u32 s40, s52, s64
    s_lshl_b32 s52, s3, 13
    s_add_u32 s52, s52, s64
    s_add_u32 s44, s52, 65536
    s_mul_i32 s52, s3, 21504
    s_add_u32 s52, s52, s64
    s_add_u32 s46, s52, 98304
    s_add_u32 s41, s40, 4096
    s_add_u32 s42, s40, 8192
    s_add_u32 s43, s40, 12288
    s_add_u32 s45, s44, 4096
    s_add_u32 s47, s46, 4032
    s_add_u32 s48, s46, 8064
    s_add_u32 s49, s46, 12096
    s_add_u32 s50, s46, 16128
    s_add_u32 s51, s46, 20160
    s_lshl_b32 s54, s4, 8
    s_add_u32 s54, s54, 69632
    v_and_b32 v6, 3, v1
    v_lshlrev_b32 v6, 6, v6
    buffer_load_dword v13, v6, s[8:11], s54 offen sc1
    s_branch L_idle
L_idle_ret:
    s_waitcnt lgkmcnt(0)
    s_barrier
    s_waitcnt vmcnt(1)
    v_cmp_ne_u32 vcc, s6, v9
    s_nop 3
    s_cbranch_vccz Lkr_8
    s_mov_b32 s63, 0x80000
Lsp_9:
    buffer_load_dword v9, v10, s[8:11], s66 offen sc1
    s_waitcnt vmcnt(0)
    v_cmp_ne_u32 vcc, s6, v9
    s_sub_u32 s63, s63, 1
    s_cbranch_scc1 Lsd_10
    s_nop 2
    s_cbranch_vccnz Lsp_9
Lsd_10:
Lkr_8:
    s_cmp_eq_u32 s7, 0
    s_cbranch_scc1 Lrc_11
    s_and_b32 s52, s2, 7
    s_lshl_b32 s52, s52, 11
    s_add_u32 s52, s52, s67
    s_add_u32 s52, s52, 196608
    buffer_load_dwordx4 v[208:211], v4, s[8:11], s52 offen sc1
    buffer_load_dwordx4 v[212:215], v4, s[8:11], s52 offen offset:1024 sc1
Lrc_11:
    buffer_load_dwordx4 a[64:67], v4, s[8:11], s44 offen offset:0 sc1
    buffer_load_dwordx4 a[0:3], v4, s[8:11], s40 offen offset:0 sc1
    buffer_load_dwordx4 a[96:99], v15, s[8:11], s46 offen offset:0 sc1
    buffer_load_dwordx4 a[100:103], v15, s[8:11], s46 offen offset:672 sc1
    buffer_load_dwordx4 a[4:7], v4, s[8:11], s40 offen offset:1024 sc1
    buffer_load_dwordx4 a[104:107], v15, s[8:11], s46 offen offset:1344 sc1
    buffer_load_dwordx4 a[108:111], v15, s[8:11], s46 offen offset:2016 sc1
    ds_read_b128 v[96:99], v126 offset:0
    ds_read_b128 v[100:103], v126 offset:1024
    ds_read_b64 v[104:105], v127 offset:0
    v_mov_b32 v8, -1
    v_mov_b32 v9, -1
    v_mov_b32 v10, -1
    v_mov_b32 v11, -1
    s_cmp_eq_u32 s7, 0
    s_cbranch_scc1 L_loc
L_loc_ret:
    s_mul_i32 s52, s4, 40960
    s_mul_i32 s53, s3, 10240
    s_add_u32 s52, s52, s53
    s_and_b32 s53, s5, 1
    s_mul_i32 s53, s53, 5120
    s_add_u32 s52, s52, s53
    s_lshr_b32 s53, s5, 1
    s_mul_i32 s53, s53, 2621440
    s_add_u32 s52, s52, s53
    s_add_u32 s52, s52, 3145728
    buffer_load_dwordx4 a[68:71], v4, s[8:11], s44 offen offset:1024 sc1
    buffer_load_dwordx4 a[8:11], v4, s[8:11], s40 offen offset:2048 sc1
    buffer_load_dwordx4 a[112:115], v15, s[8:11], s46 offen offset:2688 sc1
    buffer_load_dwordx4 a[116:119], v15, s[8:11], s46 offen offset:3360 sc1
    s_cmp_eq_u32 s39, 0
    s_cbranch_scc1 Lrm_12
    buffer_store_dwordx4 v[8:11], v4, s[8:11], s52 offen offset:0
    buffer_store_dwordx4 v[8:11], v4, s[8:11], s52 offen offset:1024
    buffer_store_dwordx4 v[8:11], v4, s[8:11], s52 offen offset:2048
    buffer_store_dwordx4 v[8:11], v4, s[8:11], s52 offen offset:3072
    buffer_store_dwordx4 v[8:11], v254, s[8:11], s52 offen offset:0
    s_branch Lrd_13
Lrm_12:
    buffer_store_dwordx4 v[8:11], v4, s[8:11], s52 offen offset:0 sc1
    buffer_store_dwordx4 v[8:11], v4, s[8:11], s52 offen offset:1024 sc1
    buffer_store_dwordx4 v[8:11], v4, s[8:11], s52 offen offset:2048 sc1
    buffer_store_dwordx4 v[8:11], v4, s[8:11], s52 offen offset:3072 sc1
    buffer_store_dwordx4 v[8:11], v254, s[8:11], s52 offen offset:0 sc1
Lrd_13:
    s_waitcnt lgkmcnt(0)
    s_waitcnt vmcnt(12)
    v_mfma_f32_32x32x16_bf16 v[16:31], a[0:3], v[96:99], 0
    v_mfma_f32_32x32x16_bf16 v[32:47], a[0:3], v[100:103], 0
    s_nop 7
    s_nop 1
    v_mfma_f32_32x32x4_2b_bf16 v[16:47], a[64:65], v[104:105], v[16:47]
    s_nop 15
    s_nop 3
    s_waitcnt vmcnt(9)
    v_mfma_f32_32x32x16_bf16 v[48:63], a[4:7], v[96:99], 0
    v_exp_f32 v16, v16
    v_exp_f32 v17, v17
    v_exp_f32 v18, v18
    v_exp_f32 v19, v19
    v_cvt_pk_bf16_f32 v80, v16, v17
    v_exp_f32 v20, v20
    v_exp_f32 v21, v21
    v_cvt_pk_bf16_f32 v81, v18, v19
    v_exp_f32 v22, v22
    v_exp_f32 v23, v23
    v_cvt_pk_bf16_f32 v82, v20, v21
    v_exp_f32 v24, v24
    buffer_load_dwordx4 a[12:15], v4, s[8:11], s40 offen offset:3072 sc1
    buffer_load_dwordx4 a[120:123], v15, s[8:11], s47 offen offset:0 sc1
    buffer_load_dwordx4 a[124:127], v15, s[8:11], s47 offen offset:672 sc1
    v_mfma_f32_32x32x16_bf16 v[64:79], a[4:7], v[100:103], 0
    v_exp_f32 v25, v25
    v_cvt_pk_bf16_f32 v83, v22, v23
    v_exp_f32 v26, v26
    v_exp_f32 v27, v27
    v_cvt_pk_bf16_f32 v84, v24, v25
    v_exp_f32 v28, v28
    v_exp_f32 v29, v29
    v_cvt_pk_bf16_f32 v85, v26, v27
    v_exp_f32 v30, v30
    v_exp_f32 v31, v31
    v_cvt_pk_bf16_f32 v86, v28, v29
    v_cvt_pk_bf16_f32 v87, v30, v31
    v_mfma_f32_32x32x4_2b_bf16 v[48:79], a[66:67], v[104:105], v[48:79]
    v_exp_f32 v32, v32
    v_exp_f32 v33, v33
    v_exp_f32 v34, v34
    v_exp_f32 v35, v35
    v_cvt_pk_bf16_f32 v88, v32, v33
    v_exp_f32 v36, v36
    v_exp_f32 v37, v37
    v_cvt_pk_bf16_f32 v89, v34, v35
    v_exp_f32 v38, v38
    v_exp_f32 v39, v39
    buffer_load_dwordx4 a[72:75], v4, s[8:11], s44 offen offset:2048 sc1
    buffer_load_dwordx4 a[16:19], v4, s[8:11], s41 offen offset:0 sc1
    buffer_load_dwordx4 a[128:131], v15, s[8:11], s47 offen offset:1344 sc1
    buffer_load_dwordx4 a[132:135], v15, s[8:11], s47 offen offset:2016 sc1
    v_mfma_f32_32x32x16_bf16 a[224:239], a[96:99], v[80:83], 0
    v_cvt_pk_bf16_f32 v90, v36, v37
    v_exp_f32 v40, v40
    v_exp_f32 v41, v41
    v_cvt_pk_bf16_f32 v91, v38, v39
    v_exp_f32 v42, v42
    v_exp_f32 v43, v43
    v_cvt_pk_bf16_f32 v92, v40, v41
    v_mfma_f32_32x32x16_bf16 a[224:239], a[100:103], v[84:87], a[224:239]
    v_exp_f32 v44, v44
    v_exp_f32 v45, v45
    v_cvt_pk_bf16_f32 v93, v42, v43
    v_exp_f32 v46, v46
    v_exp_f32 v47, v47
    v_cvt_pk_bf16_f32 v94, v44, v45
    v_cvt_pk_bf16_f32 v95, v46, v47
    s_waitcnt vmcnt(12)
    v_mfma_f32_32x32x16_bf16 v[16:31], a[8:11], v[96:99], 0
    v_exp_f32 v48, v48
    v_exp_f32 v49, v49
    v_exp_f32 v50, v50
    v_exp_f32 v51, v51
    v_cvt_pk_bf16_f32 v80, v48, v49
    v_exp_f32 v52, v52
    v_mfma_f32_32x32x16_bf16 a[240:255], a[96:99], v[88:91], 0
    v_exp_f32 v53, v53
    v_cvt_pk_bf16_f32 v81, v50, v51
    v_exp_f32 v54, v54
    v_exp_f32 v55, v55
    v_cvt_pk_bf16_f32 v82, v52, v53
    v_exp_f32 v56, v56
    buffer_load_dwordx4 a[20:23], v4, s[8:11], s41 offen offset:1024 sc1
    buffer_load_dwordx4 a[136:139], v15, s[8:11], s47 offen offset:2688 sc1
    buffer_load_dwordx4 a[140:143], v15, s[8:11], s47 offen offset:3360 sc1
    v_mfma_f32_32x32x16_bf16 v[32:47], a[8:11], v[100:103], 0
    v_exp_f32 v57, v57
    v_cvt_pk_bf16_f32 v83, v54, v55
    v_exp_f32 v58, v58
    v_exp_f32 v59, v59
    v_cvt_pk_bf16_f32 v84, v56, v57
    v_exp_f32 v60, v60
    v_mfma_f32_32x32x16_bf16 a[240:255], a[100:103], v[92:95], a[240:255]
    v_exp_f32 v61, v61
    v_cvt_pk_bf16_f32 v85, v58, v59
    v_exp_f32 v62, v62
    v_exp_f32 v63, v63
    v_cvt_pk_bf16_f32 v86, v60, v61
    v_cvt_pk_bf16_f32 v87, v62, v63
    v_mfma_f32_32x32x4_2b_bf16 v[16:47], a[68:69], v[104:105], v[16:47]
    v_exp_f32 v64, v64
    v_exp_f32 v65, v65
    v_exp_f32 v66, v66
    v_exp_f32 v67, v67
    v_cvt_pk_bf16_f32 v88, v64, v65
    v_exp_f32 v68, v68
    v_exp_f32 v69, v69
    v_cvt_pk_bf16_f32 v89, v66, v67
    v_exp_f32 v70, v70
    v_exp_f32 v71, v71
    buffer_load_dwordx4 a[76:79], v4, s[8:11], s44 offen offset:3072 sc1
    buffer_load_dwordx4 a[24:27], v4, s[8:11], s41 offen offset:2048 sc1
    buffer_load_dwordx4 a[144:147], v15, s[8:11], s48 offen offset:0 sc1
    buffer_load_dwordx4 a[148:151], v15, s[8:11], s48 offen offset:672 sc1
    v_mfma_f32_32x32x16_bf16 a[224:239], a[104:107], v[80:83], a[224:239]
    v_cvt_pk_bf16_f32 v90, v68, v69
    v_exp_f32 v72, v72
    v_exp_f32 v73, v73
    v_cvt_pk_bf16_f32 v91, v70, v71
    v_exp_f32 v74, v74
    v_exp_f32 v75, v75
    v_cvt_pk_bf16_f32 v92, v72, v73
    v_mfma_f32_32x32x16_bf16 a[224:239], a[108:111], v[84:87], a[224:239]
    v_exp_f32 v76, v76
    v_exp_f32 v77, v77
    v_cvt_pk_bf16_f32 v93, v74, v75
    v_exp_f32 v78, v78
    v_exp_f32 v79, v79
    v_cvt_pk_bf16_f32 v94, v76, v77
    v_cvt_pk_bf16_f32 v95, v78, v79
    s_cmp_lg_u32 s7, 0
    s_cbranch_scc1 L_top2
L_top2_ret:
    s_waitcnt vmcnt(11)
    v_mfma_f32_32x32x16_bf16 v[48:63], a[12:15], v[96:99], 0
    v_exp_f32 v16, v16
    v_exp_f32 v17, v17
    v_exp_f32 v18, v18
    v_exp_f32 v19, v19
    v_cvt_pk_bf16_f32 v80, v16, v17
    v_exp_f32 v20, v20
    v_mfma_f32_32x32x16_bf16 a[240:255], a[104:107], v[88:91], a[240:255]
    v_exp_f32 v21, v21
    v_cvt_pk_bf16_f32 v81, v18, v19
    v_exp_f32 v22, v22
    v_exp_f32 v23, v23
    v_cvt_pk_bf16_f32 v82, v20, v21
    v_exp_f32 v24, v24
    buffer_load_dwordx4 a[28:31], v4, s[8:11], s41 offen offset:3072 sc1
    buffer_load_dwordx4 a[152:155], v15, s[8:11], s48 offen offset:1344 sc1
    buffer_load_dwordx4 a[156:159], v15, s[8:11], s48 offen offset:2016 sc1
    v_mfma_f32_32x32x16_bf16 v[64:79], a[12:15], v[100:103], 0
    v_exp_f32 v25, v25
    v_cvt_pk_bf16_f32 v83, v22, v23
    v_exp_f32 v26, v26
    v_exp_f32 v27, v27
    v_cvt_pk_bf16_f32 v84, v24, v25
    v_exp_f32 v28, v28
    v_mfma_f32_32x32x16_bf16 a[240:255], a[108:111], v[92:95], a[240:255]
    v_exp_f32 v29, v29
    v_cvt_pk_bf16_f32 v85, v26, v27
    v_exp_f32 v30, v30
    v_exp_f32 v31, v31
    v_cvt_pk_bf16_f32 v86, v28, v29
    v_cvt_pk_bf16_f32 v87, v30, v31
    v_mfma_f32_32x32x4_2b_bf16 v[48:79], a[70:71], v[104:105], v[48:79]
    v_exp_f32 v32, v32
    v_exp_f32 v33, v33
    v_exp_f32 v34, v34
    v_exp_f32 v35, v35
    v_cvt_pk_bf16_f32 v88, v32, v33
    v_exp_f32 v36, v36
    v_exp_f32 v37, v37
    v_cvt_pk_bf16_f32 v89, v34, v35
    v_exp_f32 v38, v38
    v_exp_f32 v39, v39
    buffer_load_dwordx4 a[80:83], v4, s[8:11], s45 offen offset:0 sc1
    buffer_load_dwordx4 a[32:35], v4, s[8:11], s42 offen offset:0 sc1
    buffer_load_dwordx4 a[160:163], v15, s[8:11], s48 offen offset:2688 sc1
    buffer_load_dwordx4 a[164:167], v15, s[8:11], s48 offen offset:3360 sc1
    v_mfma_f32_32x32x16_bf16 a[224:239], a[112:115], v[80:83], a[224:239]
    v_cvt_pk_bf16_f32 v90, v36, v37
    v_exp_f32 v40, v40
    v_exp_f32 v41, v41
    v_cvt_pk_bf16_f32 v91, v38, v39
    v_exp_f32 v42, v42
    v_exp_f32 v43, v43
    v_cvt_pk_bf16_f32 v92, v40, v41
    v_mfma_f32_32x32x16_bf16 a[224:239], a[116:119], v[84:87], a[224:239]
    v_exp_f32 v44, v44
    v_exp_f32 v45, v45
    v_cvt_pk_bf16_f32 v93, v42, v43
    v_exp_f32 v46, v46
    v_exp_f32 v47, v47
    v_cvt_pk_bf16_f32 v94, v44, v45
    v_cvt_pk_bf16_f32 v95, v46, v47
    s_waitcnt vmcnt(14)
    v_mfma_f32_32x32x16_bf16 v[16:31], a[16:19], v[96:99], 0
    v_exp_f32 v48, v48
    v_exp_f32 v49, v49
    v_exp_f32 v50, v50
    v_exp_f32 v51, v51
    v_cvt_pk_bf16_f32 v80, v48, v49
    v_exp_f32 v52, v52
    v_mfma_f32_32x32x16_bf16 a[240:255], a[112:115], v[88:91], a[240:255]
    v_exp_f32 v53, v53
    v_cvt_pk_bf16_f32 v81, v50, v51
    v_exp_f32 v54, v54
    v_exp_f32 v55, v55
    v_cvt_pk_bf16_f32 v82, v52, v53
    v_exp_f32 v56, v56
    buffer_load_dwordx4 a[36:39], v4, s[8:11], s42 offen offset:1024 sc1
    buffer_load_dwordx4 a[168:171], v15, s[8:11], s49 offen offset:0 sc1
    buffer_load_dwordx4 a[172:175], v15, s[8:11], s49 offen offset:672 sc1
    v_mfma_f32_32x32x16_bf16 v[32:47], a[16:19], v[100:103], 0
    v_exp_f32 v57, v57
    v_cvt_pk_bf16_f32 v83, v54, v55
    v_exp_f32 v58, v58
    v_exp_f32 v59, v59
    v_cvt_pk_bf16_f32 v84, v56, v57
    v_exp_f32 v60, v60
    v_mfma_f32_32x32x16_bf16 a[240:255], a[116:119], v[92:95], a[240:255]
    v_exp_f32 v61, v61
    v_cvt_pk_bf16_f32 v85, v58, v59
    v_exp_f32 v62, v62
    v_exp_f32 v63, v63
    v_cvt_pk_bf16_f32 v86, v60, v61
    v_cvt_pk_bf16_f32 v87, v62, v63
    v_mfma_f32_32x32x4_2b_bf16 v[16:47], a[72:73], v[104:105], v[16:47]
    v_exp_f32 v64, v64
    v_exp_f32 v65, v65
    v_exp_f32 v66, v66
    v_exp_f32 v67, v67
    v_cvt_pk_bf16_f32 v88, v64, v65
    v_exp_f32 v68, v68
    v_exp_f32 v69, v69
    v_cvt_pk_bf16_f32 v89, v66, v67
    v_exp_f32 v70, v70
    v_exp_f32 v71, v71
    v_mfma_f32_32x32x16_bf16 a[224:239], a[120:123], v[80:83], a[224:239]
    v_cvt_pk_bf16_f32 v90, v68, v69
    v_exp_f32 v72, v72
    v_exp_f32 v73, v73
    v_cvt_pk_bf16_f32 v91, v70, v71
    v_exp_f32 v74, v74
    v_exp_f32 v75, v75
    v_cvt_pk_bf16_f32 v92, v72, v73
    v_mfma_f32_32x32x16_bf16 a[224:239], a[124:127], v[84:87], a[224:239]
    v_exp_f32 v76, v76
    v_exp_f32 v77, v77
    v_cvt_pk_bf16_f32 v93, v74, v75
    v_exp_f32 v78, v78
    v_exp_f32 v79, v79
    v_cvt_pk_bf16_f32 v94, v76, v77
    v_cvt_pk_bf16_f32 v95, v78, v79
    s_waitcnt vmcnt(14)
    v_mfma_f32_32x32x16_bf16 v[48:63], a[20:23], v[96:99], 0
    v_exp_f32 v16, v16
    v_exp_f32 v17, v17
    v_exp_f32 v18, v18
    v_exp_f32 v19, v19
    v_cvt_pk_bf16_f32 v80, v16, v17
    v_exp_f32 v20, v20
    v_mfma_f32_32x32x16_bf16 a[240:255], a[120:123], v[88:91], a[240:255]
    v_exp_f32 v21, v21
    v_cvt_pk_bf16_f32 v81, v18, v19
    v_exp_f32 v22, v22
    v_exp_f32 v23, v23
    v_cvt_pk_bf16_f32 v82, v20, v21
    v_exp_f32 v24, v24
    buffer_load_dwordx4 a[84:87], v4, s[8:11], s45 offen offset:1024 sc1
    buffer_load_dwordx4 a[40:43], v4, s[8:11], s42 offen offset:2048 sc1
    buffer_load_dwordx4 a[176:179], v15, s[8:11], s49 offen offset:1344 sc1
    buffer_load_dwordx4 a[180:183], v15, s[8:11], s49 offen offset:2016 sc1
    v_mfma_f32_32x32x16_bf16 v[64:79], a[20:23], v[100:103], 0
    v_exp_f32 v25, v25
    v_cvt_pk_bf16_f32 v83, v22, v23
    v_exp_f32 v26, v26
    v_exp_f32 v27, v27
    v_cvt_pk_bf16_f32 v84, v24, v25
    v_exp_f32 v28, v28
    v_mfma_f32_32x32x16_bf16 a[240:255], a[124:127], v[92:95], a[240:255]
    v_exp_f32 v29, v29
    v_cvt_pk_bf16_f32 v85, v26, v27
    v_exp_f32 v30, v30
    v_exp_f32 v31, v31
    v_cvt_pk_bf16_f32 v86, v28, v29
    v_cvt_pk_bf16_f32 v87, v30, v31
    v_mfma_f32_32x32x4_2b_bf16 v[48:79], a[74:75], v[104:105], v[48:79]
    v_exp_f32 v32, v32
    v_exp_f32 v33, v33
    v_exp_f32 v34, v34
    v_exp_f32 v35, v35
    v_cvt_pk_bf16_f32 v88, v32, v33
    v_exp_f32 v36, v36
    v_exp_f32 v37, v37
    v_cvt_pk_bf16_f32 v89, v34, v35
    v_exp_f32 v38, v38
    v_exp_f32 v39, v39
    v_mfma_f32_32x32x16_bf16 a[224:239], a[128:131], v[80:83], a[224:239]
    v_cvt_pk_bf16_f32 v90, v36, v37
    v_exp_f32 v40, v40
    v_exp_f32 v41, v41
    v_cvt_pk_bf16_f32 v91, v38, v39
    v_exp_f32 v42, v42
    v_exp_f32 v43, v43
    v_cvt_pk_bf16_f32 v92, v40, v41
    v_mfma_f32_32x32x16_bf16 a[224:239], a[132:135], v[84:87], a[224:239]
    v_exp_f32 v44, v44
    v_exp_f32 v45, v45
    v_cvt_pk_bf16_f32 v93, v42, v43
    v_exp_f32 v46, v46
    v_exp_f32 v47, v47
    v_cvt_pk_bf16_f32 v94, v44, v45
    v_cvt_pk_bf16_f32 v95, v46, v47
    s_waitcnt vmcnt(14)
    v_mfma_f32_32x32x16_bf16 v[16:31], a[24:27], v[96:99], 0
    v_exp_f32 v48, v48
    v_exp_f32 v49, v49
    v_exp_f32 v50, v50
    v_exp_f32 v51, v51
    v_cvt_pk_bf16_f32 v80, v48, v49
    v_exp_f32 v52, v52
    v_mfma_f32_32x32x16_bf16 a[240:255], a[128:131], v[88:91], a[240:255]
    v_exp_f32 v53, v53
    v_cvt_pk_bf16_f32 v81, v50, v51
    v_exp_f32 v54, v54
    v_exp_f32 v55, v55
    v_cvt_pk_bf16_f32 v82, v52, v53
    v_exp_f32 v56, v56
    buffer_load_dwordx4 a[44:47], v4, s[8:11], s42 offen offset:3072 sc1
    buffer_load_dwordx4 a[184:187], v15, s[8:11], s49 offen offset:2688 sc1
    buffer_load_dwordx4 a[188:191], v15, s[8:11], s49 offen offset:3360 sc1
    v_mfma_f32_32x32x16_bf16 v[32:47], a[24:27], v[100:103], 0
    v_exp_f32 v57, v57
    v_cvt_pk_bf16_f32 v83, v54, v55
    v_exp_f32 v58, v58
    v_exp_f32 v59, v59
    v_cvt_pk_bf16_f32 v84, v56, v57
    v_exp_f32 v60, v60
    v_mfma_f32_32x32x16_bf16 a[240:255], a[132:135], v[92:95], a[240:255]
    v_exp_f32 v61, v61
    v_cvt_pk_bf16_f32 v85, v58, v59
    v_exp_f32 v62, v62
    v_exp_f32 v63, v63
    v_cvt_pk_bf16_f32 v86, v60, v61
    v_cvt_pk_bf16_f32 v87, v62, v63
    v_mfma_f32_32x32x4_2b_bf16 v[16:47], a[76:77], v[104:105], v[16:47]
    v_exp_f32 v64, v64
    v_exp_f32 v65, v65
    v_exp_f32 v66, v66
    v_exp_f32 v67, v67
    v_cvt_pk_bf16_f32 v88, v64, v65
    v_exp_f32 v68, v68
    v_exp_f32 v69, v69
    v_cvt_pk_bf16_f32 v89, v66, v67
    v_exp_f32 v70, v70
    v_exp_f32 v71, v71
    v_mfma_f32_32x32x16_bf16 a[224:239], a[136:139], v[80:83], a[224:239]
    v_cvt_pk_bf16_f32 v90, v68, v69
    v_exp_f32 v72, v72
    v_exp_f32 v73, v73
    v_cvt_pk_bf16_f32 v91, v70, v71
    v_exp_f32 v74, v74
    v_exp_f32 v75, v75
    v_cvt_pk_bf16_f32 v92, v72, v73
    v_mfma_f32_32x32x16_bf16 a[224:239], a[140:143], v[84:87], a[224:239]
    v_exp_f32 v76, v76
    v_exp_f32 v77, v77
    v_cvt_pk_bf16_f32 v93, v74, v75
    v_exp_f32 v78, v78
    v_exp_f32 v79, v79
    v_cvt_pk_bf16_f32 v94, v76, v77
    v_cvt_pk_bf16_f32 v95, v78, v79
    s_bitcmp1_b32 s24, 0
    s_cbranch_scc1 L_u2
L_u2_ret:
    s_waitcnt vmcnt(14)
    v_mfma_f32_32x32x16_bf16 v[48:63], a[28:31], v[96:99], 0
    v_exp_f32 v16, v16
    v_exp_f32 v17, v17
    v_exp_f32 v18, v18
    v_exp_f32 v19, v19
    v_cvt_pk_bf16_f32 v80, v16, v17
    v_exp_f32 v20, v20
    v_mfma_f32_32x32x16_bf16 a[240:255], a[136:139], v[88:91], a[240:255]
    v_exp_f32 v21, v21
    v_cvt_pk_bf16_f32 v81, v18, v19
    v_exp_f32 v22, v22
    v_exp_f32 v23, v23
    v_cvt_pk_bf16_f32 v82, v20, v21
    v_exp_f32 v24, v24
    buffer_load_dwordx4 a[88:91], v4, s[8:11], s45 offen offset:2048 sc1
    buffer_load_dwordx4 a[48:51], v4, s[8:11], s43 offen offset:0 sc1
    buffer_load_dwordx4 a[192:195], v15, s[8:11], s50 offen offset:0 sc1
    buffer_load_dwordx4 a[196:199], v15, s[8:11], s50 offen offset:672 sc1
    v_mfma_f32_32x32x16_bf16 v[64:79], a[28:31], v[100:103], 0
    v_exp_f32 v25, v25
    v_cvt_pk_bf16_f32 v83, v22, v23
    v_exp_f32 v26, v26
    v_exp_f32 v27, v27
    v_cvt_pk_bf16_f32 v84, v24, v25
    v_exp_f32 v28, v28
    v_mfma_f32_32x32x16_bf16 a[240:255], a[140:143], v[92:95], a[240:255]
    v_exp_f32 v29, v29
    v_cvt_pk_bf16_f32 v85, v26, v27
    v_exp_f32 v30, v30
    v_exp_f32 v31, v31
    v_cvt_pk_bf16_f32 v86, v28, v29
    v_cvt_pk_bf16_f32 v87, v30, v31
    v_mfma_f32_32x32x4_2b_bf16 v[48:79], a[78:79], v[104:105], v[48:79]
    v_exp_f32 v32, v32
    v_exp_f32 v33, v33
    v_exp_f32 v34, v34
    v_exp_f32 v35, v35
    v_cvt_pk_bf16_f32 v88, v32, v33
    v_exp_f32 v36, v36
    v_exp_f32 v37, v37
    v_cvt_pk_bf16_f32 v89, v34, v35
    v_exp_f32 v38, v38
    v_exp_f32 v39, v39
    v_mfma_f32_32x32x16_bf16 a[224:239], a[144:147], v[80:83], a[224:239]
    v_cvt_pk_bf16_f32 v90, v36, v37
    v_exp_f32 v40, v40
    v_exp_f32 v41, v41
    v_cvt_pk_bf16_f32 v91, v38, v39
    v_exp_f32 v42, v42
    v_exp_f32 v43, v43
    v_cvt_pk_bf16_f32 v92, v40, v41
    v_mfma_f32_32x32x16_bf16 a[224:239], a[148:151], v[84:87], a[224:239]
    v_exp_f32 v44, v44
    v_exp_f32 v45, v45
    v_cvt_pk_bf16_f32 v93, v42, v43
    v_exp_f32 v46, v46
    v_exp_f32 v47, v47
    v_cvt_pk_bf16_f32 v94, v44, v45
    v_cvt_pk_bf16_f32 v95, v46, v47
    s_waitcnt vmcnt(14)
    v_mfma_f32_32x32x16_bf16 v[16:31], a[32:35], v[96:99], 0
    v_exp_f32 v48, v48
    v_exp_f32 v49, v49
    v_exp_f32 v50, v50
    v_exp_f32 v51, v51
    v_cvt_pk_bf16_f32 v80, v48, v49
    v_exp_f32 v52, v52
    v_mfma_f32_32x32x16_bf16 a[240:255], a[144:147], v[88:91], a[240:255]
    v_exp_f32 v53, v53
    v_cvt_pk_bf16_f32 v81, v50, v51
    v_exp_f32 v54, v54
    v_exp_f32 v55, v55
    v_cvt_pk_bf16_f32 v82, v52, v53
    v_exp_f32 v56, v56
    buffer_load_dwordx4 a[52:55], v4, s[8:11], s43 offen offset:1024 sc1
    buffer_load_dwordx4 a[200:203], v15, s[8:11], s50 offen offset:1344 sc1
    buffer_load_dwordx4 a[204:207], v15, s[8:11], s50 offen offset:2016 sc1
    v_mfma_f32_32x32x16_bf16 v[32:47], a[32:35], v[100:103], 0
    v_exp_f32 v57, v57
    v_cvt_pk_bf16_f32 v83, v54, v55
    v_exp_f32 v58, v58
    v_exp_f32 v59, v59
    v_cvt_pk_bf16_f32 v84, v56, v57
    v_exp_f32 v60, v60
    v_mfma_f32_32x32x16_bf16 a[240:255], a[148:151], v[92:95], a[240:255]
    v_exp_f32 v61, v61
    v_cvt_pk_bf16_f32 v85, v58, v59
    v_exp_f32 v62, v62
    v_exp_f32 v63, v63
    v_cvt_pk_bf16_f32 v86, v60, v61
    v_cvt_pk_bf16_f32 v87, v62, v63
    v_mfma_f32_32x32x4_2b_bf16 v[16:47], a[80:81], v[104:105], v[16:47]
    v_exp_f32 v64, v64
    v_exp_f32 v65, v65
    v_exp_f32 v66, v66
    v_exp_f32 v67, v67
    v_cvt_pk_bf16_f32 v88, v64, v65
    v_exp_f32 v68, v68
    v_exp_f32 v69, v69
    v_cvt_pk_bf16_f32 v89, v66, v67
    v_exp_f32 v70, v70
    v_exp_f32 v71, v71
    v_mfma_f32_32x32x16_bf16 a[224:239], a[152:155], v[80:83], a[224:239]
    v_cvt_pk_bf16_f32 v90, v68, v69
    v_exp_f32 v72, v72
    v_exp_f32 v73, v73
    v_cvt_pk_bf16_f32 v91, v70, v71
    v_exp_f32 v74, v74
    v_exp_f32 v75, v75
    v_cvt_pk_bf16_f32 v92, v72, v73
    v_mfma_f32_32x32x16_bf16 a[224:239], a[156:159], v[84:87], a[224:239]
    v_exp_f32 v76, v76
    v_exp_f32 v77, v77
    v_cvt_pk_bf16_f32 v93, v74, v75
    v_exp_f32 v78, v78
    v_exp_f32 v79, v79
    v_cvt_pk_bf16_f32 v94, v76, v77
    v_cvt_pk_bf16_f32 v95, v78, v79
    s_waitcnt vmcnt(14)
    v_mfma_f32_32x32x16_bf16 v[48:63], a[36:39], v[96:99], 0
    v_exp_f32 v16, v16
    v_exp_f32 v17, v17
    v_exp_f32 v18, v18
    v_exp_f32 v19, v19
    v_cvt_pk_bf16_f32 v80, v16, v17
    v_exp_f32 v20, v20
    v_mfma_f32_32x32x16_bf16 a[240:255], a[152:155], v[88:91], a[240:255]
    v_exp_f32 v21, v21
    v_cvt_pk_bf16_f32 v81, v18, v19
    v_exp_f32 v22, v22
    v_exp_f32 v23, v23
    v_cvt_pk_bf16_f32 v82, v20, v21
    v_exp_f32 v24, v24
    buffer_load_dwordx4 a[92:95], v4, s[8:11], s45 offen offset:3072 sc1
    buffer_load_dwordx4 a[56:59], v4, s[8:11], s43 offen offset:2048 sc1
    buffer_load_dwordx4 a[208:211], v15, s[8:11], s50 offen offset:2688 sc1
    buffer_load_dwordx4 a[212:215], v15, s[8:11], s50 offen offset:3360 sc1
    ds_read_b128 v[106:109], v126 offset:128
    ds_read_b128 v[110:113], v126 offset:1152
    ds_read_b64 v[114:115], v127 offset:64
    v_mfma_f32_32x32x16_bf16 v[64:79], a[36:39], v[100:103], 0
    v_exp_f32 v25, v25
    v_cvt_pk_bf16_f32 v83, v22, v23
    v_exp_f32 v26, v26
    v_exp_f32 v27, v27
    v_cvt_pk_bf16_f32 v84, v24, v25
    v_exp_f32 v28, v28
    v_mfma_f32_32x32x16_bf16 a[240:255], a[156:159], v[92:95], a[240:255]
    v_exp_f32 v29, v29
    v_cvt_pk_bf16_f32 v85, v26, v27
    v_exp_f32 v30, v30
    v_exp_f32 v31, v31
    v_cvt_pk_bf16_f32 v86, v28, v29
    v_cvt_pk_bf16_f32 v87, v30, v31
    v_mfma_f32_32x32x4_2b_bf16 v[48:79], a[82:83], v[104:105], v[48:79]
    v_exp_f32 v32, v32
    v_exp_f32 v33, v33
    v_exp_f32 v34, v34
    v_exp_f32 v35, v35
    v_cvt_pk_bf16_f32 v88, v32, v33
    v_exp_f32 v36, v36
    v_exp_f32 v37, v37
    v_cvt_pk_bf16_f32 v89, v34, v35
    v_exp_f32 v38, v38
    v_exp_f32 v39, v39
    v_mfma_f32_32x32x16_bf16 a[224:239], a[160:163], v[80:83], a[224:239]
    v_cvt_pk_bf16_f32 v90, v36, v37
    v_exp_f32 v40, v40
    v_exp_f32 v41, v41
    v_cvt_pk_bf16_f32 v91, v38, v39
    v_exp_f32 v42, v42
    v_exp_f32 v43, v43
    v_cvt_pk_bf16_f32 v92, v40, v41
    v_mfma_f32_32x32x16_bf16 a[224:239], a[164:167], v[84:87], a[224:239]
    v_exp_f32 v44, v44
    v_exp_f32 v45, v45
    v_cvt_pk_bf16_f32 v93, v42, v43
    v_exp_f32 v46, v46
    v_exp_f32 v47, v47
    v_cvt_pk_bf16_f32 v94, v44, v45
    v_cvt_pk_bf16_f32 v95, v46, v47
    s_waitcnt vmcnt(14)
    v_mfma_f32_32x32x16_bf16 v[16:31], a[40:43], v[96:99], 0
    v_exp_f32 v48, v48
    v_exp_f32 v49, v49
    v_exp_f32 v50, v50
    v_exp_f32 v51, v51
    v_cvt_pk_bf16_f32 v80, v48, v49
    v_exp_f32 v52, v52
    v_mfma_f32_32x32x16_bf16 a[240:255], a[160:163], v[88:91], a[240:255]
    v_exp_f32 v53, v53
    v_cvt_pk_bf16_f32 v81, v50, v51
    v_exp_f32 v54, v54
    v_exp_f32 v55, v55
    v_cvt_pk_bf16_f32 v82, v52, v53
    v_exp_f32 v56, v56
    buffer_load_dwordx4 a[60:63], v4, s[8:11], s43 offen offset:3072 sc1
    buffer_load_dwordx4 a[216:219], v15, s[8:11], s51 offen offset:0 sc1
    buffer_load_dwordx4 a[220:223], v15, s[8:11], s51 offen offset:672 sc1
    v_mfma_f32_32x32x16_bf16 v[32:47], a[40:43], v[100:103], 0
    v_exp_f32 v57, v57
    v_cvt_pk_bf16_f32 v83, v54, v55
    v_exp_f32 v58, v58
    v_exp_f32 v59, v59
    v_cvt_pk_bf16_f32 v84, v56, v57
    v_exp_f32 v60, v60
    v_mfma_f32_32x32x16_bf16 a[240:255], a[164:167], v[92:95], a[240:255]
    v_exp_f32 v61, v61
    v_cvt_pk_bf16_f32 v85, v58, v59
    v_exp_f32 v62, v62
    v_exp_f32 v63, v63
    v_cvt_pk_bf16_f32 v86, v60, v61
    v_cvt_pk_bf16_f32 v87, v62, v63
    v_mfma_f32_32x32x4_2b_bf16 v[16:47], a[84:85], v[104:105], v[16:47]
    v_exp_f32 v64, v64
    v_exp_f32 v65, v65
    v_exp_f32 v66, v66
    v_exp_f32 v67, v67
    v_cvt_pk_bf16_f32 v88, v64, v65
    v_exp_f32 v68, v68
    v_exp_f32 v69, v69
    v_cvt_pk_bf16_f32 v89, v66, v67
    v_exp_f32 v70, v70
    v_exp_f32 v71, v71
    v_mfma_f32_32x32x16_bf16 a[224:239], a[168:171], v[80:83], a[224:239]
    v_cvt_pk_bf16_f32 v90, v68, v69
    v_exp_f32 v72, v72
    v_exp_f32 v73, v73
    v_cvt_pk_bf16_f32 v91, v70, v71
    v_exp_f32 v74, v74
    v_exp_f32 v75, v75
    v_cvt_pk_bf16_f32 v92, v72, v73
    v_mfma_f32_32x32x16_bf16 a[224:239], a[172:175], v[84:87], a[224:239]
    v_exp_f32 v76, v76
    v_exp_f32 v77, v77
    v_cvt_pk_bf16_f32 v93, v74, v75
    v_exp_f32 v78, v78
    v_exp_f32 v79, v79
    v_cvt_pk_bf16_f32 v94, v76, v77
    v_cvt_pk_bf16_f32 v95, v78, v79
    s_waitcnt vmcnt(14)
    v_mfma_f32_32x32x16_bf16 v[48:63], a[44:47], v[96:99], 0
    v_exp_f32 v16, v16
    v_exp_f32 v17, v17
    v_exp_f32 v18, v18
    v_exp_f32 v19, v19
    v_cvt_pk_bf16_f32 v80, v16, v17
    v_exp_f32 v20, v20
    v_mfma_f32_32x32x16_bf16 a[240:255], a[168:171], v[88:91], a[240:255]
    v_exp_f32 v21, v21
    v_cvt_pk_bf16_f32 v81, v18, v19
    v_exp_f32 v22, v22
    v_exp_f32 v23, v23
    v_cvt_pk_bf16_f32 v82, v20, v21
    v_exp_f32 v24, v24
    v_mfma_f32_32x32x16_bf16 v[64:79], a[44:47], v[100:103], 0
    v_exp_f32 v25, v25
    v_cvt_pk_bf16_f32 v83, v22, v23
    v_exp_f32 v26, v26
    v_exp_f32 v27, v27
    v_cvt_pk_bf16_f32 v84, v24, v25
    v_exp_f32 v28, v28
    v_mfma_f32_32x32x16_bf16 a[240:255], a[172:175], v[92:95], a[240:255]
    v_exp_f32 v29, v29
    v_cvt_pk_bf16_f32 v85, v26, v27
    v_exp_f32 v30, v30
    v_exp_f32 v31, v31
    v_cvt_pk_bf16_f32 v86, v28, v29
    v_cvt_pk_bf16_f32 v87, v30, v31
    v_mfma_f32_32x32x4_2b_bf16 v[48:79], a[86:87], v[104:105], v[48:79]
    v_exp_f32 v32, v32
    v_exp_f32 v33, v33
    v_exp_f32 v34, v34
    v_exp_f32 v35, v35
    v_cvt_pk_bf16_f32 v88, v32, v33
    v_exp_f32 v36, v36
    v_exp_f32 v37, v37
    v_cvt_pk_bf16_f32 v89, v34, v35
    v_exp_f32 v38, v38
    v_exp_f32 v39, v39
    v_mfma_f32_32x32x16_bf16 a[224:239], a[176:179], v[80:83], a[224:239]
    v_cvt_pk_bf16_f32 v90, v36, v37
    v_exp_f32 v40, v40
    v_exp_f32 v41, v41
    v_cvt_pk_bf16_f32 v91, v38, v39
    v_exp_f32 v42, v42
    v_exp_f32 v43, v43
    v_cvt_pk_bf16_f32 v92, v40, v41
    v_mfma_f32_32x32x16_bf16 a[224:239], a[180:183], v[84:87], a[224:239]
    v_exp_f32 v44, v44
    v_exp_f32 v45, v45
    v_cvt_pk_bf16_f32 v93, v42, v43
    v_exp_f32 v46, v46
    v_exp_f32 v47, v47
    v_cvt_pk_bf16_f32 v94, v44, v45
    v_cvt_pk_bf16_f32 v95, v46, v47
    s_cmp_eq_u32 s7, 0
    s_cbranch_scc1 L_hook10
L_hook10_ret:
    s_waitcnt vmcnt(10)
    v_mfma_f32_32x32x16_bf16 v[16:31], a[48:51], v[96:99], 0
    v_exp_f32 v48, v48
    v_exp_f32 v49, v49
    v_exp_f32 v50, v50
    v_exp_f32 v51, v51
    v_cvt_pk_bf16_f32 v80, v48, v49
    v_exp_f32 v52, v52
    v_mfma_f32_32x32x16_bf16 a[240:255], a[176:179], v[88:91], a[240:255]
    v_exp_f32 v53, v53
    v_cvt_pk_bf16_f32 v81, v50, v51
    v_exp_f32 v54, v54
    v_exp_f32 v55, v55
    v_cvt_pk_bf16_f32 v82, v52, v53
    v_exp_f32 v56, v56
    v_mfma_f32_32x32x16_bf16 v[32:47], a[48:51], v[100:103], 0
    v_exp_f32 v57, v57
    v_cvt_pk_bf16_f32 v83, v54, v55
    v_exp_f32 v58, v58
    v_exp_f32 v59, v59
    v_cvt_pk_bf16_f32 v84, v56, v57
    v_exp_f32 v60, v60
    v_mfma_f32_32x32x16_bf16 a[240:255], a[180:183], v[92:95], a[240:255]
    v_exp_f32 v61, v61
    v_cvt_pk_bf16_f32 v85, v58, v59
    v_exp_f32 v62, v62
    v_exp_f32 v63, v63
    v_cvt_pk_bf16_f32 v86, v60, v61
    v_cvt_pk_bf16_f32 v87, v62, v63
    v_mfma_f32_32x32x4_2b_bf16 v[16:47], a[88:89], v[104:105], v[16:47]
    v_exp_f32 v64, v64
    v_exp_f32 v65, v65
    v_exp_f32 v66, v66
    v_exp_f32 v67, v67
    v_cvt_pk_bf16_f32 v88, v64, v65
    v_exp_f32 v68, v68
    v_exp_f32 v69, v69
    v_cvt_pk_bf16_f32 v89, v66, v67
    v_exp_f32 v70, v70
    v_exp_f32 v71, v71
    v_mfma_f32_32x32x16_bf16 a[224:239], a[184:187], v[80:83], a[224:239]
    v_cvt_pk_bf16_f32 v90, v68, v69
    v_exp_f32 v72, v72
    v_exp_f32 v73, v73
    v_cvt_pk_bf16_f32 v91, v70, v71
    v_exp_f32 v74, v74
    v_exp_f32 v75, v75
    v_cvt_pk_bf16_f32 v92, v72, v73
    v_mfma_f32_32x32x16_bf16 a[224:239], a[188:191], v[84:87], a[224:239]
    v_exp_f32 v76, v76
    v_exp_f32 v77, v77
    v_cvt_pk_bf16_f32 v93, v74, v75
    v_exp_f32 v78, v78
    v_exp_f32 v79, v79
    v_cvt_pk_bf16_f32 v94, v76, v77
    v_cvt_pk_bf16_f32 v95, v78, v79
    s_waitcnt vmcnt(7)
    v_mfma_f32_32x32x16_bf16 v[48:63], a[52:55], v[96:99], 0
    v_exp_f32 v16, v16
    v_exp_f32 v17, v17
    v_exp_f32 v18, v18
    v_exp_f32 v19, v19
    v_cvt_pk_bf16_f32 v80, v16, v17
    v_exp_f32 v20, v20
    v_mfma_f32_32x32x16_bf16 a[240:255], a[184:187], v[88:91], a[240:255]
    v_exp_f32 v21, v21
    v_cvt_pk_bf16_f32 v81, v18, v19
    v_exp_f32 v22, v22
    v_exp_f32 v23, v23
    v_cvt_pk_bf16_f32 v82, v20, v21
    v_exp_f32 v24, v24
    v_mfma_f32_32x32x16_bf16 v[64:79], a[52:55], v[100:103], 0
    v_exp_f32 v25, v25
    v_cvt_pk_bf16_f32 v83, v22, v23
    v_exp_f32 v26, v26
    v_exp_f32 v27, v27
    v_cvt_pk_bf16_f32 v84, v24, v25
    v_exp_f32 v28, v28
    v_mfma_f32_32x32x16_bf16 a[240:255], a[188:191], v[92:95], a[240:255]
    v_exp_f32 v29, v29
    v_cvt_pk_bf16_f32 v85, v26, v27
    v_exp_f32 v30, v30
    v_exp_f32 v31, v31
    v_cvt_pk_bf16_f32 v86, v28, v29
    v_cvt_pk_bf16_f32 v87, v30, v31
    v_mfma_f32_32x32x4_2b_bf16 v[48:79], a[90:91], v[104:105], v[48:79]
    v_exp_f32 v32, v32
    v_exp_f32 v33, v33
    v_exp_f32 v34, v34
    v_exp_f32 v35, v35
    v_cvt_pk_bf16_f32 v88, v32, v33
    v_exp_f32 v36, v36
    v_exp_f32 v37, v37
    v_cvt_pk_bf16_f32 v89, v34, v35
    v_exp_f32 v38, v38
    v_exp_f32 v39, v39
    v_mfma_f32_32x32x16_bf16 a[224:239], a[192:195], v[80:83], a[224:239]
    v_cvt_pk_bf16_f32 v90, v36, v37
    v_exp_f32 v40, v40
    v_exp_f32 v41, v41
    v_cvt_pk_bf16_f32 v91, v38, v39
    v_exp_f32 v42, v42
    v_exp_f32 v43, v43
    v_cvt_pk_bf16_f32 v92, v40, v41
    v_mfma_f32_32x32x16_bf16 a[224:239], a[196:199], v[84:87], a[224:239]
    v_exp_f32 v44, v44
    v_exp_f32 v45, v45
    v_cvt_pk_bf16_f32 v93, v42, v43
    v_exp_f32 v46, v46
    v_exp_f32 v47, v47
    v_cvt_pk_bf16_f32 v94, v44, v45
    v_cvt_pk_bf16_f32 v95, v46, v47
    s_waitcnt vmcnt(3)
    v_mfma_f32_32x32x16_bf16 v[16:31], a[56:59], v[96:99], 0
    v_exp_f32 v48, v48
    v_exp_f32 v49, v49
    v_exp_f32 v50, v50
    v_exp_f32 v51, v51
    v_cvt_pk_bf16_f32 v80, v48, v49
    v_exp_f32 v52, v52
    v_mfma_f32_32x32x16_bf16 a[240:255], a[192:195], v[88:91], a[240:255]
    v_exp_f32 v53, v53
    v_cvt_pk_bf16_f32 v81, v50, v51
    v_exp_f32 v54, v54
    v_exp_f32 v55, v55
    v_cvt_pk_bf16_f32 v82, v52, v53
    v_exp_f32 v56, v56
    v_mfma_f32_32x32x16_bf16 v[32:47], a[56:59], v[100:103], 0
    v_exp_f32 v57, v57
    v_cvt_pk_bf16_f32 v83, v54, v55
    v_exp_f32 v58, v58
    v_exp_f32 v59, v59
    v_cvt_pk_bf16_f32 v84, v56, v57
    v_exp_f32 v60, v60
    v_mfma_f32_32x32x16_bf16 a[240:255], a[196:199], v[92:95], a[240:255]
    v_exp_f32 v61, v61
    v_cvt_pk_bf16_f32 v85, v58, v59
    v_exp_f32 v62, v62
    v_exp_f32 v63, v63
    v_cvt_pk_bf16_f32 v86, v60, v61
    v_cvt_pk_bf16_f32 v87, v62, v63
    v_mfma_f32_32x32x4_2b_bf16 v[16:47], a[92:93], v[104:105], v[16:47]
    v_exp_f32 v64, v64
    v_exp_f32 v65, v65
    v_exp_f32 v66, v66
    v_exp_f32 v67, v67
    v_cvt_pk_bf16_f32 v88, v64, v65
    v_exp_f32 v68, v68
    v_exp_f32 v69, v69
    v_cvt_pk_bf16_f32 v89, v66, v67
    v_exp_f32 v70, v70
    v_exp_f32 v71, v71
    v_mfma_f32_32x32x16_bf16 a[224:239], a[200:203], v[80:83], a[224:239]
    v_cvt_pk_bf16_f32 v90, v68, v69
    v_exp_f32 v72, v72
    v_exp_f32 v73, v73
    v_cvt_pk_bf16_f32 v91, v70, v71
    v_exp_f32 v74, v74
    v_exp_f32 v75, v75
    v_cvt_pk_bf16_f32 v92, v72, v73
    v_mfma_f32_32x32x16_bf16 a[224:239], a[204:207], v[84:87], a[224:239]
    v_exp_f32 v76, v76
    v_exp_f32 v77, v77
    v_cvt_pk_bf16_f32 v93, v74, v75
    v_exp_f32 v78, v78
    v_exp_f32 v79, v79
    v_cvt_pk_bf16_f32 v94, v76, v77
    v_cvt_pk_bf16_f32 v95, v78, v79
    s_waitcnt vmcnt(0)
    s_barrier
    s_cmp_eq_u32 s3, 0
    s_cbranch_scc1 L_hook28
L_hookret28:
    s_waitcnt vmcnt(0)
    v_mfma_f32_32x32x16_bf16 v[48:63], a[60:63], v[96:99], 0
    v_exp_f32 v16, v16
    v_exp_f32 v17, v17
    v_exp_f32 v18, v18
    v_exp_f32 v19, v19
    v_cvt_pk_bf16_f32 v80, v16, v17
    v_exp_f32 v20, v20
    v_mfma_f32_32x32x16_bf16 a[240:255], a[200:203], v[88:91], a[240:255]
    v_exp_f32 v21, v21
    v_cvt_pk_bf16_f32 v81, v18, v19
    v_exp_f32 v22, v22
    v_exp_f32 v23, v23
    v_cvt_pk_bf16_f32 v82, v20, v21
    v_exp_f32 v24, v24
    v_mfma_f32_32x32x16_bf16 v[64:79], a[60:63], v[100:103], 0
    v_exp_f32 v25, v25
    v_cvt_pk_bf16_f32 v83, v22, v23
    v_exp_f32 v26, v26
    v_exp_f32 v27, v27
    v_cvt_pk_bf16_f32 v84, v24, v25
    v_exp_f32 v28, v28
    v_mfma_f32_32x32x16_bf16 a[240:255], a[204:207], v[92:95], a[240:255]
    v_exp_f32 v29, v29
    v_cvt_pk_bf16_f32 v85, v26, v27
    v_exp_f32 v30, v30
    v_exp_f32 v31, v31
    v_cvt_pk_bf16_f32 v86, v28, v29
    v_cvt_pk_bf16_f32 v87, v30, v31
    v_mfma_f32_32x32x4_2b_bf16 v[48:79], a[94:95], v[104:105], v[48:79]
    v_exp_f32 v32, v32
    v_exp_f32 v33, v33
    v_exp_f32 v34, v34
    v_exp_f32 v35, v35
    v_cvt_pk_bf16_f32 v88, v32, v33
    v_exp_f32 v36, v36
    v_exp_f32 v37, v37
    v_cvt_pk_bf16_f32 v89, v34, v35
    v_exp_f32 v38, v38
    v_exp_f32 v39, v39
    v_mfma_f32_32x32x16_bf16 a[224:239], a[208:211], v[80:83], a[224:239]
    v_cvt_pk_bf16_f32 v90, v36, v37
    v_exp_f32 v40, v40
    v_exp_f32 v41, v41
    v_cvt_pk_bf16_f32 v91, v38, v39
    v_exp_f32 v42, v42
    v_exp_f32 v43, v43
    v_cvt_pk_bf16_f32 v92, v40, v41
    v_mfma_f32_32x32x16_bf16 a[224:239], a[212:215], v[84:87], a[224:239]
    v_exp_f32 v44, v44
    v_exp_f32 v45, v45
    v_cvt_pk_bf16_f32 v93, v42, v43
    v_exp_f32 v46, v46
    v_exp_f32 v47, v47
    v_cvt_pk_bf16_f32 v94, v44, v45
    v_cvt_pk_bf16_f32 v95, v46, v47
    s_bitcmp1_b32 s24, 1
    s_cbranch_scc1 L_dh
L_dh_ret:
    s_waitcnt lgkmcnt(0)
    v_mfma_f32_32x32x16_bf16 v[16:31], a[0:3], v[106:109], 0
    v_exp_f32 v48, v48
    v_exp_f32 v49, v49
    v_exp_f32 v50, v50
    v_exp_f32 v51, v51
    v_cvt_pk_bf16_f32 v80, v48, v49
    v_exp_f32 v52, v52
    v_mfma_f32_32x32x16_bf16 a[240:255], a[208:211], v[88:91], a[240:255]
    v_exp_f32 v53, v53
    v_cvt_pk_bf16_f32 v81, v50, v51
    v_exp_f32 v54, v54
    v_exp_f32 v55, v55
    v_cvt_pk_bf16_f32 v82, v52, v53
    v_exp_f32 v56, v56
    v_mfma_f32_32x32x16_bf16 v[32:47], a[0:3], v[110:113], 0
    v_exp_f32 v57, v57
    v_cvt_pk_bf16_f32 v83, v54, v55
    v_exp_f32 v58, v58
    v_exp_f32 v59, v59
    v_cvt_pk_bf16_f32 v84, v56, v57
    v_exp_f32 v60, v60
    v_mfma_f32_32x32x16_bf16 a[240:255], a[212:215], v[92:95], a[240:255]
    v_exp_f32 v61, v61
    v_cvt_pk_bf16_f32 v85, v58, v59
    v_exp_f32 v62, v62
    v_exp_f32 v63, v63
    v_cvt_pk_bf16_f32 v86, v60, v61
    v_cvt_pk_bf16_f32 v87, v62, v63
    v_mfma_f32_32x32x4_2b_bf16 v[16:47], a[64:65], v[114:115], v[16:47]
    v_exp_f32 v64, v64
    v_exp_f32 v65, v65
    v_exp_f32 v66, v66
    v_exp_f32 v67, v67
    v_cvt_pk_bf16_f32 v88, v64, v65
    v_exp_f32 v68, v68
    v_exp_f32 v69, v69
    v_cvt_pk_bf16_f32 v89, v66, v67
    v_exp_f32 v70, v70
    v_exp_f32 v71, v71
    v_mfma_f32_32x32x16_bf16 a[224:239], a[216:219], v[80:83], a[224:239]
    v_cvt_pk_bf16_f32 v90, v68, v69
    v_exp_f32 v72, v72
    v_exp_f32 v73, v73
    v_cvt_pk_bf16_f32 v91, v70, v71
    v_exp_f32 v74, v74
    v_exp_f32 v75, v75
    v_cvt_pk_bf16_f32 v92, v72, v73
    v_mfma_f32_32x32x16_bf16 a[224:239], a[220:223], v[84:87], a[224:239]
    v_exp_f32 v76, v76
    v_exp_f32 v77, v77
    v_cvt_pk_bf16_f32 v93, v74, v75
    v_exp_f32 v78, v78
    v_exp_f32 v79, v79
    v_cvt_pk_bf16_f32 v94, v76, v77
    v_cvt_pk_bf16_f32 v95, v78, v79
    v_mfma_f32_32x32x16_bf16 v[48:63], a[4:7], v[106:109], 0
    v_exp_f32 v16, v16
    v_exp_f32 v17, v17
    v_exp_f32 v18, v18
    v_exp_f32 v19, v19
    v_cvt_pk_bf16_f32 v80, v16, v17
    v_exp_f32 v20, v20
    v_mfma_f32_32x32x16_bf16 a[240:255], a[216:219], v[88:91], a[240:255]
    v_exp_f32 v21, v21
    v_cvt_pk_bf16_f32 v81, v18, v19
    v_exp_f32 v22, v22
    v_exp_f32 v23, v23
    v_cvt_pk_bf16_f32 v82, v20, v21
    v_exp_f32 v24, v24
    ds_write_b128 v14, a[224:227] offset:0
    ds_write_b128 v14, a[228:231] offset:1024
    ds_write_b128 v14, a[232:235] offset:2048
    v_mfma_f32_32x32x16_bf16 v[64:79], a[4:7], v[110:113], 0
    v_exp_f32 v25, v25
    v_cvt_pk_bf16_f32 v83, v22, v23
    v_exp_f32 v26, v26
    v_exp_f32 v27, v27
    v_cvt_pk_bf16_f32 v84, v24, v25
    v_exp_f32 v28, v28
    v_mfma_f32_32x32x16_bf16 a[240:255], a[220:223], v[92:95], a[240:255]
    v_exp_f32 v29, v29
    v_cvt_pk_bf16_f32 v85, v26, v27
    v_exp_f32 v30, v30
    v_exp_f32 v31, v31
    v_cvt_pk_bf16_f32 v86, v28, v29
    v_cvt_pk_bf16_f32 v87, v30, v31
    v_mfma_f32_32x32x4_2b_bf16 v[48:79], a[66:67], v[114:115], v[48:79]
    v_exp_f32 v32, v32
    v_exp_f32 v33, v33
    v_exp_f32 v34, v34
    v_exp_f32 v35, v35
    v_cvt_pk_bf16_f32 v88, v32, v33
    v_exp_f32 v36, v36
    v_exp_f32 v37, v37
    v_cvt_pk_bf16_f32 v89, v34, v35
    v_exp_f32 v38, v38
    v_exp_f32 v39, v39
    v_mfma_f32_32x32x16_bf16 a[224:239], a[96:99], v[80:83], 0
    v_cvt_pk_bf16_f32 v90, v36, v37
    v_exp_f32 v40, v40
    v_exp_f32 v41, v41
    v_cvt_pk_bf16_f32 v91, v38, v39
    v_exp_f32 v42, v42
    v_exp_f32 v43, v43
    v_cvt_pk_bf16_f32 v92, v40, v41
    v_mfma_f32_32x32x16_bf16 a[224:239], a[100:103], v[84:87], a[224:239]
    v_exp_f32 v44, v44
    v_exp_f32 v45, v45
    v_cvt_pk_bf16_f32 v93, v42, v43
    v_exp_f32 v46, v46
    v_exp_f32 v47, v47
    v_cvt_pk_bf16_f32 v94, v44, v45
    v_cvt_pk_bf16_f32 v95, v46, v47
    ds_write_b128 v14, a[240:243] offset:3072
    ds_write_b128 v14, a[244:247] offset:4096
    ds_write_b128 v14, a[248:251] offset:5120
    v_mfma_f32_32x32x16_bf16 v[16:31], a[8:11], v[106:109], 0
    v_exp_f32 v48, v48
    v_exp_f32 v49, v49
    v_exp_f32 v50, v50
    v_exp_f32 v51, v51
    v_cvt_pk_bf16_f32 v80, v48, v49
    v_exp_f32 v52, v52
    v_mfma_f32_32x32x16_bf16 a[240:255], a[96:99], v[88:91], 0
    v_exp_f32 v53, v53
    v_cvt_pk_bf16_f32 v81, v50, v51
    v_exp_f32 v54, v54
    v_exp_f32 v55, v55
    v_cvt_pk_bf16_f32 v82, v52, v53
    v_exp_f32 v56, v56
    v_mfma_f32_32x32x16_bf16 v[32:47], a[8:11], v[110:113], 0
    v_exp_f32 v57, v57
    v_cvt_pk_bf16_f32 v83, v54, v55
    v_exp_f32 v58, v58
    v_exp_f32 v59, v59
    v_cvt_pk_bf16_f32 v84, v56, v57
    v_exp_f32 v60, v60
    v_mfma_f32_32x32x16_bf16 a[240:255], a[100:103], v[92:95], a[240:255]
    v_exp_f32 v61, v61
    v_cvt_pk_bf16_f32 v85, v58, v59
    v_exp_f32 v62, v62
    v_exp_f32 v63, v63
    v_cvt_pk_bf16_f32 v86, v60, v61
    v_cvt_pk_bf16_f32 v87, v62, v63
    v_mfma_f32_32x32x4_2b_bf16 v[16:47], a[68:69], v[114:115], v[16:47]
    v_exp_f32 v64, v64
    v_exp_f32 v65, v65
    v_exp_f32 v66, v66
    v_exp_f32 v67, v67
    v_cvt_pk_bf16_f32 v88, v64, v65
    v_exp_f32 v68, v68
    v_exp_f32 v69, v69
    v_cvt_pk_bf16_f32 v89, v66, v67
    v_exp_f32 v70, v70
    v_exp_f32 v71, v71
    v_mfma_f32_32x32x16_bf16 a[224:239], a[104:107], v[80:83], a[224:239]
    v_cvt_pk_bf16_f32 v90, v68, v69
    v_exp_f32 v72, v72
    v_exp_f32 v73, v73
    v_cvt_pk_bf16_f32 v91, v70, v71
    v_exp_f32 v74, v74
    v_exp_f32 v75, v75
    v_cvt_pk_bf16_f32 v92, v72, v73
    v_mfma_f32_32x32x16_bf16 a[224:239], a[108:111], v[84:87], a[224:239]
    v_exp_f32 v76, v76
    v_exp_f32 v77, v77
    v_cvt_pk_bf16_f32 v93, v74, v75
    v_exp_f32 v78, v78
    v_exp_f32 v79, v79
    v_cvt_pk_bf16_f32 v94, v76, v77
    v_cvt_pk_bf16_f32 v95, v78, v79
    v_mfma_f32_32x32x16_bf16 v[48:63], a[12:15], v[106:109], 0
    v_exp_f32 v16, v16
    v_exp_f32 v17, v17
    v_exp_f32 v18, v18
    v_exp_f32 v19, v19
    v_cvt_pk_bf16_f32 v80, v16, v17
    v_exp_f32 v20, v20
    v_mfma_f32_32x32x16_bf16 a[240:255], a[104:107], v[88:91], a[240:255]
    v_exp_f32 v21, v21
    v_cvt_pk_bf16_f32 v81, v18, v19
    v_exp_f32 v22, v22
    v_exp_f32 v23, v23
    v_cvt_pk_bf16_f32 v82, v20, v21
    v_exp_f32 v24, v24
    v_mfma_f32_32x32x16_bf16 v[64:79], a[12:15], v[110:113], 0
    v_exp_f32 v25, v25
    v_cvt_pk_bf16_f32 v83, v22, v23
    v_exp_f32 v26, v26
    v_exp_f32 v27, v27
    v_cvt_pk_bf16_f32 v84, v24, v25
    v_exp_f32 v28, v28
    v_mfma_f32_32x32x16_bf16 a[240:255], a[108:111], v[92:95], a[240:255]
    v_exp_f32 v29, v29
    v_cvt_pk_bf16_f32 v85, v26, v27
    v_exp_f32 v30, v30
    v_exp_f32 v31, v31
    v_cvt_pk_bf16_f32 v86, v28, v29
    v_cvt_pk_bf16_f32 v87, v30, v31
    v_mfma_f32_32x32x4_2b_bf16 v[48:79], a[70:71], v[114:115], v[48:79]
    v_exp_f32 v32, v32
    v_exp_f32 v33, v33
    v_exp_f32 v34, v34
    v_exp_f32 v35, v35
    v_cvt_pk_bf16_f32 v88, v32, v33
    v_exp_f32 v36, v36
    v_exp_f32 v37, v37
    v_cvt_pk_bf16_f32 v89, v34, v35
    v_exp_f32 v38, v38
    v_exp_f32 v39, v39
    v_mfma_f32_32x32x16_bf16 a[224:239], a[112:115], v[80:83], a[224:239]
    v_cvt_pk_bf16_f32 v90, v36, v37
    v_exp_f32 v40, v40
    v_exp_f32 v41, v41
    v_cvt_pk_bf16_f32 v91, v38, v39
    v_exp_f32 v42, v42
    v_exp_f32 v43, v43
    v_cvt_pk_bf16_f32 v92, v40, v41
    v_mfma_f32_32x32x16_bf16 a[224:239], a[116:119], v[84:87], a[224:239]
    v_exp_f32 v44, v44
    v_exp_f32 v45, v45
    v_cvt_pk_bf16_f32 v93, v42, v43
    v_exp_f32 v46, v46
    v_exp_f32 v47, v47
    v_cvt_pk_bf16_f32 v94, v44, v45
    v_cvt_pk_bf16_f32 v95, v46, v47
    s_bitcmp1_b32 s24, 1
    s_cbranch_scc1 L_d2
L_d2_ret:
    v_mfma_f32_32x32x16_bf16 v[16:31], a[16:19], v[106:109], 0
    v_exp_f32 v48, v48
    v_exp_f32 v49, v49
    v_exp_f32 v50, v50
    v_exp_f32 v51, v51
    v_cvt_pk_bf16_f32 v80, v48, v49
    v_exp_f32 v52, v52
    v_mfma_f32_32x32x16_bf16 a[240:255], a[112:115], v[88:91], a[240:255]
    v_exp_f32 v53, v53
    v_cvt_pk_bf16_f32 v81, v50, v51
    v_exp_f32 v54, v54
    v_exp_f32 v55, v55
    v_cvt_pk_bf16_f32 v82, v52, v53
    v_exp_f32 v56, v56
    v_mfma_f32_32x32x16_bf16 v[32:47], a[16:19], v[110:113], 0
    v_exp_f32 v57, v57
    v_cvt_pk_bf16_f32 v83, v54, v55
    v_exp_f32 v58, v58
    v_exp_f32 v59, v59
    v_cvt_pk_bf16_f32 v84, v56, v57
    v_exp_f32 v60, v60
    v_mfma_f32_32x32x16_bf16 a[240:255], a[116:119], v[92:95], a[240:255]
    v_exp_f32 v61, v61
    v_cvt_pk_bf16_f32 v85, v58, v59
    v_exp_f32 v62, v62
    v_exp_f32 v63, v63
    v_cvt_pk_bf16_f32 v86, v60, v61
    v_cvt_pk_bf16_f32 v87, v62, v63
    v_mfma_f32_32x32x4_2b_bf16 v[16:47], a[72:73], v[114:115], v[16:47]
    v_exp_f32 v64, v64
    v_exp_f32 v65, v65
    v_exp_f32 v66, v66
    v_exp_f32 v67, v67
    v_cvt_pk_bf16_f32 v88, v64, v65
    v_exp_f32 v68, v68
    v_exp_f32 v69, v69
    v_cvt_pk_bf16_f32 v89, v66, v67
    v_exp_f32 v70, v70
    v_exp_f32 v71, v71
    v_mfma_f32_32x32x16_bf16 a[224:239], a[120:123], v[80:83], a[224:239]
    v_cvt_pk_bf16_f32 v90, v68, v69
    v_exp_f32 v72, v72
    v_exp_f32 v73, v73
    v_cvt_pk_bf16_f32 v91, v70, v71
    v_exp_f32 v74, v74
    v_exp_f32 v75, v75
    v_cvt_pk_bf16_f32 v92, v72, v73
    v_mfma_f32_32x32x16_bf16 a[224:239], a[124:127], v[84:87], a[224:239]
    v_exp_f32 v76, v76
    v_exp_f32 v77, v77
    v_cvt_pk_bf16_f32 v93, v74, v75
    v_exp_f32 v78, v78
    v_exp_f32 v79, v79
    v_cvt_pk_bf16_f32 v94, v76, v77
    v_cvt_pk_bf16_f32 v95, v78, v79
    v_lshlrev_b32 v5, 6, v1
    s_add_u32 s52, s66, 32768
    s_add_u32 s53, s66, 36864
    s_add_u32 s54, s66, 40960
    s_add_u32 s55, s66, 45056
    buffer_load_dword v8, v5, s[8:11], s52 offen sc1
    buffer_load_dword v9, v5, s[8:11], s53 offen sc1
    buffer_load_dword v10, v5, s[8:11], s54 offen sc1
    buffer_load_dword v11, v5, s[8:11], s55 offen sc1
    v_mfma_f32_32x32x16_bf16 v[48:63], a[20:23], v[106:109], 0
    v_exp_f32 v16, v16
    v_exp_f32 v17, v17
    v_exp_f32 v18, v18
    v_exp_f32 v19, v19
    v_cvt_pk_bf16_f32 v80, v16, v17
    v_exp_f32 v20, v20
    v_mfma_f32_32x32x16_bf16 a[240:255], a[120:123], v[88:91], a[240:255]
    v_exp_f32 v21, v21
    v_cvt_pk_bf16_f32 v81, v18, v19
    v_exp_f32 v22, v22
    v_exp_f32 v23, v23
    v_cvt_pk_bf16_f32 v82, v20, v21
    v_exp_f32 v24, v24
    v_mfma_f32_32x32x16_bf16 v[64:79], a[20:23], v[110:113], 0
    v_exp_f32 v25, v25
    v_cvt_pk_bf16_f32 v83, v22, v23
    v_exp_f32 v26, v26
    v_exp_f32 v27, v27
    v_cvt_pk_bf16_f32 v84, v24, v25
    v_exp_f32 v28, v28
    v_mfma_f32_32x32x16_bf16 a[240:255], a[124:127], v[92:95], a[240:255]
    v_exp_f32 v29, v29
    v_cvt_pk_bf16_f32 v85, v26, v27
    v_exp_f32 v30, v30
    v_exp_f32 v31, v31
    v_cvt_pk_bf16_f32 v86, v28, v29
    v_cvt_pk_bf16_f32 v87, v30, v31
    v_mfma_f32_32x32x4_2b_bf16 v[48:79], a[74:75], v[114:115], v[48:79]
    v_exp_f32 v32, v32
    v_exp_f32 v33, v33
    v_exp_f32 v34, v34
    v_exp_f32 v35, v35
    v_cvt_pk_bf16_f32 v88, v32, v33
    v_exp_f32 v36, v36
    v_exp_f32 v37, v37
    v_cvt_pk_bf16_f32 v89, v34, v35
    v_exp_f32 v38, v38
    v_exp_f32 v39, v39
    v_mfma_f32_32x32x16_bf16 a[224:239], a[128:131], v[80:83], a[224:239]
    v_cvt_pk_bf16_f32 v90, v36, v37
    v_exp_f32 v40, v40
    v_exp_f32 v41, v41
    v_cvt_pk_bf16_f32 v91, v38, v39
    v_exp_f32 v42, v42
    v_exp_f32 v43, v43
    v_cvt_pk_bf16_f32 v92, v40, v41
    v_mfma_f32_32x32x16_bf16 a[224:239], a[132:135], v[84:87], a[224:239]
    v_exp_f32 v44, v44
    v_exp_f32 v45, v45
    v_cvt_pk_bf16_f32 v93, v42, v43
    v_exp_f32 v46, v46
    v_exp_f32 v47, v47
    v_cvt_pk_bf16_f32 v94, v44, v45
    v_cvt_pk_bf16_f32 v95, v46, v47
    v_mfma_f32_32x32x16_bf16 v[16:31], a[24:27], v[106:109], 0
    v_exp_f32 v48, v48
    v_exp_f32 v49, v49
    v_exp_f32 v50, v50
    v_exp_f32 v51, v51
    v_cvt_pk_bf16_f32 v80, v48, v49
    v_exp_f32 v52, v52
    v_mfma_f32_32x32x16_bf16 a[240:255], a[128:131], v[88:91], a[240:255]
    v_exp_f32 v53, v53
    v_cvt_pk_bf16_f32 v81, v50, v51
    v_exp_f32 v54, v54
    v_exp_f32 v55, v55
    v_cvt_pk_bf16_f32 v82, v52, v53
    v_exp_f32 v56, v56
    v_mfma_f32_32x32x16_bf16 v[32:47], a[24:27], v[110:113], 0
    v_exp_f32 v57, v57
    v_cvt_pk_bf16_f32 v83, v54, v55
    v_exp_f32 v58, v58
    v_exp_f32 v59, v59
    v_cvt_pk_bf16_f32 v84, v56, v57
    v_exp_f32 v60, v60
    v_mfma_f32_32x32x16_bf16 a[240:255], a[132:135], v[92:95], a[240:255]
    v_exp_f32 v61, v61
    v_cvt_pk_bf16_f32 v85, v58, v59
    v_exp_f32 v62, v62
    v_exp_f32 v63, v63
    v_cvt_pk_bf16_f32 v86, v60, v61
    v_cvt_pk_bf16_f32 v87, v62, v63
    v_mfma_f32_32x32x4_2b_bf16 v[16:47], a[76:77], v[114:115], v[16:47]
    v_exp_f32 v64, v64
    v_exp_f32 v65, v65
    v_exp_f32 v66, v66
    v_exp_f32 v67, v67
    v_cvt_pk_bf16_f32 v88, v64, v65
    v_exp_f32 v68, v68
    v_exp_f32 v69, v69
    v_cvt_pk_bf16_f32 v89, v66, v67
    v_exp_f32 v70, v70
    v_exp_f32 v71, v71
    v_mfma_f32_32x32x16_bf16 a[224:239], a[136:139], v[80:83], a[224:239]
    v_cvt_pk_bf16_f32 v90, v68, v69
    v_exp_f32 v72, v72
    v_exp_f32 v73, v73
    v_cvt_pk_bf16_f32 v91, v70, v71
    v_exp_f32 v74, v74
    v_exp_f32 v75, v75
    v_cvt_pk_bf16_f32 v92, v72, v73
    v_mfma_f32_32x32x16_bf16 a[224:239], a[140:143], v[84:87], a[224:239]
    v_exp_f32 v76, v76
    v_exp_f32 v77, v77
    v_cvt_pk_bf16_f32 v93, v74, v75
    v_exp_f32 v78, v78
    v_exp_f32 v79, v79
    v_cvt_pk_bf16_f32 v94, v76, v77
    v_cvt_pk_bf16_f32 v95, v78, v79
    v_mfma_f32_32x32x16_bf16 v[48:63], a[28:31], v[106:109], 0
    v_exp_f32 v16, v16
    v_exp_f32 v17, v17
    v_exp_f32 v18, v18
    v_exp_f32 v19, v19
    v_cvt_pk_bf16_f32 v80, v16, v17
    v_exp_f32 v20, v20
    v_mfma_f32_32x32x16_bf16 a[240:255], a[136:139], v[88:91], a[240:255]
    v_exp_f32 v21, v21
    v_cvt_pk_bf16_f32 v81, v18, v19
    v_exp_f32 v22, v22
    v_exp_f32 v23, v23
    v_cvt_pk_bf16_f32 v82, v20, v21
    v_exp_f32 v24, v24
    v_mfma_f32_32x32x16_bf16 v[64:79], a[28:31], v[110:113], 0
    v_exp_f32 v25, v25
    v_cvt_pk_bf16_f32 v83, v22, v23
    v_exp_f32 v26, v26
    v_exp_f32 v27, v27
    v_cvt_pk_bf16_f32 v84, v24, v25
    v_exp_f32 v28, v28
    v_mfma_f32_32x32x16_bf16 a[240:255], a[140:143], v[92:95], a[240:255]
    v_exp_f32 v29, v29
    v_cvt_pk_bf16_f32 v85, v26, v27
    v_exp_f32 v30, v30
    v_exp_f32 v31, v31
    v_cvt_pk_bf16_f32 v86, v28, v29
    v_cvt_pk_bf16_f32 v87, v30, v31
    v_mfma_f32_32x32x4_2b_bf16 v[48:79], a[78:79], v[114:115], v[48:79]
    v_exp_f32 v32, v32
    v_exp_f32 v33, v33
    v_exp_f32 v34, v34
    v_exp_f32 v35, v35
    v_cvt_pk_bf16_f32 v88, v32, v33
    v_exp_f32 v36, v36
    v_exp_f32 v37, v37
    v_cvt_pk_bf16_f32 v89, v34, v35
    v_exp_f32 v38, v38
    v_exp_f32 v39, v39
    v_mfma_f32_32x32x16_bf16 a[224:239], a[144:147], v[80:83], a[224:239]
    v_cvt_pk_bf16_f32 v90, v36, v37
    v_exp_f32 v40, v40
    v_exp_f32 v41, v41
    v_cvt_pk_bf16_f32 v91, v38, v39
    v_exp_f32 v42, v42
    v_exp_f32 v43, v43
    v_cvt_pk_bf16_f32 v92, v40, v41
    v_mfma_f32_32x32x16_bf16 a[224:239], a[148:151], v[84:87], a[224:239]
    v_exp_f32 v44, v44
    v_exp_f32 v45, v45
    v_cvt_pk_bf16_f32 v93, v42, v43
    v_exp_f32 v46, v46
    v_exp_f32 v47, v47
    v_cvt_pk_bf16_f32 v94, v44, v45
    v_cvt_pk_bf16_f32 v95, v46, v47
    v_mfma_f32_32x32x16_bf16 v[16:31], a[32:35], v[106:109], 0
    v_exp_f32 v48, v48
    v_exp_f32 v49, v49
    v_exp_f32 v50, v50
    v_exp_f32 v51, v51
    v_cvt_pk_bf16_f32 v80, v48, v49
    v_exp_f32 v52, v52
    v_mfma_f32_32x32x16_bf16 a[240:255], a[144:147], v[88:91], a[240:255]
    v_exp_f32 v53, v53
    v_cvt_pk_bf16_f32 v81, v50, v51
    v_exp_f32 v54, v54
    v_exp_f32 v55, v55
    v_cvt_pk_bf16_f32 v82, v52, v53
    v_exp_f32 v56, v56
    v_mfma_f32_32x32x16_bf16 v[32:47], a[32:35], v[110:113], 0
    v_exp_f32 v57, v57
    v_cvt_pk_bf16_f32 v83, v54, v55
    v_exp_f32 v58, v58
    v_exp_f32 v59, v59
    v_cvt_pk_bf16_f32 v84, v56, v57
    v_exp_f32 v60, v60
    v_mfma_f32_32x32x16_bf16 a[240:255], a[148:151], v[92:95], a[240:255]
    v_exp_f32 v61, v61
    v_cvt_pk_bf16_f32 v85, v58, v59
    v_exp_f32 v62, v62
    v_exp_f32 v63, v63
    v_cvt_pk_bf16_f32 v86, v60, v61
    v_cvt_pk_bf16_f32 v87, v62, v63
    v_mfma_f32_32x32x4_2b_bf16 v[16:47], a[80:81], v[114:115], v[16:47]
    v_exp_f32 v64, v64
    v_exp_f32 v65, v65
    v_exp_f32 v66, v66
    v_exp_f32 v67, v67
    v_cvt_pk_bf16_f32 v88, v64, v65
    v_exp_f32 v68, v68
    v_exp_f32 v69, v69
    v_cvt_pk_bf16_f32 v89, v66, v67
    v_exp_f32 v70, v70
    v_exp_f32 v71, v71
    v_mfma_f32_32x32x16_bf16 a[224:239], a[152:155], v[80:83], a[224:239]
    v_cvt_pk_bf16_f32 v90, v68, v69
    v_exp_f32 v72, v72
    v_exp_f32 v73, v73
    v_cvt_pk_bf16_f32 v91, v70, v71
    v_exp_f32 v74, v74
    v_exp_f32 v75, v75
    v_cvt_pk_bf16_f32 v92, v72, v73
    v_mfma_f32_32x32x16_bf16 a[224:239], a[156:159], v[84:87], a[224:239]
    v_exp_f32 v76, v76
    v_exp_f32 v77, v77
    v_cvt_pk_bf16_f32 v93, v74, v75
    v_exp_f32 v78, v78
    v_exp_f32 v79, v79
    v_cvt_pk_bf16_f32 v94, v76, v77
    v_cvt_pk_bf16_f32 v95, v78, v79
    s_waitcnt vmcnt(0)
    v_xor_b32 v8, s6, v8
    v_xor_b32 v9, s6, v9
    v_xor_b32 v10, s6, v10
    v_xor_b32 v11, s6, v11
    v_or_b32 v8, v8, v9
    v_or3_b32 v8, v8, v10, v11
    v_cmp_ne_u32 vcc, 0, v8
    s_cmp_eq_u32 s7, 0
    s_cselect_b64 s[32:33], -1, 0
    s_nop 1
    s_or_b64 vcc, vcc, s[32:33]
    s_cbranch_vccnz L_hook47
L_hookret47:
    v_mfma_f32_32x32x16_bf16 v[48:63], a[36:39], v[106:109], 0
    v_exp_f32 v16, v16
    v_exp_f32 v17, v17
    v_exp_f32 v18, v18
    v_exp_f32 v19, v19
    v_cvt_pk_bf16_f32 v80, v16, v17
    v_exp_f32 v20, v20
    v_mfma_f32_32x32x16_bf16 a[240:255], a[152:155], v[88:91], a[240:255]
    v_exp_f32 v21, v21
    v_cvt_pk_bf16_f32 v81, v18, v19
    v_exp_f32 v22, v22
    v_exp_f32 v23, v23
    v_cvt_pk_bf16_f32 v82, v20, v21
    v_exp_f32 v24, v24
    ds_read_b128 v[96:99], v126 offset:256
    ds_read_b128 v[100:103], v126 offset:1280
    ds_read_b64 v[104:105], v127 offset:128
    v_mfma_f32_32x32x16_bf16 v[64:79], a[36:39], v[110:113], 0
    v_exp_f32 v25, v25
    v_cvt_pk_bf16_f32 v83, v22, v23
    v_exp_f32 v26, v26
    v_exp_f32 v27, v27
    v_cvt_pk_bf16_f32 v84, v24, v25
    v_exp_f32 v28, v28
    v_mfma_f32_32x32x16_bf16 a[240:255], a[156:159], v[92:95], a[240:255]
    v_exp_f32 v29, v29
    v_cvt_pk_bf16_f32 v85, v26, v27
    v_exp_f32 v30, v30
    v_exp_f32 v31, v31
    v_cvt_pk_bf16_f32 v86, v28, v29
    v_cvt_pk_bf16_f32 v87, v30, v31
    v_mfma_f32_32x32x4_2b_bf16 v[48:79], a[82:83], v[114:115], v[48:79]
    v_exp_f32 v32, v32
    v_exp_f32 v33, v33
    v_exp_f32 v34, v34
    v_exp_f32 v35, v35
    v_cvt_pk_bf16_f32 v88, v32, v33
    v_exp_f32 v36, v36
    v_exp_f32 v37, v37
    v_cvt_pk_bf16_f32 v89, v34, v35
    v_exp_f32 v38, v38
    v_exp_f32 v39, v39
    v_mfma_f32_32x32x16_bf16 a[224:239], a[160:163], v[80:83], a[224:239]
    v_cvt_pk_bf16_f32 v90, v36, v37
    v_exp_f32 v40, v40
    v_exp_f32 v41, v41
    v_cvt_pk_bf16_f32 v91, v38, v39
    v_exp_f32 v42, v42
    v_exp_f32 v43, v43
    v_cvt_pk_bf16_f32 v92, v40, v41
    v_mfma_f32_32x32x16_bf16 a[224:239], a[164:167], v[84:87], a[224:239]
    v_exp_f32 v44, v44
    v_exp_f32 v45, v45
    v_cvt_pk_bf16_f32 v93, v42, v43
    v_exp_f32 v46, v46
    v_exp_f32 v47, v47
    v_cvt_pk_bf16_f32 v94, v44, v45
    v_cvt_pk_bf16_f32 v95, v46, v47
    s_bitcmp1_b32 s24, 4
    s_cbranch_scc1 L_h1
L_h1_ret:
    buffer_load_dwordx4 v12, s[16:19], s25 offen lds
    s_add_u32 m0, m0, 1024
    s_add_u32 s25, s25, s28
    v_mfma_f32_32x32x16_bf16 v[16:31], a[40:43], v[106:109], 0
    v_exp_f32 v48, v48
    v_exp_f32 v49, v49
    v_exp_f32 v50, v50
    v_exp_f32 v51, v51
    v_cvt_pk_bf16_f32 v80, v48, v49
    v_exp_f32 v52, v52
    v_mfma_f32_32x32x16_bf16 a[240:255], a[160:163], v[88:91], a[240:255]
    v_exp_f32 v53, v53
    v_cvt_pk_bf16_f32 v81, v50, v51
    v_exp_f32 v54, v54
    v_exp_f32 v55, v55
    v_cvt_pk_bf16_f32 v82, v52, v53
    v_exp_f32 v56, v56
    v_mfma_f32_32x32x16_bf16 v[32:47], a[40:43], v[110:113], 0
    v_exp_f32 v57, v57
    v_cvt_pk_bf16_f32 v83, v54, v55
    v_exp_f32 v58, v58
    v_exp_f32 v59, v59
    v_cvt_pk_bf16_f32 v84, v56, v57
    v_exp_f32 v60, v60
    v_mfma_f32_32x32x16_bf16 a[240:255], a[164:167], v[92:95], a[240:255]
    v_exp_f32 v61, v61
    v_cvt_pk_bf16_f32 v85, v58, v59
    v_exp_f32 v62, v62
    v_exp_f32 v63, v63
    v_cvt_pk_bf16_f32 v86, v60, v61
    v_cvt_pk_bf16_f32 v87, v62, v63
    v_mfma_f32_32x32x4_2b_bf16 v[16:47], a[84:85], v[114:115], v[16:47]
    v_exp_f32 v64, v64
    v_exp_f32 v65, v65
    v_exp_f32 v66, v66
    v_exp_f32 v67, v67
    v_cvt_pk_bf16_f32 v88, v64, v65
    v_exp_f32 v68, v68
    v_exp_f32 v69, v69
    v_cvt_pk_bf16_f32 v89, v66, v67
    v_exp_f32 v70, v70
    v_exp_f32 v71, v71
    v_mfma_f32_32x32x16_bf16 a[224:239], a[168:171], v[80:83], a[224:239]
    v_cvt_pk_bf16_f32 v90, v68, v69
    v_exp_f32 v72, v72
    v_exp_f32 v73, v73
    v_cvt_pk_bf16_f32 v91, v70, v71
    v_exp_f32 v74, v74
    v_exp_f32 v75, v75
    v_cvt_pk_bf16_f32 v92, v72, v73
    v_mfma_f32_32x32x16_bf16 a[224:239], a[172:175], v[84:87], a[224:239]
    v_exp_f32 v76, v76
    v_exp_f32 v77, v77
    v_cvt_pk_bf16_f32 v93, v74, v75
    v_exp_f32 v78, v78
    v_exp_f32 v79, v79
    v_cvt_pk_bf16_f32 v94, v76, v77
    v_cvt_pk_bf16_f32 v95, v78, v79
    v_mfma_f32_32x32x16_bf16 v[48:63], a[44:47], v[106:109], 0
    v_exp_f32 v16, v16
    v_exp_f32 v17, v17
    v_exp_f32 v18, v18
    v_exp_f32 v19, v19
    v_cvt_pk_bf16_f32 v80, v16, v17
    v_exp_f32 v20, v20
    v_mfma_f32_32x32x16_bf16 a[240:255], a[168:171], v[88:91], a[240:255]
    v_exp_f32 v21, v21
    v_cvt_pk_bf16_f32 v81, v18, v19
    v_exp_f32 v22, v22
    v_exp_f32 v23, v23
    v_cvt_pk_bf16_f32 v82, v20, v21
    v_exp_f32 v24, v24
    v_mfma_f32_32x32x16_bf16 v[64:79], a[44:47], v[110:113], 0
    v_exp_f32 v25, v25
    v_cvt_pk_bf16_f32 v83, v22, v23
    v_exp_f32 v26, v26
    v_exp_f32 v27, v27
    v_cvt_pk_bf16_f32 v84, v24, v25
    v_exp_f32 v28, v28
    v_mfma_f32_32x32x16_bf16 a[240:255], a[172:175], v[92:95], a[240:255]
    v_exp_f32 v29, v29
    v_cvt_pk_bf16_f32 v85, v26, v27
    v_exp_f32 v30, v30
    v_exp_f32 v31, v31
    v_cvt_pk_bf16_f32 v86, v28, v29
    v_cvt_pk_bf16_f32 v87, v30, v31
    v_mfma_f32_32x32x4_2b_bf16 v[48:79], a[86:87], v[114:115], v[48:79]
    v_exp_f32 v32, v32
    v_exp_f32 v33, v33
    v_exp_f32 v34, v34
    v_exp_f32 v35, v35
    v_cvt_pk_bf16_f32 v88, v32, v33
    v_exp_f32 v36, v36
    v_exp_f32 v37, v37
    v_cvt_pk_bf16_f32 v89, v34, v35
    v_exp_f32 v38, v38
    v_exp_f32 v39, v39
    v_mfma_f32_32x32x16_bf16 a[224:239], a[176:179], v[80:83], a[224:239]
    v_cvt_pk_bf16_f32 v90, v36, v37
    v_exp_f32 v40, v40
    v_exp_f32 v41, v41
    v_cvt_pk_bf16_f32 v91, v38, v39
    v_exp_f32 v42, v42
    v_exp_f32 v43, v43
    v_cvt_pk_bf16_f32 v92, v40, v41
    v_mfma_f32_32x32x16_bf16 a[224:239], a[180:183], v[84:87], a[224:239]
    v_exp_f32 v44, v44
    v_exp_f32 v45, v45
    v_cvt_pk_bf16_f32 v93, v42, v43
    v_exp_f32 v46, v46
    v_exp_f32 v47, v47
    v_cvt_pk_bf16_f32 v94, v44, v45
    v_cvt_pk_bf16_f32 v95, v46, v47
    v_mfma_f32_32x32x16_bf16 v[16:31], a[48:51], v[106:109], 0
    v_exp_f32 v48, v48
    v_exp_f32 v49, v49
    v_exp_f32 v50, v50
    v_exp_f32 v51, v51
    v_cvt_pk_bf16_f32 v80, v48, v49
    v_exp_f32 v52, v52
    v_mfma_f32_32x32x16_bf16 a[240:255], a[176:179], v[88:91], a[240:255]
    v_exp_f32 v53, v53
    v_cvt_pk_bf16_f32 v81, v50, v51
    v_exp_f32 v54, v54
    v_exp_f32 v55, v55
    v_cvt_pk_bf16_f32 v82, v52, v53
    v_exp_f32 v56, v56
    v_mfma_f32_32x32x16_bf16 v[32:47], a[48:51], v[110:113], 0
    v_exp_f32 v57, v57
    v_cvt_pk_bf16_f32 v83, v54, v55
    v_exp_f32 v58, v58
    v_exp_f32 v59, v59
    v_cvt_pk_bf16_f32 v84, v56, v57
    v_exp_f32 v60, v60
    v_mfma_f32_32x32x16_bf16 a[240:255], a[180:183], v[92:95], a[240:255]
    v_exp_f32 v61, v61
    v_cvt_pk_bf16_f32 v85, v58, v59
    v_exp_f32 v62, v62
    v_exp_f32 v63, v63
    v_cvt_pk_bf16_f32 v86, v60, v61
    v_cvt_pk_bf16_f32 v87, v62, v63
    v_mfma_f32_32x32x4_2b_bf16 v[16:47], a[88:89], v[114:115], v[16:47]
    v_exp_f32 v64, v64
    v_exp_f32 v65, v65
    v_exp_f32 v66, v66
    v_exp_f32 v67, v67
    v_cvt_pk_bf16_f32 v88, v64, v65
    v_exp_f32 v68, v68
    v_exp_f32 v69, v69
    v_cvt_pk_bf16_f32 v89, v66, v67
    v_exp_f32 v70, v70
    v_exp_f32 v71, v71
    v_mfma_f32_32x32x16_bf16 a[224:239], a[184:187], v[80:83], a[224:239]
    v_cvt_pk_bf16_f32 v90, v68, v69
    v_exp_f32 v72, v72
    v_exp_f32 v73, v73
    v_cvt_pk_bf16_f32 v91, v70, v71
    v_exp_f32 v74, v74
    v_exp_f32 v75, v75
    v_cvt_pk_bf16_f32 v92, v72, v73
    v_mfma_f32_32x32x16_bf16 a[224:239], a[188:191], v[84:87], a[224:239]
    v_exp_f32 v76, v76
    v_exp_f32 v77, v77
    v_cvt_pk_bf16_f32 v93, v74, v75
    v_exp_f32 v78, v78
    v_exp_f32 v79, v79
    v_cvt_pk_bf16_f32 v94, v76, v77
    v_cvt_pk_bf16_f32 v95, v78, v79
    s_bitcmp1_b32 s24, 4
    s_cbranch_scc1 L_h2
L_h2_ret:
    buffer_load_dwordx4 v12, s[16:19], s25 offen lds
    s_add_u32 m0, m0, 1024
    s_add_u32 s25, s25, s28
    v_mfma_f32_32x32x16_bf16 v[48:63], a[52:55], v[106:109], 0
    v_exp_f32 v16, v16
    v_exp_f32 v17, v17
    v_exp_f32 v18, v18
    v_exp_f32 v19, v19
    v_cvt_pk_bf16_f32 v80, v16, v17
    v_exp_f32 v20, v20
    v_mfma_f32_32x32x16_bf16 a[240:255], a[184:187], v[88:91], a[240:255]
    v_exp_f32 v21, v21
    v_cvt_pk_bf16_f32 v81, v18, v19
    v_exp_f32 v22, v22
    v_exp_f32 v23, v23
    v_cvt_pk_bf16_f32 v82, v20, v21
    v_exp_f32 v24, v24
    v_mfma_f32_32x32x16_bf16 v[64:79], a[52:55], v[110:113], 0
    v_exp_f32 v25, v25
    v_cvt_pk_bf16_f32 v83, v22, v23
    v_exp_f32 v26, v26
    v_exp_f32 v27, v27
    v_cvt_pk_bf16_f32 v84, v24, v25
    v_exp_f32 v28, v28
    v_mfma_f32_32x32x16_bf16 a[240:255], a[188:191], v[92:95], a[240:255]
    v_exp_f32 v29, v29
    v_cvt_pk_bf16_f32 v85, v26, v27
    v_exp_f32 v30, v30
    v_exp_f32 v31, v31
    v_cvt_pk_bf16_f32 v86, v28, v29
    v_cvt_pk_bf16_f32 v87, v30, v31
    v_mfma_f32_32x32x4_2b_bf16 v[48:79], a[90:91], v[114:115], v[48:79]
    v_exp_f32 v32, v32
    v_exp_f32 v33, v33
    v_exp_f32 v34, v34
    v_exp_f32 v35, v35
    v_cvt_pk_bf16_f32 v88, v32, v33
    v_exp_f32 v36, v36
    v_exp_f32 v37, v37
    v_cvt_pk_bf16_f32 v89, v34, v35
    v_exp_f32 v38, v38
    v_exp_f32 v39, v39
    v_mfma_f32_32x32x16_bf16 a[224:239], a[192:195], v[80:83], a[224:239]
    v_cvt_pk_bf16_f32 v90, v36, v37
    v_exp_f32 v40, v40
    v_exp_f32 v41, v41
    v_cvt_pk_bf16_f32 v91, v38, v39
    v_exp_f32 v42, v42
    v_exp_f32 v43, v43
    v_cvt_pk_bf16_f32 v92, v40, v41
    v_mfma_f32_32x32x16_bf16 a[224:239], a[196:199], v[84:87], a[224:239]
    v_exp_f32 v44, v44
    v_exp_f32 v45, v45
    v_cvt_pk_bf16_f32 v93, v42, v43
    v_exp_f32 v46, v46
    v_exp_f32 v47, v47
    v_cvt_pk_bf16_f32 v94, v44, v45
    v_cvt_pk_bf16_f32 v95, v46, v47
    v_mfma_f32_32x32x16_bf16 v[16:31], a[56:59], v[106:109], 0
    v_exp_f32 v48, v48
    v_exp_f32 v49, v49
    v_exp_f32 v50, v50
    v_exp_f32 v51, v51
    v_cvt_pk_bf16_f32 v80, v48, v49
    v_exp_f32 v52, v52
    v_mfma_f32_32x32x16_bf16 a[240:255], a[192:195], v[88:91], a[240:255]
    v_exp_f32 v53, v53
    v_cvt_pk_bf16_f32 v81, v50, v51
    v_exp_f32 v54, v54
    v_exp_f32 v55, v55
    v_cvt_pk_bf16_f32 v82, v52, v53
    v_exp_f32 v56, v56
    v_mfma_f32_32x32x16_bf16 v[32:47], a[56:59], v[110:113], 0
    v_exp_f32 v57, v57
    v_cvt_pk_bf16_f32 v83, v54, v55
    v_exp_f32 v58, v58
    v_exp_f32 v59, v59
    v_cvt_pk_bf16_f32 v84, v56, v57
    v_exp_f32 v60, v60
    v_mfma_f32_32x32x16_bf16 a[240:255], a[196:199], v[92:95], a[240:255]
    v_exp_f32 v61, v61
    v_cvt_pk_bf16_f32 v85, v58, v59
    v_exp_f32 v62, v62
    v_exp_f32 v63, v63
    v_cvt_pk_bf16_f32 v86, v60, v61
    v_cvt_pk_bf16_f32 v87, v62, v63
    v_mfma_f32_32x32x4_2b_bf16 v[16:47], a[92:93], v[114:115], v[16:47]
    v_exp_f32 v64, v64
    v_exp_f32 v65, v65
    v_exp_f32 v66, v66
    v_exp_f32 v67, v67
    v_cvt_pk_bf16_f32 v88, v64, v65
    v_exp_f32 v68, v68
    v_exp_f32 v69, v69
    v_cvt_pk_bf16_f32 v89, v66, v67
    v_exp_f32 v70, v70
    v_exp_f32 v71, v71
    v_mfma_f32_32x32x16_bf16 a[224:239], a[200:203], v[80:83], a[224:239]
    v_cvt_pk_bf16_f32 v90, v68, v69
    v_exp_f32 v72, v72
    v_exp_f32 v73, v73
    v_cvt_pk_bf16_f32 v91, v70, v71
    v_exp_f32 v74, v74
    v_exp_f32 v75, v75
    v_cvt_pk_bf16_f32 v92, v72, v73
    v_mfma_f32_32x32x16_bf16 a[224:239], a[204:207], v[84:87], a[224:239]
    v_exp_f32 v76, v76
    v_exp_f32 v77, v77
    v_cvt_pk_bf16_f32 v93, v74, v75
    v_exp_f32 v78, v78
    v_exp_f32 v79, v79
    v_cvt_pk_bf16_f32 v94, v76, v77
    v_cvt_pk_bf16_f32 v95, v78, v79
    s_bitcmp1_b32 s24, 4
    s_cbranch_scc1 L_h3
L_h3_ret:
    v_mfma_f32_32x32x16_bf16 v[48:63], a[60:63], v[106:109], 0
    v_exp_f32 v16, v16
    v_exp_f32 v17, v17
    v_exp_f32 v18, v18
    v_exp_f32 v19, v19
    v_cvt_pk_bf16_f32 v80, v16, v17
    v_exp_f32 v20, v20
    v_mfma_f32_32x32x16_bf16 a[240:255], a[200:203], v[88:91], a[240:255]
    v_exp_f32 v21, v21
    v_cvt_pk_bf16_f32 v81, v18, v19
    v_exp_f32 v22, v22
    v_exp_f32 v23, v23
    v_cvt_pk_bf16_f32 v82, v20, v21
    v_exp_f32 v24, v24
    v_mfma_f32_32x32x16_bf16 v[64:79], a[60:63], v[110:113], 0
    v_exp_f32 v25, v25
    v_cvt_pk_bf16_f32 v83, v22, v23
    v_exp_f32 v26, v26
    v_exp_f32 v27, v27
    v_cvt_pk_bf16_f32 v84, v24, v25
    v_exp_f32 v28, v28
    v_mfma_f32_32x32x16_bf16 a[240:255], a[204:207], v[92:95], a[240:255]
    v_exp_f32 v29, v29
    v_cvt_pk_bf16_f32 v85, v26, v27
    v_exp_f32 v30, v30
    v_exp_f32 v31, v31
    v_cvt_pk_bf16_f32 v86, v28, v29
    v_cvt_pk_bf16_f32 v87, v30, v31
    v_mfma_f32_32x32x4_2b_bf16 v[48:79], a[94:95], v[114:115], v[48:79]
    v_exp_f32 v32, v32
    v_exp_f32 v33, v33
    v_exp_f32 v34, v34
    v_exp_f32 v35, v35
    v_cvt_pk_bf16_f32 v88, v32, v33
    v_exp_f32 v36, v36
    v_exp_f32 v37, v37
    v_cvt_pk_bf16_f32 v89, v34, v35
    v_exp_f32 v38, v38
    v_exp_f32 v39, v39
    v_mfma_f32_32x32x16_bf16 a[224:239], a[208:211], v[80:83], a[224:239]
    v_cvt_pk_bf16_f32 v90, v36, v37
    v_exp_f32 v40, v40
    v_exp_f32 v41, v41
    v_cvt_pk_bf16_f32 v91, v38, v39
    v_exp_f32 v42, v42
    v_exp_f32 v43, v43
    v_cvt_pk_bf16_f32 v92, v40, v41
    v_mfma_f32_32x32x16_bf16 a[224:239], a[212:215], v[84:87], a[224:239]
    v_exp_f32 v44, v44
    v_exp_f32 v45, v45
    v_cvt_pk_bf16_f32 v93, v42, v43
    v_exp_f32 v46, v46
    v_exp_f32 v47, v47
    v_cvt_pk_bf16_f32 v94, v44, v45
    v_cvt_pk_bf16_f32 v95, v46, v47
    buffer_load_dwordx4 v12, s[16:19], s25 offen lds
    s_add_u32 m0, m0, 1024
    s_add_u32 s25, s25, s28
    s_waitcnt lgkmcnt(0)
    v_mfma_f32_32x32x16_bf16 v[16:31], a[0:3], v[96:99], 0
    v_exp_f32 v48, v48
    v_exp_f32 v49, v49
    v_exp_f32 v50, v50
    v_exp_f32 v51, v51
    v_cvt_pk_bf16_f32 v80, v48, v49
    v_exp_f32 v52, v52
    v_mfma_f32_32x32x16_bf16 a[240:255], a[208:211], v[88:91], a[240:255]
    v_exp_f32 v53, v53
    v_cvt_pk_bf16_f32 v81, v50, v51
    v_exp_f32 v54, v54
    v_exp_f32 v55, v55
    v_cvt_pk_bf16_f32 v82, v52, v53
    v_exp_f32 v56, v56
    v_mfma_f32_32x32x16_bf16 v[32:47], a[0:3], v[100:103], 0
    v_exp_f32 v57, v57
    v_cvt_pk_bf16_f32 v83, v54, v55
    v_exp_f32 v58, v58
    v_exp_f32 v59, v59
    v_cvt_pk_bf16_f32 v84, v56, v57
    v_exp_f32 v60, v60
    v_mfma_f32_32x32x16_bf16 a[240:255], a[212:215], v[92:95], a[240:255]
    v_exp_f32 v61, v61
    v_cvt_pk_bf16_f32 v85, v58, v59
    v_exp_f32 v62, v62
    v_exp_f32 v63, v63
    v_cvt_pk_bf16_f32 v86, v60, v61
    v_cvt_pk_bf16_f32 v87, v62, v63
    v_mfma_f32_32x32x4_2b_bf16 v[16:47], a[64:65], v[104:105], v[16:47]
    v_exp_f32 v64, v64
    v_exp_f32 v65, v65
    v_exp_f32 v66, v66
    v_exp_f32 v67, v67
    v_cvt_pk_bf16_f32 v88, v64, v65
    v_exp_f32 v68, v68
    v_exp_f32 v69, v69
    v_cvt_pk_bf16_f32 v89, v66, v67
    v_exp_f32 v70, v70
    v_exp_f32 v71, v71
    v_mfma_f32_32x32x16_bf16 a[224:239], a[216:219], v[80:83], a[224:239]
    v_cvt_pk_bf16_f32 v90, v68, v69
    v_exp_f32 v72, v72
    v_exp_f32 v73, v73
    v_cvt_pk_bf16_f32 v91, v70, v71
    v_exp_f32 v74, v74
    v_exp_f32 v75, v75
    v_cvt_pk_bf16_f32 v92, v72, v73
    v_mfma_f32_32x32x16_bf16 a[224:239], a[220:223], v[84:87], a[224:239]
    v_exp_f32 v76, v76
    v_exp_f32 v77, v77
    v_cvt_pk_bf16_f32 v93, v74, v75
    v_exp_f32 v78, v78
    v_exp_f32 v79, v79
    v_cvt_pk_bf16_f32 v94, v76, v77
    v_cvt_pk_bf16_f32 v95, v78, v79
    v_mfma_f32_32x32x16_bf16 v[48:63], a[4:7], v[96:99], 0
    v_exp_f32 v16, v16
    v_exp_f32 v17, v17
    v_exp_f32 v18, v18
    v_exp_f32 v19, v19
    v_cvt_pk_bf16_f32 v80, v16, v17
    v_exp_f32 v20, v20
    v_mfma_f32_32x32x16_bf16 a[240:255], a[216:219], v[88:91], a[240:255]
    v_exp_f32 v21, v21
    v_cvt_pk_bf16_f32 v81, v18, v19
    v_exp_f32 v22, v22
    v_exp_f32 v23, v23
    v_cvt_pk_bf16_f32 v82, v20, v21
    v_exp_f32 v24, v24
    ds_write_b128 v14, a[224:227] offset:6144
    ds_write_b128 v14, a[228:231] offset:7168
    ds_write_b128 v14, a[232:235] offset:8192
    v_mfma_f32_32x32x16_bf16 v[64:79], a[4:7], v[100:103], 0
    v_exp_f32 v25, v25
    v_cvt_pk_bf16_f32 v83, v22, v23
    v_exp_f32 v26, v26
    v_exp_f32 v27, v27
    v_cvt_pk_bf16_f32 v84, v24, v25
    v_exp_f32 v28, v28
    v_mfma_f32_32x32x16_bf16 a[240:255], a[220:223], v[92:95], a[240:255]
    v_exp_f32 v29, v29
    v_cvt_pk_bf16_f32 v85, v26, v27
    v_exp_f32 v30, v30
    v_exp_f32 v31, v31
    v_cvt_pk_bf16_f32 v86, v28, v29
    v_cvt_pk_bf16_f32 v87, v30, v31
    v_mfma_f32_32x32x4_2b_bf16 v[48:79], a[66:67], v[104:105], v[48:79]
    v_exp_f32 v32, v32
    v_exp_f32 v33, v33
    v_exp_f32 v34, v34
    v_exp_f32 v35, v35
    v_cvt_pk_bf16_f32 v88, v32, v33
    v_exp_f32 v36, v36
    v_exp_f32 v37, v37
    v_cvt_pk_bf16_f32 v89, v34, v35
    v_exp_f32 v38, v38
    v_exp_f32 v39, v39
    v_mfma_f32_32x32x16_bf16 a[224:239], a[96:99], v[80:83], 0
    v_cvt_pk_bf16_f32 v90, v36, v37
    v_exp_f32 v40, v40
    v_exp_f32 v41, v41
    v_cvt_pk_bf16_f32 v91, v38, v39
    v_exp_f32 v42, v42
    v_exp_f32 v43, v43
    v_cvt_pk_bf16_f32 v92, v40, v41
    v_mfma_f32_32x32x16_bf16 a[224:239], a[100:103], v[84:87], a[224:239]
    v_exp_f32 v44, v44
    v_exp_f32 v45, v45
    v_cvt_pk_bf16_f32 v93, v42, v43
    v_exp_f32 v46, v46
    v_exp_f32 v47, v47
    v_cvt_pk_bf16_f32 v94, v44, v45
    v_cvt_pk_bf16_f32 v95, v46, v47
    ds_write_b128 v14, a[240:243] offset:9216
    ds_write_b128 v14, a[244:247] offset:10240
    ds_write_b128 v14, a[248:251] offset:11264
    v_mfma_f32_32x32x16_bf16 v[16:31], a[8:11], v[96:99], 0
    v_exp_f32 v48, v48
    v_exp_f32 v49, v49
    v_exp_f32 v50, v50
    v_exp_f32 v51, v51
    v_cvt_pk_bf16_f32 v80, v48, v49
    v_exp_f32 v52, v52
    v_mfma_f32_32x32x16_bf16 a[240:255], a[96:99], v[88:91], 0
    v_exp_f32 v53, v53
    v_cvt_pk_bf16_f32 v81, v50, v51
    v_exp_f32 v54, v54
    v_exp_f32 v55, v55
    v_cvt_pk_bf16_f32 v82, v52, v53
    v_exp_f32 v56, v56
    v_mfma_f32_32x32x16_bf16 v[32:47], a[8:11], v[100:103], 0
    v_exp_f32 v57, v57
    v_cvt_pk_bf16_f32 v83, v54, v55
    v_exp_f32 v58, v58
    v_exp_f32 v59, v59
    v_cvt_pk_bf16_f32 v84, v56, v57
    v_exp_f32 v60, v60
    v_mfma_f32_32x32x16_bf16 a[240:255], a[100:103], v[92:95], a[240:255]
    v_exp_f32 v61, v61
    v_cvt_pk_bf16_f32 v85, v58, v59
    v_exp_f32 v62, v62
    v_exp_f32 v63, v63
    v_cvt_pk_bf16_f32 v86, v60, v61
    v_cvt_pk_bf16_f32 v87, v62, v63
    v_mfma_f32_32x32x4_2b_bf16 v[16:47], a[68:69], v[104:105], v[16:47]
    v_exp_f32 v64, v64
    v_exp_f32 v65, v65
    v_exp_f32 v66, v66
    v_exp_f32 v67, v67
    v_cvt_pk_bf16_f32 v88, v64, v65
    v_exp_f32 v68, v68
    v_exp_f32 v69, v69
    v_cvt_pk_bf16_f32 v89, v66, v67
    v_exp_f32 v70, v70
    v_exp_f32 v71, v71
    v_mfma_f32_32x32x16_bf16 a[224:239], a[104:107], v[80:83], a[224:239]
    v_cvt_pk_bf16_f32 v90, v68, v69
    v_exp_f32 v72, v72
    v_exp_f32 v73, v73
    v_cvt_pk_bf16_f32 v91, v70, v71
    v_exp_f32 v74, v74
    v_exp_f32 v75, v75
    v_cvt_pk_bf16_f32 v92, v72, v73
    v_mfma_f32_32x32x16_bf16 a[224:239], a[108:111], v[84:87], a[224:239]
    v_exp_f32 v76, v76
    v_exp_f32 v77, v77
    v_cvt_pk_bf16_f32 v93, v74, v75
    v_exp_f32 v78, v78
    v_exp_f32 v79, v79
    v_cvt_pk_bf16_f32 v94, v76, v77
    v_cvt_pk_bf16_f32 v95, v78, v79
    buffer_load_dwordx4 v12, s[16:19], s25 offen lds
    s_add_u32 m0, m0, 1024
    s_add_u32 s25, s25, s28
    v_mfma_f32_32x32x16_bf16 v[48:63], a[12:15], v[96:99], 0
    v_exp_f32 v16, v16
    v_exp_f32 v17, v17
    v_exp_f32 v18, v18
    v_exp_f32 v19, v19
    v_cvt_pk_bf16_f32 v80, v16, v17
    v_exp_f32 v20, v20
    v_mfma_f32_32x32x16_bf16 a[240:255], a[104:107], v[88:91], a[240:255]
    v_exp_f32 v21, v21
    v_cvt_pk_bf16_f32 v81, v18, v19
    v_exp_f32 v22, v22
    v_exp_f32 v23, v23
    v_cvt_pk_bf16_f32 v82, v20, v21
    v_exp_f32 v24, v24
    v_mfma_f32_32x32x16_bf16 v[64:79], a[12:15], v[100:103], 0
    v_exp_f32 v25, v25
    v_cvt_pk_bf16_f32 v83, v22, v23
    v_exp_f32 v26, v26
    v_exp_f32 v27, v27
    v_cvt_pk_bf16_f32 v84, v24, v25
    v_exp_f32 v28, v28
    v_mfma_f32_32x32x16_bf16 a[240:255], a[108:111], v[92:95], a[240:255]
    v_exp_f32 v29, v29
    v_cvt_pk_bf16_f32 v85, v26, v27
    v_exp_f32 v30, v30
    v_exp_f32 v31, v31
    v_cvt_pk_bf16_f32 v86, v28, v29
    v_cvt_pk_bf16_f32 v87, v30, v31
    v_mfma_f32_32x32x4_2b_bf16 v[48:79], a[70:71], v[104:105], v[48:79]
    v_exp_f32 v32, v32
    v_exp_f32 v33, v33
    v_exp_f32 v34, v34
    v_exp_f32 v35, v35
    v_cvt_pk_bf16_f32 v88, v32, v33
    v_exp_f32 v36, v36
    v_exp_f32 v37, v37
    v_cvt_pk_bf16_f32 v89, v34, v35
    v_exp_f32 v38, v38
    v_exp_f32 v39, v39
    v_mfma_f32_32x32x16_bf16 a[224:239], a[112:115], v[80:83], a[224:239]
    v_cvt_pk_bf16_f32 v90, v36, v37
    v_exp_f32 v40, v40
    v_exp_f32 v41, v41
    v_cvt_pk_bf16_f32 v91, v38, v39
    v_exp_f32 v42, v42
    v_exp_f32 v43, v43
    v_cvt_pk_bf16_f32 v92, v40, v41
    v_mfma_f32_32x32x16_bf16 a[224:239], a[116:119], v[84:87], a[224:239]
    v_exp_f32 v44, v44
    v_exp_f32 v45, v45
    v_cvt_pk_bf16_f32 v93, v42, v43
    v_exp_f32 v46, v46
    v_exp_f32 v47, v47
    v_cvt_pk_bf16_f32 v94, v44, v45
    v_cvt_pk_bf16_f32 v95, v46, v47
    v_mfma_f32_32x32x16_bf16 v[16:31], a[16:19], v[96:99], 0
    v_exp_f32 v48, v48
    v_exp_f32 v49, v49
    v_exp_f32 v50, v50
    v_exp_f32 v51, v51
    v_cvt_pk_bf16_f32 v80, v48, v49
    v_exp_f32 v52, v52
    v_mfma_f32_32x32x16_bf16 a[240:255], a[112:115], v[88:91], a[240:255]
    v_exp_f32 v53, v53
    v_cvt_pk_bf16_f32 v81, v50, v51
    v_exp_f32 v54, v54
    v_exp_f32 v55, v55
    v_cvt_pk_bf16_f32 v82, v52, v53
    v_exp_f32 v56, v56
    v_mfma_f32_32x32x16_bf16 v[32:47], a[16:19], v[100:103], 0
    v_exp_f32 v57, v57
    v_cvt_pk_bf16_f32 v83, v54, v55
    v_exp_f32 v58, v58
    v_exp_f32 v59, v59
    v_cvt_pk_bf16_f32 v84, v56, v57
    v_exp_f32 v60, v60
    v_mfma_f32_32x32x16_bf16 a[240:255], a[116:119], v[92:95], a[240:255]
    v_exp_f32 v61, v61
    v_cvt_pk_bf16_f32 v85, v58, v59
    v_exp_f32 v62, v62
    v_exp_f32 v63, v63
    v_cvt_pk_bf16_f32 v86, v60, v61
    v_cvt_pk_bf16_f32 v87, v62, v63
    v_mfma_f32_32x32x4_2b_bf16 v[16:47], a[72:73], v[104:105], v[16:47]
    v_exp_f32 v64, v64
    v_exp_f32 v65, v65
    v_exp_f32 v66, v66
    v_exp_f32 v67, v67
    v_cvt_pk_bf16_f32 v88, v64, v65
    v_exp_f32 v68, v68
    v_exp_f32 v69, v69
    v_cvt_pk_bf16_f32 v89, v66, v67
    v_exp_f32 v70, v70
    v_exp_f32 v71, v71
    v_mfma_f32_32x32x16_bf16 a[224:239], a[120:123], v[80:83], a[224:239]
    v_cvt_pk_bf16_f32 v90, v68, v69
    v_exp_f32 v72, v72
    v_exp_f32 v73, v73
    v_cvt_pk_bf16_f32 v91, v70, v71
    v_exp_f32 v74, v74
    v_exp_f32 v75, v75
    v_cvt_pk_bf16_f32 v92, v72, v73
    v_mfma_f32_32x32x16_bf16 a[224:239], a[124:127], v[84:87], a[224:239]
    v_exp_f32 v76, v76
    v_exp_f32 v77, v77
    v_cvt_pk_bf16_f32 v93, v74, v75
    v_exp_f32 v78, v78
    v_exp_f32 v79, v79
    v_cvt_pk_bf16_f32 v94, v76, v77
    v_cvt_pk_bf16_f32 v95, v78, v79
    v_mfma_f32_32x32x16_bf16 v[48:63], a[20:23], v[96:99], 0
    v_exp_f32 v16, v16
    v_exp_f32 v17, v17
    v_exp_f32 v18, v18
    v_exp_f32 v19, v19
    v_cvt_pk_bf16_f32 v80, v16, v17
    v_exp_f32 v20, v20
    v_mfma_f32_32x32x16_bf16 a[240:255], a[120:123], v[88:91], a[240:255]
    v_exp_f32 v21, v21
    v_cvt_pk_bf16_f32 v81, v18, v19
    v_exp_f32 v22, v22
    v_exp_f32 v23, v23
    v_cvt_pk_bf16_f32 v82, v20, v21
    v_exp_f32 v24, v24
    v_mfma_f32_32x32x16_bf16 v[64:79], a[20:23], v[100:103], 0
    v_exp_f32 v25, v25
    v_cvt_pk_bf16_f32 v83, v22, v23
    v_exp_f32 v26, v26
    v_exp_f32 v27, v27
    v_cvt_pk_bf16_f32 v84, v24, v25
    v_exp_f32 v28, v28
    v_mfma_f32_32x32x16_bf16 a[240:255], a[124:127], v[92:95], a[240:255]
    v_exp_f32 v29, v29
    v_cvt_pk_bf16_f32 v85, v26, v27
    v_exp_f32 v30, v30
    v_exp_f32 v31, v31
    v_cvt_pk_bf16_f32 v86, v28, v29
    v_cvt_pk_bf16_f32 v87, v30, v31
    v_mfma_f32_32x32x4_2b_bf16 v[48:79], a[74:75], v[104:105], v[48:79]
    v_exp_f32 v32, v32
    v_exp_f32 v33, v33
    v_exp_f32 v34, v34
    v_exp_f32 v35, v35
    v_cvt_pk_bf16_f32 v88, v32, v33
    v_exp_f32 v36, v36
    v_exp_f32 v37, v37
    v_cvt_pk_bf16_f32 v89, v34, v35
    v_exp_f32 v38, v38
    v_exp_f32 v39, v39
    v_mfma_f32_32x32x16_bf16 a[224:239], a[128:131], v[80:83], a[224:239]
    v_cvt_pk_bf16_f32 v90, v36, v37
    v_exp_f32 v40, v40
    v_exp_f32 v41, v41
    v_cvt_pk_bf16_f32 v91, v38, v39
    v_exp_f32 v42, v42
    v_exp_f32 v43, v43
    v_cvt_pk_bf16_f32 v92, v40, v41
    v_mfma_f32_32x32x16_bf16 a[224:239], a[132:135], v[84:87], a[224:239]
    v_exp_f32 v44, v44
    v_exp_f32 v45, v45
    v_cvt_pk_bf16_f32 v93, v42, v43
    v_exp_f32 v46, v46
    v_exp_f32 v47, v47
    v_cvt_pk_bf16_f32 v94, v44, v45
    v_cvt_pk_bf16_f32 v95, v46, v47
    buffer_load_dwordx4 v12, s[16:19], s25 offen lds
    s_add_u32 m0, m0, 1024
    s_add_u32 s25, s25, s28
    v_mfma_f32_32x32x16_bf16 v[16:31], a[24:27], v[96:99], 0
    v_exp_f32 v48, v48
    v_exp_f32 v49, v49
    v_exp_f32 v50, v50
    v_exp_f32 v51, v51
    v_cvt_pk_bf16_f32 v80, v48, v49
    v_exp_f32 v52, v52
    v_mfma_f32_32x32x16_bf16 a[240:255], a[128:131], v[88:91], a[240:255]
    v_exp_f32 v53, v53
    v_cvt_pk_bf16_f32 v81, v50, v51
    v_exp_f32 v54, v54
    v_exp_f32 v55, v55
    v_cvt_pk_bf16_f32 v82, v52, v53
    v_exp_f32 v56, v56
    v_mfma_f32_32x32x16_bf16 v[32:47], a[24:27], v[100:103], 0
    v_exp_f32 v57, v57
    v_cvt_pk_bf16_f32 v83, v54, v55
    v_exp_f32 v58, v58
    v_exp_f32 v59, v59
    v_cvt_pk_bf16_f32 v84, v56, v57
    v_exp_f32 v60, v60
    v_mfma_f32_32x32x16_bf16 a[240:255], a[132:135], v[92:95], a[240:255]
    v_exp_f32 v61, v61
    v_cvt_pk_bf16_f32 v85, v58, v59
    v_exp_f32 v62, v62
    v_exp_f32 v63, v63
    v_cvt_pk_bf16_f32 v86, v60, v61
    v_cvt_pk_bf16_f32 v87, v62, v63
    v_mfma_f32_32x32x4_2b_bf16 v[16:47], a[76:77], v[104:105], v[16:47]
    v_exp_f32 v64, v64
    v_exp_f32 v65, v65
    v_exp_f32 v66, v66
    v_exp_f32 v67, v67
    v_cvt_pk_bf16_f32 v88, v64, v65
    v_exp_f32 v68, v68
    v_exp_f32 v69, v69
    v_cvt_pk_bf16_f32 v89, v66, v67
    v_exp_f32 v70, v70
    v_exp_f32 v71, v71
    v_mfma_f32_32x32x16_bf16 a[224:239], a[136:139], v[80:83], a[224:239]
    v_cvt_pk_bf16_f32 v90, v68, v69
    v_exp_f32 v72, v72
    v_exp_f32 v73, v73
    v_cvt_pk_bf16_f32 v91, v70, v71
    v_exp_f32 v74, v74
    v_exp_f32 v75, v75
    v_cvt_pk_bf16_f32 v92, v72, v73
    v_mfma_f32_32x32x16_bf16 a[224:239], a[140:143], v[84:87], a[224:239]
    v_exp_f32 v76, v76
    v_exp_f32 v77, v77
    v_cvt_pk_bf16_f32 v93, v74, v75
    v_exp_f32 v78, v78
    v_exp_f32 v79, v79
    v_cvt_pk_bf16_f32 v94, v76, v77
    v_cvt_pk_bf16_f32 v95, v78, v79
    v_mfma_f32_32x32x16_bf16 v[48:63], a[28:31], v[96:99], 0
    v_exp_f32 v16, v16
    v_exp_f32 v17, v17
    v_exp_f32 v18, v18
    v_exp_f32 v19, v19
    v_cvt_pk_bf16_f32 v80, v16, v17
    v_exp_f32 v20, v20
    v_mfma_f32_32x32x16_bf16 a[240:255], a[136:139], v[88:91], a[240:255]
    v_exp_f32 v21, v21
    v_cvt_pk_bf16_f32 v81, v18, v19
    v_exp_f32 v22, v22
    v_exp_f32 v23, v23
    v_cvt_pk_bf16_f32 v82, v20, v21
    v_exp_f32 v24, v24
    v_mfma_f32_32x32x16_bf16 v[64:79], a[28:31], v[100:103], 0
    v_exp_f32 v25, v25
    v_cvt_pk_bf16_f32 v83, v22, v23
    v_exp_f32 v26, v26
    v_exp_f32 v27, v27
    v_cvt_pk_bf16_f32 v84, v24, v25
    v_exp_f32 v28, v28
    v_mfma_f32_32x32x16_bf16 a[240:255], a[140:143], v[92:95], a[240:255]
    v_exp_f32 v29, v29
    v_cvt_pk_bf16_f32 v85, v26, v27
    v_exp_f32 v30, v30
    v_exp_f32 v31, v31
    v_cvt_pk_bf16_f32 v86, v28, v29
    v_cvt_pk_bf16_f32 v87, v30, v31
    v_mfma_f32_32x32x4_2b_bf16 v[48:79], a[78:79], v[104:105], v[48:79]
    v_exp_f32 v32, v32
    v_exp_f32 v33, v33
    v_exp_f32 v34, v34
    v_exp_f32 v35, v35
    v_cvt_pk_bf16_f32 v88, v32, v33
    v_exp_f32 v36, v36
    v_exp_f32 v37, v37
    v_cvt_pk_bf16_f32 v89, v34, v35
    v_exp_f32 v38, v38
    v_exp_f32 v39, v39
    v_mfma_f32_32x32x16_bf16 a[224:239], a[144:147], v[80:83], a[224:239]
    v_cvt_pk_bf16_f32 v90, v36, v37
    v_exp_f32 v40, v40
    v_exp_f32 v41, v41
    v_cvt_pk_bf16_f32 v91, v38, v39
    v_exp_f32 v42, v42
    v_exp_f32 v43, v43
    v_cvt_pk_bf16_f32 v92, v40, v41
    v_mfma_f32_32x32x16_bf16 a[224:239], a[148:151], v[84:87], a[224:239]
    v_exp_f32 v44, v44
    v_exp_f32 v45, v45
    v_cvt_pk_bf16_f32 v93, v42, v43
    v_exp_f32 v46, v46
    v_exp_f32 v47, v47
    v_cvt_pk_bf16_f32 v94, v44, v45
    v_cvt_pk_bf16_f32 v95, v46, v47
    v_mfma_f32_32x32x16_bf16 v[16:31], a[32:35], v[96:99], 0
    v_exp_f32 v48, v48
    v_exp_f32 v49, v49
    v_exp_f32 v50, v50
    v_exp_f32 v51, v51
    v_cvt_pk_bf16_f32 v80, v48, v49
    v_exp_f32 v52, v52
    v_mfma_f32_32x32x16_bf16 a[240:255], a[144:147], v[88:91], a[240:255]
    v_exp_f32 v53, v53
    v_cvt_pk_bf16_f32 v81, v50, v51
    v_exp_f32 v54, v54
    v_exp_f32 v55, v55
    v_cvt_pk_bf16_f32 v82, v52, v53
    v_exp_f32 v56, v56
    v_mfma_f32_32x32x16_bf16 v[32:47], a[32:35], v[100:103], 0
    v_exp_f32 v57, v57
    v_cvt_pk_bf16_f32 v83, v54, v55
    v_exp_f32 v58, v58
    v_exp_f32 v59, v59
    v_cvt_pk_bf16_f32 v84, v56, v57
    v_exp_f32 v60, v60
    v_mfma_f32_32x32x16_bf16 a[240:255], a[148:151], v[92:95], a[240:255]
    v_exp_f32 v61, v61
    v_cvt_pk_bf16_f32 v85, v58, v59
    v_exp_f32 v62, v62
    v_exp_f32 v63, v63
    v_cvt_pk_bf16_f32 v86, v60, v61
    v_cvt_pk_bf16_f32 v87, v62, v63
    v_mfma_f32_32x32x4_2b_bf16 v[16:47], a[80:81], v[104:105], v[16:47]
    v_exp_f32 v64, v64
    v_exp_f32 v65, v65
    v_exp_f32 v66, v66
    v_exp_f32 v67, v67
    v_cvt_pk_bf16_f32 v88, v64, v65
    v_exp_f32 v68, v68
    v_exp_f32 v69, v69
    v_cvt_pk_bf16_f32 v89, v66, v67
    v_exp_f32 v70, v70
    v_exp_f32 v71, v71
    v_mfma_f32_32x32x16_bf16 a[224:239], a[152:155], v[80:83], a[224:239]
    v_cvt_pk_bf16_f32 v90, v68, v69
    v_exp_f32 v72, v72
    v_exp_f32 v73, v73
    v_cvt_pk_bf16_f32 v91, v70, v71
    v_exp_f32 v74, v74
    v_exp_f32 v75, v75
    v_cvt_pk_bf16_f32 v92, v72, v73
    v_mfma_f32_32x32x16_bf16 a[224:239], a[156:159], v[84:87], a[224:239]
    v_exp_f32 v76, v76
    v_exp_f32 v77, v77
    v_cvt_pk_bf16_f32 v93, v74, v75
    v_exp_f32 v78, v78
    v_exp_f32 v79, v79
    v_cvt_pk_bf16_f32 v94, v76, v77
    v_cvt_pk_bf16_f32 v95, v78, v79
    s_mov_b32 s25, s68
    buffer_load_dwordx4 v12, s[20:23], s25 offen lds
    s_add_u32 m0, m0, 1024
    s_add_u32 s25, s25, s28
    v_mfma_f32_32x32x16_bf16 v[48:63], a[36:39], v[96:99], 0
    v_exp_f32 v16, v16
    v_exp_f32 v17, v17
    v_exp_f32 v18, v18
    v_exp_f32 v19, v19
    v_cvt_pk_bf16_f32 v80, v16, v17
    v_exp_f32 v20, v20
    v_mfma_f32_32x32x16_bf16 a[240:255], a[152:155], v[88:91], a[240:255]
    v_exp_f32 v21, v21
    v_cvt_pk_bf16_f32 v81, v18, v19
    v_exp_f32 v22, v22
    v_exp_f32 v23, v23
    v_cvt_pk_bf16_f32 v82, v20, v21
    v_exp_f32 v24, v24
    v_mfma_f32_32x32x16_bf16 v[64:79], a[36:39], v[100:103], 0
    v_exp_f32 v25, v25
    v_cvt_pk_bf16_f32 v83, v22, v23
    v_exp_f32 v26, v26
    v_exp_f32 v27, v27
    v_cvt_pk_bf16_f32 v84, v24, v25
    v_exp_f32 v28, v28
    v_mfma_f32_32x32x16_bf16 a[240:255], a[156:159], v[92:95], a[240:255]
    v_exp_f32 v29, v29
    v_cvt_pk_bf16_f32 v85, v26, v27
    v_exp_f32 v30, v30
    v_exp_f32 v31, v31
    v_cvt_pk_bf16_f32 v86, v28, v29
    v_cvt_pk_bf16_f32 v87, v30, v31
    v_mfma_f32_32x32x4_2b_bf16 v[48:79], a[82:83], v[104:105], v[48:79]
    v_exp_f32 v32, v32
    v_exp_f32 v33, v33
    v_exp_f32 v34, v34
    v_exp_f32 v35, v35
    v_cvt_pk_bf16_f32 v88, v32, v33
    v_exp_f32 v36, v36
    v_exp_f32 v37, v37
    v_cvt_pk_bf16_f32 v89, v34, v35
    v_exp_f32 v38, v38
    v_exp_f32 v39, v39
    v_mfma_f32_32x32x16_bf16 a[224:239], a[160:163], v[80:83], a[224:239]
    v_cvt_pk_bf16_f32 v90, v36, v37
    v_exp_f32 v40, v40
    v_exp_f32 v41, v41
    v_cvt_pk_bf16_f32 v91, v38, v39
    v_exp_f32 v42, v42
    v_exp_f32 v43, v43
    v_cvt_pk_bf16_f32 v92, v40, v41
    v_mfma_f32_32x32x16_bf16 a[224:239], a[164:167], v[84:87], a[224:239]
    v_exp_f32 v44, v44
    v_exp_f32 v45, v45
    v_cvt_pk_bf16_f32 v93, v42, v43
    v_exp_f32 v46, v46
    v_exp_f32 v47, v47
    v_cvt_pk_bf16_f32 v94, v44, v45
    v_cvt_pk_bf16_f32 v95, v46, v47
    s_bitcmp1_b32 s24, 2
    s_cbranch_scc1 L_s1
L_s1_ret:
    v_mfma_f32_32x32x16_bf16 v[16:31], a[40:43], v[96:99], 0
    v_exp_f32 v48, v48
    v_exp_f32 v49, v49
    v_exp_f32 v50, v50
    v_exp_f32 v51, v51
    v_cvt_pk_bf16_f32 v80, v48, v49
    v_exp_f32 v52, v52
    v_mfma_f32_32x32x16_bf16 a[240:255], a[160:163], v[88:91], a[240:255]
    v_exp_f32 v53, v53
    v_cvt_pk_bf16_f32 v81, v50, v51
    v_exp_f32 v54, v54
    v_exp_f32 v55, v55
    v_cvt_pk_bf16_f32 v82, v52, v53
    v_exp_f32 v56, v56
    v_mfma_f32_32x32x16_bf16 v[32:47], a[40:43], v[100:103], 0
    v_exp_f32 v57, v57
    v_cvt_pk_bf16_f32 v83, v54, v55
    v_exp_f32 v58, v58
    v_exp_f32 v59, v59
    v_cvt_pk_bf16_f32 v84, v56, v57
    v_exp_f32 v60, v60
    v_mfma_f32_32x32x16_bf16 a[240:255], a[164:167], v[92:95], a[240:255]
    v_exp_f32 v61, v61
    v_cvt_pk_bf16_f32 v85, v58, v59
    v_exp_f32 v62, v62
    v_exp_f32 v63, v63
    v_cvt_pk_bf16_f32 v86, v60, v61
    v_cvt_pk_bf16_f32 v87, v62, v63
    v_mfma_f32_32x32x4_2b_bf16 v[16:47], a[84:85], v[104:105], v[16:47]
    v_exp_f32 v64, v64
    v_exp_f32 v65, v65
    v_exp_f32 v66, v66
    v_exp_f32 v67, v67
    v_cvt_pk_bf16_f32 v88, v64, v65
    v_exp_f32 v68, v68
    v_exp_f32 v69, v69
    v_cvt_pk_bf16_f32 v89, v66, v67
    v_exp_f32 v70, v70
    v_exp_f32 v71, v71
    v_mfma_f32_32x32x16_bf16 a[224:239], a[168:171], v[80:83], a[224:239]
    v_cvt_pk_bf16_f32 v90, v68, v69
    v_exp_f32 v72, v72
    v_exp_f32 v73, v73
    v_cvt_pk_bf16_f32 v91, v70, v71
    v_exp_f32 v74, v74
    v_exp_f32 v75, v75
    v_cvt_pk_bf16_f32 v92, v72, v73
    v_mfma_f32_32x32x16_bf16 a[224:239], a[172:175], v[84:87], a[224:239]
    v_exp_f32 v76, v76
    v_exp_f32 v77, v77
    v_cvt_pk_bf16_f32 v93, v74, v75
    v_exp_f32 v78, v78
    v_exp_f32 v79, v79
    v_cvt_pk_bf16_f32 v94, v76, v77
    v_cvt_pk_bf16_f32 v95, v78, v79
    v_mfma_f32_32x32x16_bf16 v[48:63], a[44:47], v[96:99], 0
    v_exp_f32 v16, v16
    v_exp_f32 v17, v17
    v_exp_f32 v18, v18
    v_exp_f32 v19, v19
    v_cvt_pk_bf16_f32 v80, v16, v17
    v_exp_f32 v20, v20
    v_mfma_f32_32x32x16_bf16 a[240:255], a[168:171], v[88:91], a[240:255]
    v_exp_f32 v21, v21
    v_cvt_pk_bf16_f32 v81, v18, v19
    v_exp_f32 v22, v22
    v_exp_f32 v23, v23
    v_cvt_pk_bf16_f32 v82, v20, v21
    v_exp_f32 v24, v24
    v_mfma_f32_32x32x16_bf16 v[64:79], a[44:47], v[100:103], 0
    v_exp_f32 v25, v25
    v_cvt_pk_bf16_f32 v83, v22, v23
    v_exp_f32 v26, v26
    v_exp_f32 v27, v27
    v_cvt_pk_bf16_f32 v84, v24, v25
    v_exp_f32 v28, v28
    v_mfma_f32_32x32x16_bf16 a[240:255], a[172:175], v[92:95], a[240:255]
    v_exp_f32 v29, v29
    v_cvt_pk_bf16_f32 v85, v26, v27
    v_exp_f32 v30, v30
    v_exp_f32 v31, v31
    v_cvt_pk_bf16_f32 v86, v28, v29
    v_cvt_pk_bf16_f32 v87, v30, v31
    v_mfma_f32_32x32x4_2b_bf16 v[48:79], a[86:87], v[104:105], v[48:79]
    v_exp_f32 v32, v32
    v_exp_f32 v33, v33
    v_exp_f32 v34, v34
    v_exp_f32 v35, v35
    v_cvt_pk_bf16_f32 v88, v32, v33
    v_exp_f32 v36, v36
    v_exp_f32 v37, v37
    v_cvt_pk_bf16_f32 v89, v34, v35
    v_exp_f32 v38, v38
    v_exp_f32 v39, v39
    v_mfma_f32_32x32x16_bf16 a[224:239], a[176:179], v[80:83], a[224:239]
    v_cvt_pk_bf16_f32 v90, v36, v37
    v_exp_f32 v40, v40
    v_exp_f32 v41, v41
    v_cvt_pk_bf16_f32 v91, v38, v39
    v_exp_f32 v42, v42
    v_exp_f32 v43, v43
    v_cvt_pk_bf16_f32 v92, v40, v41
    v_mfma_f32_32x32x16_bf16 a[224:239], a[180:183], v[84:87], a[224:239]
    v_exp_f32 v44, v44
    v_exp_f32 v45, v45
    v_cvt_pk_bf16_f32 v93, v42, v43
    v_exp_f32 v46, v46
    v_exp_f32 v47, v47
    v_cvt_pk_bf16_f32 v94, v44, v45
    v_cvt_pk_bf16_f32 v95, v46, v47
    buffer_load_dwordx4 v12, s[20:23], s25 offen lds
    s_add_u32 m0, m0, 1024
    s_add_u32 s25, s25, s28
    v_mfma_f32_32x32x16_bf16 v[16:31], a[48:51], v[96:99], 0
    v_exp_f32 v48, v48
    v_exp_f32 v49, v49
    v_exp_f32 v50, v50
    v_exp_f32 v51, v51
    v_cvt_pk_bf16_f32 v80, v48, v49
    v_exp_f32 v52, v52
    v_mfma_f32_32x32x16_bf16 a[240:255], a[176:179], v[88:91], a[240:255]
    v_exp_f32 v53, v53
    v_cvt_pk_bf16_f32 v81, v50, v51
    v_exp_f32 v54, v54
    v_exp_f32 v55, v55
    v_cvt_pk_bf16_f32 v82, v52, v53
    v_exp_f32 v56, v56
    v_mfma_f32_32x32x16_bf16 v[32:47], a[48:51], v[100:103], 0
    v_exp_f32 v57, v57
    v_cvt_pk_bf16_f32 v83, v54, v55
    v_exp_f32 v58, v58
    v_exp_f32 v59, v59
    v_cvt_pk_bf16_f32 v84, v56, v57
    v_exp_f32 v60, v60
    v_mfma_f32_32x32x16_bf16 a[240:255], a[180:183], v[92:95], a[240:255]
    v_exp_f32 v61, v61
    v_cvt_pk_bf16_f32 v85, v58, v59
    v_exp_f32 v62, v62
    v_exp_f32 v63, v63
    v_cvt_pk_bf16_f32 v86, v60, v61
    v_cvt_pk_bf16_f32 v87, v62, v63
    v_mfma_f32_32x32x4_2b_bf16 v[16:47], a[88:89], v[104:105], v[16:47]
    v_exp_f32 v64, v64
    v_exp_f32 v65, v65
    v_exp_f32 v66, v66
    v_exp_f32 v67, v67
    v_cvt_pk_bf16_f32 v88, v64, v65
    v_exp_f32 v68, v68
    v_exp_f32 v69, v69
    v_cvt_pk_bf16_f32 v89, v66, v67
    v_exp_f32 v70, v70
    v_exp_f32 v71, v71
    v_mfma_f32_32x32x16_bf16 a[224:239], a[184:187], v[80:83], a[224:239]
    v_cvt_pk_bf16_f32 v90, v68, v69
    v_exp_f32 v72, v72
    v_exp_f32 v73, v73
    v_cvt_pk_bf16_f32 v91, v70, v71
    v_exp_f32 v74, v74
    v_exp_f32 v75, v75
    v_cvt_pk_bf16_f32 v92, v72, v73
    v_mfma_f32_32x32x16_bf16 a[224:239], a[188:191], v[84:87], a[224:239]
    v_exp_f32 v76, v76
    v_exp_f32 v77, v77
    v_cvt_pk_bf16_f32 v93, v74, v75
    v_exp_f32 v78, v78
    v_exp_f32 v79, v79
    v_cvt_pk_bf16_f32 v94, v76, v77
    v_cvt_pk_bf16_f32 v95, v78, v79
    v_mfma_f32_32x32x16_bf16 v[48:63], a[52:55], v[96:99], 0
    v_exp_f32 v16, v16
    v_exp_f32 v17, v17
    v_exp_f32 v18, v18
    v_exp_f32 v19, v19
    v_cvt_pk_bf16_f32 v80, v16, v17
    v_exp_f32 v20, v20
    v_mfma_f32_32x32x16_bf16 a[240:255], a[184:187], v[88:91], a[240:255]
    v_exp_f32 v21, v21
    v_cvt_pk_bf16_f32 v81, v18, v19
    v_exp_f32 v22, v22
    v_exp_f32 v23, v23
    v_cvt_pk_bf16_f32 v82, v20, v21
    v_exp_f32 v24, v24
    v_mfma_f32_32x32x16_bf16 v[64:79], a[52:55], v[100:103], 0
    v_exp_f32 v25, v25
    v_cvt_pk_bf16_f32 v83, v22, v23
    v_exp_f32 v26, v26
    v_exp_f32 v27, v27
    v_cvt_pk_bf16_f32 v84, v24, v25
    v_exp_f32 v28, v28
    v_mfma_f32_32x32x16_bf16 a[240:255], a[188:191], v[92:95], a[240:255]
    v_exp_f32 v29, v29
    v_cvt_pk_bf16_f32 v85, v26, v27
    v_exp_f32 v30, v30
    v_exp_f32 v31, v31
    v_cvt_pk_bf16_f32 v86, v28, v29
    v_cvt_pk_bf16_f32 v87, v30, v31
    v_mfma_f32_32x32x4_2b_bf16 v[48:79], a[90:91], v[104:105], v[48:79]
    v_exp_f32 v32, v32
    v_exp_f32 v33, v33
    v_exp_f32 v34, v34
    v_exp_f32 v35, v35
    v_cvt_pk_bf16_f32 v88, v32, v33
    v_exp_f32 v36, v36
    v_exp_f32 v37, v37
    v_cvt_pk_bf16_f32 v89, v34, v35
    v_exp_f32 v38, v38
    v_exp_f32 v39, v39
    v_mfma_f32_32x32x16_bf16 a[224:239], a[192:195], v[80:83], a[224:239]
    v_cvt_pk_bf16_f32 v90, v36, v37
    v_exp_f32 v40, v40
    v_exp_f32 v41, v41
    v_cvt_pk_bf16_f32 v91, v38, v39
    v_exp_f32 v42, v42
    v_exp_f32 v43, v43
    v_cvt_pk_bf16_f32 v92, v40, v41
    v_mfma_f32_32x32x16_bf16 a[224:239], a[196:199], v[84:87], a[224:239]
    v_exp_f32 v44, v44
    v_exp_f32 v45, v45
    v_cvt_pk_bf16_f32 v93, v42, v43
    v_exp_f32 v46, v46
    v_exp_f32 v47, v47
    v_cvt_pk_bf16_f32 v94, v44, v45
    v_cvt_pk_bf16_f32 v95, v46, v47
    s_bitcmp1_b32 s24, 2
    s_cbranch_scc1 L_s2
L_s2_ret:
    v_mfma_f32_32x32x16_bf16 v[16:31], a[56:59], v[96:99], 0
    v_exp_f32 v48, v48
    v_exp_f32 v49, v49
    v_exp_f32 v50, v50
    v_exp_f32 v51, v51
    v_cvt_pk_bf16_f32 v80, v48, v49
    v_exp_f32 v52, v52
    v_mfma_f32_32x32x16_bf16 a[240:255], a[192:195], v[88:91], a[240:255]
    v_exp_f32 v53, v53
    v_cvt_pk_bf16_f32 v81, v50, v51
    v_exp_f32 v54, v54
    v_exp_f32 v55, v55
    v_cvt_pk_bf16_f32 v82, v52, v53
    v_exp_f32 v56, v56
    ds_read_b128 v[106:109], v126 offset:384
    ds_read_b128 v[110:113], v126 offset:1408
    ds_read_b64 v[114:115], v127 offset:192
    v_mfma_f32_32x32x16_bf16 v[32:47], a[56:59], v[100:103], 0
    v_exp_f32 v57, v57
    v_cvt_pk_bf16_f32 v83, v54, v55
    v_exp_f32 v58, v58
    v_exp_f32 v59, v59
    v_cvt_pk_bf16_f32 v84, v56, v57
    v_exp_f32 v60, v60
    v_mfma_f32_32x32x16_bf16 a[240:255], a[196:199], v[92:95], a[240:255]
    v_exp_f32 v61, v61
    v_cvt_pk_bf16_f32 v85, v58, v59
    v_exp_f32 v62, v62
    v_exp_f32 v63, v63
    v_cvt_pk_bf16_f32 v86, v60, v61
    v_cvt_pk_bf16_f32 v87, v62, v63
    v_mfma_f32_32x32x4_2b_bf16 v[16:47], a[92:93], v[104:105], v[16:47]
    v_exp_f32 v64, v64
    v_exp_f32 v65, v65
    v_exp_f32 v66, v66
    v_exp_f32 v67, v67
    v_cvt_pk_bf16_f32 v88, v64, v65
    v_exp_f32 v68, v68
    v_exp_f32 v69, v69
    v_cvt_pk_bf16_f32 v89, v66, v67
    v_exp_f32 v70, v70
    v_exp_f32 v71, v71
    v_mfma_f32_32x32x16_bf16 a[224:239], a[200:203], v[80:83], a[224:239]
    v_cvt_pk_bf16_f32 v90, v68, v69
    v_exp_f32 v72, v72
    v_exp_f32 v73, v73
    v_cvt_pk_bf16_f32 v91, v70, v71
    v_exp_f32 v74, v74
    v_exp_f32 v75, v75
    v_cvt_pk_bf16_f32 v92, v72, v73
    v_mfma_f32_32x32x16_bf16 a[224:239], a[204:207], v[84:87], a[224:239]
    v_exp_f32 v76, v76
    v_exp_f32 v77, v77
    v_cvt_pk_bf16_f32 v93, v74, v75
    v_exp_f32 v78, v78
    v_exp_f32 v79, v79
    v_cvt_pk_bf16_f32 v94, v76, v77
    v_cvt_pk_bf16_f32 v95, v78, v79
    s_add_u32 s25, s25, s69
    buffer_load_dwordx4 v12, s[20:23], s25 offen lds
    s_add_u32 m0, m0, 1024
    s_add_u32 s25, s25, s28
    v_mfma_f32_32x32x16_bf16 v[48:63], a[60:63], v[96:99], 0
    v_exp_f32 v16, v16
    v_exp_f32 v17, v17
    v_exp_f32 v18, v18
    v_exp_f32 v19, v19
    v_cvt_pk_bf16_f32 v80, v16, v17
    v_exp_f32 v20, v20
    v_mfma_f32_32x32x16_bf16 a[240:255], a[200:203], v[88:91], a[240:255]
    v_exp_f32 v21, v21
    v_cvt_pk_bf16_f32 v81, v18, v19
    v_exp_f32 v22, v22
    v_exp_f32 v23, v23
    v_cvt_pk_bf16_f32 v82, v20, v21
    v_exp_f32 v24, v24
    v_mfma_f32_32x32x16_bf16 v[64:79], a[60:63], v[100:103], 0
    v_exp_f32 v25, v25
    v_cvt_pk_bf16_f32 v83, v22, v23
    v_exp_f32 v26, v26
    v_exp_f32 v27, v27
    v_cvt_pk_bf16_f32 v84, v24, v25
    v_exp_f32 v28, v28
    v_mfma_f32_32x32x16_bf16 a[240:255], a[204:207], v[92:95], a[240:255]
    v_exp_f32 v29, v29
    v_cvt_pk_bf16_f32 v85, v26, v27
    v_exp_f32 v30, v30
    v_exp_f32 v31, v31
    v_cvt_pk_bf16_f32 v86, v28, v29
    v_cvt_pk_bf16_f32 v87, v30, v31
    v_mfma_f32_32x32x4_2b_bf16 v[48:79], a[94:95], v[104:105], v[48:79]
    v_exp_f32 v32, v32
    v_exp_f32 v33, v33
    v_exp_f32 v34, v34
    v_exp_f32 v35, v35
    v_cvt_pk_bf16_f32 v88, v32, v33
    v_exp_f32 v36, v36
    v_exp_f32 v37, v37
    v_cvt_pk_bf16_f32 v89, v34, v35
    v_exp_f32 v38, v38
    v_exp_f32 v39, v39
    v_mfma_f32_32x32x16_bf16 a[224:239], a[208:211], v[80:83], a[224:239]
    v_cvt_pk_bf16_f32 v90, v36, v37
    v_exp_f32 v40, v40
    v_exp_f32 v41, v41
    v_cvt_pk_bf16_f32 v91, v38, v39
    v_exp_f32 v42, v42
    v_exp_f32 v43, v43
    v_cvt_pk_bf16_f32 v92, v40, v41
    v_mfma_f32_32x32x16_bf16 a[224:239], a[212:215], v[84:87], a[224:239]
    v_exp_f32 v44, v44
    v_exp_f32 v45, v45
    v_cvt_pk_bf16_f32 v93, v42, v43
    v_exp_f32 v46, v46
    v_exp_f32 v47, v47
    v_cvt_pk_bf16_f32 v94, v44, v45
    v_cvt_pk_bf16_f32 v95, v46, v47
    s_waitcnt lgkmcnt(0)
    v_mfma_f32_32x32x16_bf16 v[16:31], a[0:3], v[106:109], 0
    v_exp_f32 v48, v48
    v_exp_f32 v49, v49
    v_exp_f32 v50, v50
    v_exp_f32 v51, v51
    v_cvt_pk_bf16_f32 v80, v48, v49
    v_exp_f32 v52, v52
    v_mfma_f32_32x32x16_bf16 a[240:255], a[208:211], v[88:91], a[240:255]
    v_exp_f32 v53, v53
    v_cvt_pk_bf16_f32 v81, v50, v51
    v_exp_f32 v54, v54
    v_exp_f32 v55, v55
    v_cvt_pk_bf16_f32 v82, v52, v53
    v_exp_f32 v56, v56
    v_mfma_f32_32x32x16_bf16 v[32:47], a[0:3], v[110:113], 0
    v_exp_f32 v57, v57
    v_cvt_pk_bf16_f32 v83, v54, v55
    v_exp_f32 v58, v58
    v_exp_f32 v59, v59
    v_cvt_pk_bf16_f32 v84, v56, v57
    v_exp_f32 v60, v60
    v_mfma_f32_32x32x16_bf16 a[240:255], a[212:215], v[92:95], a[240:255]
    v_exp_f32 v61, v61
    v_cvt_pk_bf16_f32 v85, v58, v59
    v_exp_f32 v62, v62
    v_exp_f32 v63, v63
    v_cvt_pk_bf16_f32 v86, v60, v61
    v_cvt_pk_bf16_f32 v87, v62, v63
    v_mfma_f32_32x32x4_2b_bf16 v[16:47], a[64:65], v[114:115], v[16:47]
    v_exp_f32 v64, v64
    v_exp_f32 v65, v65
    v_exp_f32 v66, v66
    v_exp_f32 v67, v67
    v_cvt_pk_bf16_f32 v88, v64, v65
    v_exp_f32 v68, v68
    v_exp_f32 v69, v69
    v_cvt_pk_bf16_f32 v89, v66, v67
    v_exp_f32 v70, v70
    v_exp_f32 v71, v71
    v_mfma_f32_32x32x16_bf16 a[224:239], a[216:219], v[80:83], a[224:239]
    v_cvt_pk_bf16_f32 v90, v68, v69
    v_exp_f32 v72, v72
    v_exp_f32 v73, v73
    v_cvt_pk_bf16_f32 v91, v70, v71
    v_exp_f32 v74, v74
    v_exp_f32 v75, v75
    v_cvt_pk_bf16_f32 v92, v72, v73
    v_mfma_f32_32x32x16_bf16 a[224:239], a[220:223], v[84:87], a[224:239]
    v_exp_f32 v76, v76
    v_exp_f32 v77, v77
    v_cvt_pk_bf16_f32 v93, v74, v75
    v_exp_f32 v78, v78
    v_exp_f32 v79, v79
    v_cvt_pk_bf16_f32 v94, v76, v77
    v_cvt_pk_bf16_f32 v95, v78, v79
    v_mfma_f32_32x32x16_bf16 v[48:63], a[4:7], v[106:109], 0
    v_exp_f32 v16, v16
    v_exp_f32 v17, v17
    v_exp_f32 v18, v18
    v_exp_f32 v19, v19
    v_cvt_pk_bf16_f32 v80, v16, v17
    v_exp_f32 v20, v20
    v_mfma_f32_32x32x16_bf16 a[240:255], a[216:219], v[88:91], a[240:255]
    v_exp_f32 v21, v21
    v_cvt_pk_bf16_f32 v81, v18, v19
    v_exp_f32 v22, v22
    v_exp_f32 v23, v23
    v_cvt_pk_bf16_f32 v82, v20, v21
    v_exp_f32 v24, v24
    ds_write_b128 v14, a[224:227] offset:12288
    ds_write_b128 v14, a[228:231] offset:13312
    ds_write_b128 v14, a[232:235] offset:14336
    v_mfma_f32_32x32x16_bf16 v[64:79], a[4:7], v[110:113], 0
    v_exp_f32 v25, v25
    v_cvt_pk_bf16_f32 v83, v22, v23
    v_exp_f32 v26, v26
    v_exp_f32 v27, v27
    v_cvt_pk_bf16_f32 v84, v24, v25
    v_exp_f32 v28, v28
    v_mfma_f32_32x32x16_bf16 a[240:255], a[220:223], v[92:95], a[240:255]
    v_exp_f32 v29, v29
    v_cvt_pk_bf16_f32 v85, v26, v27
    v_exp_f32 v30, v30
    v_exp_f32 v31, v31
    v_cvt_pk_bf16_f32 v86, v28, v29
    v_cvt_pk_bf16_f32 v87, v30, v31
    v_mfma_f32_32x32x4_2b_bf16 v[48:79], a[66:67], v[114:115], v[48:79]
    v_exp_f32 v32, v32
    v_exp_f32 v33, v33
    v_exp_f32 v34, v34
    v_exp_f32 v35, v35
    v_cvt_pk_bf16_f32 v88, v32, v33
    v_exp_f32 v36, v36
    v_exp_f32 v37, v37
    v_cvt_pk_bf16_f32 v89, v34, v35
    v_exp_f32 v38, v38
    v_exp_f32 v39, v39
    buffer_load_dwordx4 a[0:3], v4, s[8:11], s38 offen offset:0 sc1
    v_mfma_f32_32x32x16_bf16 a[224:239], a[96:99], v[80:83], 0
    v_cvt_pk_bf16_f32 v90, v36, v37
    v_exp_f32 v40, v40
    v_exp_f32 v41, v41
    v_cvt_pk_bf16_f32 v91, v38, v39
    v_exp_f32 v42, v42
    v_exp_f32 v43, v43
    v_cvt_pk_bf16_f32 v92, v40, v41
    v_mfma_f32_32x32x16_bf16 a[224:239], a[100:103], v[84:87], a[224:239]
    v_exp_f32 v44, v44
    v_exp_f32 v45, v45
    v_cvt_pk_bf16_f32 v93, v42, v43
    v_exp_f32 v46, v46
    v_exp_f32 v47, v47
    v_cvt_pk_bf16_f32 v94, v44, v45
    v_cvt_pk_bf16_f32 v95, v46, v47
    ds_write_b128 v14, a[240:243] offset:15360
    ds_write_b128 v14, a[244:247] offset:16384
    ds_write_b128 v14, a[248:251] offset:17408
    buffer_load_dwordx4 v12, s[20:23], s25 offen lds
    s_add_u32 m0, m0, 1024
    s_add_u32 s25, s25, s28
    v_mfma_f32_32x32x16_bf16 v[16:31], a[8:11], v[106:109], 0
    v_exp_f32 v48, v48
    v_exp_f32 v49, v49
    v_exp_f32 v50, v50
    v_exp_f32 v51, v51
    v_cvt_pk_bf16_f32 v80, v48, v49
    v_exp_f32 v52, v52
    v_mfma_f32_32x32x16_bf16 a[240:255], a[96:99], v[88:91], 0
    v_exp_f32 v53, v53
    v_cvt_pk_bf16_f32 v81, v50, v51
    v_exp_f32 v54, v54
    v_exp_f32 v55, v55
    v_cvt_pk_bf16_f32 v82, v52, v53
    v_exp_f32 v56, v56
    v_mfma_f32_32x32x16_bf16 v[32:47], a[8:11], v[110:113], 0
    v_exp_f32 v57, v57
    v_cvt_pk_bf16_f32 v83, v54, v55
    v_exp_f32 v58, v58
    v_exp_f32 v59, v59
    v_cvt_pk_bf16_f32 v84, v56, v57
    v_exp_f32 v60, v60
    v_mfma_f32_32x32x16_bf16 a[240:255], a[100:103], v[92:95], a[240:255]
    v_exp_f32 v61, v61
    v_cvt_pk_bf16_f32 v85, v58, v59
    v_exp_f32 v62, v62
    v_exp_f32 v63, v63
    v_cvt_pk_bf16_f32 v86, v60, v61
    v_cvt_pk_bf16_f32 v87, v62, v63
    v_mfma_f32_32x32x4_2b_bf16 v[16:47], a[68:69], v[114:115], v[16:47]
    v_exp_f32 v64, v64
    v_exp_f32 v65, v65
    v_exp_f32 v66, v66
    v_exp_f32 v67, v67
    v_cvt_pk_bf16_f32 v88, v64, v65
    v_exp_f32 v68, v68
    v_exp_f32 v69, v69
    v_cvt_pk_bf16_f32 v89, v66, v67
    v_exp_f32 v70, v70
    v_exp_f32 v71, v71
    buffer_load_dwordx4 a[4:7], v4, s[8:11], s38 offen offset:1024 sc1
    buffer_load_dwordx4 a[64:67], v4, s[8:11], s38 offen offset:2048 sc1
    buffer_load_dwordx4 a[96:99], v4, s[8:11], s38 offen offset:3072 sc1
    buffer_load_dwordx4 a[100:103], v254, s[8:11], s38 offen offset:0 sc1
    v_mfma_f32_32x32x16_bf16 a[224:239], a[104:107], v[80:83], a[224:239]
    v_cvt_pk_bf16_f32 v90, v68, v69
    v_exp_f32 v72, v72
    v_exp_f32 v73, v73
    v_cvt_pk_bf16_f32 v91, v70, v71
    v_exp_f32 v74, v74
    v_exp_f32 v75, v75
    v_cvt_pk_bf16_f32 v92, v72, v73
    v_mfma_f32_32x32x16_bf16 a[224:239], a[108:111], v[84:87], a[224:239]
    v_exp_f32 v76, v76
    v_exp_f32 v77, v77
    v_cvt_pk_bf16_f32 v93, v74, v75
    v_exp_f32 v78, v78
    v_exp_f32 v79, v79
    v_cvt_pk_bf16_f32 v94, v76, v77
    v_cvt_pk_bf16_f32 v95, v78, v79
    v_mfma_f32_32x32x16_bf16 v[48:63], a[12:15], v[106:109], 0
    v_exp_f32 v16, v16
    v_exp_f32 v17, v17
    v_exp_f32 v18, v18
    v_exp_f32 v19, v19
    v_cvt_pk_bf16_f32 v80, v16, v17
    v_exp_f32 v20, v20
    v_mfma_f32_32x32x16_bf16 a[240:255], a[104:107], v[88:91], a[240:255]
    v_exp_f32 v21, v21
    v_cvt_pk_bf16_f32 v81, v18, v19
    v_exp_f32 v22, v22
    v_exp_f32 v23, v23
    v_cvt_pk_bf16_f32 v82, v20, v21
    v_exp_f32 v24, v24
    v_mfma_f32_32x32x16_bf16 v[64:79], a[12:15], v[110:113], 0
    v_exp_f32 v25, v25
    v_cvt_pk_bf16_f32 v83, v22, v23
    v_exp_f32 v26, v26
    v_exp_f32 v27, v27
    v_cvt_pk_bf16_f32 v84, v24, v25
    v_exp_f32 v28, v28
    v_mfma_f32_32x32x16_bf16 a[240:255], a[108:111], v[92:95], a[240:255]
    v_exp_f32 v29, v29
    v_cvt_pk_bf16_f32 v85, v26, v27
    v_exp_f32 v30, v30
    v_exp_f32 v31, v31
    v_cvt_pk_bf16_f32 v86, v28, v29
    v_cvt_pk_bf16_f32 v87, v30, v31
    v_mfma_f32_32x32x4_2b_bf16 v[48:79], a[70:71], v[114:115], v[48:79]
    v_exp_f32 v32, v32
    v_exp_f32 v33, v33
    v_exp_f32 v34, v34
    v_exp_f32 v35, v35
    v_cvt_pk_bf16_f32 v88, v32, v33
    v_exp_f32 v36, v36
    v_exp_f32 v37, v37
    v_cvt_pk_bf16_f32 v89, v34, v35
    v_exp_f32 v38, v38
    v_exp_f32 v39, v39
    buffer_load_dwordx4 a[8:11], v254, s[8:11], s38 offen offset:1024 sc1
    buffer_load_dwordx4 a[104:107], v254, s[8:11], s38 offen offset:2048 sc1
    buffer_load_dwordx4 a[108:111], v254, s[8:11], s38 offen offset:3072 sc1
    v_mfma_f32_32x32x16_bf16 a[224:239], a[112:115], v[80:83], a[224:239]
    v_cvt_pk_bf16_f32 v90, v36, v37
    v_exp_f32 v40, v40
    v_exp_f32 v41, v41
    v_cvt_pk_bf16_f32 v91, v38, v39
    v_exp_f32 v42, v42
    v_exp_f32 v43, v43
    v_cvt_pk_bf16_f32 v92, v40, v41
    v_mfma_f32_32x32x16_bf16 a[224:239], a[116:119], v[84:87], a[224:239]
    v_exp_f32 v44, v44
    v_exp_f32 v45, v45
    v_cvt_pk_bf16_f32 v93, v42, v43
    v_exp_f32 v46, v46
    v_exp_f32 v47, v47
    v_cvt_pk_bf16_f32 v94, v44, v45
    v_cvt_pk_bf16_f32 v95, v46, v47
    v_mfma_f32_32x32x16_bf16 v[16:31], a[16:19], v[106:109], 0
    v_exp_f32 v48, v48
    v_exp_f32 v49, v49
    v_exp_f32 v50, v50
    v_exp_f32 v51, v51
    v_cvt_pk_bf16_f32 v80, v48, v49
    v_exp_f32 v52, v52
    v_mfma_f32_32x32x16_bf16 a[240:255], a[112:115], v[88:91], a[240:255]
    v_exp_f32 v53, v53
    v_cvt_pk_bf16_f32 v81, v50, v51
    v_exp_f32 v54, v54
    v_exp_f32 v55, v55
    v_cvt_pk_bf16_f32 v82, v52, v53
    v_exp_f32 v56, v56
    v_mfma_f32_32x32x16_bf16 v[32:47], a[16:19], v[110:113], 0
    v_exp_f32 v57, v57
    v_cvt_pk_bf16_f32 v83, v54, v55
    v_exp_f32 v58, v58
    v_exp_f32 v59, v59
    v_cvt_pk_bf16_f32 v84, v56, v57
    v_exp_f32 v60, v60
    v_mfma_f32_32x32x16_bf16 a[240:255], a[116:119], v[92:95], a[240:255]
    v_exp_f32 v61, v61
    v_cvt_pk_bf16_f32 v85, v58, v59
    v_exp_f32 v62, v62
    v_exp_f32 v63, v63
    v_cvt_pk_bf16_f32 v86, v60, v61
    v_cvt_pk_bf16_f32 v87, v62, v63
    v_mfma_f32_32x32x4_2b_bf16 v[16:47], a[72:73], v[114:115], v[16:47]
    v_exp_f32 v64, v64
    v_exp_f32 v65, v65
    v_exp_f32 v66, v66
    v_exp_f32 v67, v67
    v_cvt_pk_bf16_f32 v88, v64, v65
    v_exp_f32 v68, v68
    v_exp_f32 v69, v69
    v_cvt_pk_bf16_f32 v89, v66, v67
    v_exp_f32 v70, v70
    v_exp_f32 v71, v71
    buffer_load_dwordx4 a[12:15], v255, s[8:11], s38 offen offset:0 sc1
    buffer_load_dwordx4 a[68:71], v255, s[8:11], s38 offen offset:1024 sc1
    buffer_load_dwordx4 a[112:115], v4, s[8:11], s34 offen offset:0 sc1
    buffer_load_dwordx4 a[116:119], v4, s[8:11], s34 offen offset:1024 sc1
    v_mfma_f32_32x32x16_bf16 a[224:239], a[120:123], v[80:83], a[224:239]
    v_cvt_pk_bf16_f32 v90, v68, v69
    v_exp_f32 v72, v72
    v_exp_f32 v73, v73
    v_cvt_pk_bf16_f32 v91, v70, v71
    v_exp_f32 v74, v74
    v_exp_f32 v75, v75
    v_cvt_pk_bf16_f32 v92, v72, v73
    v_mfma_f32_32x32x16_bf16 a[224:239], a[124:127], v[84:87], a[224:239]
    v_exp_f32 v76, v76
    v_exp_f32 v77, v77
    v_cvt_pk_bf16_f32 v93, v74, v75
    v_exp_f32 v78, v78
    v_exp_f32 v79, v79
    v_cvt_pk_bf16_f32 v94, v76, v77
    v_cvt_pk_bf16_f32 v95, v78, v79
    buffer_load_dwordx4 v12, s[20:23], s25 offen lds
    s_add_u32 m0, m0, 1024
    s_add_u32 s25, s25, s28
    v_mfma_f32_32x32x16_bf16 v[48:63], a[20:23], v[106:109], 0
    v_exp_f32 v16, v16
    v_exp_f32 v17, v17
    v_exp_f32 v18, v18
    v_exp_f32 v19, v19
    v_cvt_pk_bf16_f32 v80, v16, v17
    v_exp_f32 v20, v20
    v_mfma_f32_32x32x16_bf16 a[240:255], a[120:123], v[88:91], a[240:255]
    v_exp_f32 v21, v21
    v_cvt_pk_bf16_f32 v81, v18, v19
    v_exp_f32 v22, v22
    v_exp_f32 v23, v23
    v_cvt_pk_bf16_f32 v82, v20, v21
    v_exp_f32 v24, v24
    v_mfma_f32_32x32x16_bf16 v[64:79], a[20:23], v[110:113], 0
    v_exp_f32 v25, v25
    v_cvt_pk_bf16_f32 v83, v22, v23
    v_exp_f32 v26, v26
    v_exp_f32 v27, v27
    v_cvt_pk_bf16_f32 v84, v24, v25
    v_exp_f32 v28, v28
    v_mfma_f32_32x32x16_bf16 a[240:255], a[124:127], v[92:95], a[240:255]
    v_exp_f32 v29, v29
    v_cvt_pk_bf16_f32 v85, v26, v27
    v_exp_f32 v30, v30
    v_exp_f32 v31, v31
    v_cvt_pk_bf16_f32 v86, v28, v29
    v_cvt_pk_bf16_f32 v87, v30, v31
    v_mfma_f32_32x32x4_2b_bf16 v[48:79], a[74:75], v[114:115], v[48:79]
    v_exp_f32 v32, v32
    v_exp_f32 v33, v33
    v_exp_f32 v34, v34
    v_exp_f32 v35, v35
    v_cvt_pk_bf16_f32 v88, v32, v33
    v_exp_f32 v36, v36
    v_exp_f32 v37, v37
    v_cvt_pk_bf16_f32 v89, v34, v35
    v_exp_f32 v38, v38
    v_exp_f32 v39, v39
    buffer_load_dwordx4 a[16:19], v4, s[8:11], s34 offen offset:2048 sc1
    buffer_load_dwordx4 a[120:123], v4, s[8:11], s34 offen offset:3072 sc1
    buffer_load_dwordx4 a[124:127], v254, s[8:11], s34 offen offset:0 sc1
    v_mfma_f32_32x32x16_bf16 a[224:239], a[128:131], v[80:83], a[224:239]
    v_cvt_pk_bf16_f32 v90, v36, v37
    v_exp_f32 v40, v40
    v_exp_f32 v41, v41
    v_cvt_pk_bf16_f32 v91, v38, v39
    v_exp_f32 v42, v42
    v_exp_f32 v43, v43
    v_cvt_pk_bf16_f32 v92, v40, v41
    v_mfma_f32_32x32x16_bf16 a[224:239], a[132:135], v[84:87], a[224:239]
    v_exp_f32 v44, v44
    v_exp_f32 v45, v45
    v_cvt_pk_bf16_f32 v93, v42, v43
    v_exp_f32 v46, v46
    v_exp_f32 v47, v47
    v_cvt_pk_bf16_f32 v94, v44, v45
    v_cvt_pk_bf16_f32 v95, v46, v47
    v_mfma_f32_32x32x16_bf16 v[16:31], a[24:27], v[106:109], 0
    v_exp_f32 v48, v48
    v_exp_f32 v49, v49
    v_exp_f32 v50, v50
    v_exp_f32 v51, v51
    v_cvt_pk_bf16_f32 v80, v48, v49
    v_exp_f32 v52, v52
    v_mfma_f32_32x32x16_bf16 a[240:255], a[128:131], v[88:91], a[240:255]
    v_exp_f32 v53, v53
    v_cvt_pk_bf16_f32 v81, v50, v51
    v_exp_f32 v54, v54
    v_exp_f32 v55, v55
    v_cvt_pk_bf16_f32 v82, v52, v53
    v_exp_f32 v56, v56
    v_mfma_f32_32x32x16_bf16 v[32:47], a[24:27], v[110:113], 0
    v_exp_f32 v57, v57
    v_cvt_pk_bf16_f32 v83, v54, v55
    v_exp_f32 v58, v58
    v_exp_f32 v59, v59
    v_cvt_pk_bf16_f32 v84, v56, v57
    v_exp_f32 v60, v60
    v_mfma_f32_32x32x16_bf16 a[240:255], a[132:135], v[92:95], a[240:255]
    v_exp_f32 v61, v61
    v_cvt_pk_bf16_f32 v85, v58, v59
    v_exp_f32 v62, v62
    v_exp_f32 v63, v63
    v_cvt_pk_bf16_f32 v86, v60, v61
    v_cvt_pk_bf16_f32 v87, v62, v63
    v_mfma_f32_32x32x4_2b_bf16 v[16:47], a[76:77], v[114:115], v[16:47]
    v_exp_f32 v64, v64
    v_exp_f32 v65, v65
    v_exp_f32 v66, v66
    v_exp_f32 v67, v67
    v_cvt_pk_bf16_f32 v88, v64, v65
    v_exp_f32 v68, v68
    v_exp_f32 v69, v69
    v_cvt_pk_bf16_f32 v89, v66, v67
    v_exp_f32 v70, v70
    v_exp_f32 v71, v71
    buffer_load_dwordx4 a[20:23], v254, s[8:11], s34 offen offset:1024 sc1
    buffer_load_dwordx4 a[72:75], v254, s[8:11], s34 offen offset:2048 sc1
    buffer_load_dwordx4 a[128:131], v254, s[8:11], s34 offen offset:3072 sc1
    buffer_load_dwordx4 a[132:135], v255, s[8:11], s34 offen offset:0 sc1
    v_mfma_f32_32x32x16_bf16 a[224:239], a[136:139], v[80:83], a[224:239]
    v_cvt_pk_bf16_f32 v90, v68, v69
    v_exp_f32 v72, v72
    v_exp_f32 v73, v73
    v_cvt_pk_bf16_f32 v91, v70, v71
    v_exp_f32 v74, v74
    v_exp_f32 v75, v75
    v_cvt_pk_bf16_f32 v92, v72, v73
    v_mfma_f32_32x32x16_bf16 a[224:239], a[140:143], v[84:87], a[224:239]
    v_exp_f32 v76, v76
    v_exp_f32 v77, v77
    v_cvt_pk_bf16_f32 v93, v74, v75
    v_exp_f32 v78, v78
    v_exp_f32 v79, v79
    v_cvt_pk_bf16_f32 v94, v76, v77
    v_cvt_pk_bf16_f32 v95, v78, v79
    v_mfma_f32_32x32x16_bf16 v[48:63], a[28:31], v[106:109], 0
    v_exp_f32 v16, v16
    v_exp_f32 v17, v17
    v_exp_f32 v18, v18
    v_exp_f32 v19, v19
    v_cvt_pk_bf16_f32 v80, v16, v17
    v_exp_f32 v20, v20
    v_mfma_f32_32x32x16_bf16 a[240:255], a[136:139], v[88:91], a[240:255]
    v_exp_f32 v21, v21
    v_cvt_pk_bf16_f32 v81, v18, v19
    v_exp_f32 v22, v22
    v_exp_f32 v23, v23
    v_cvt_pk_bf16_f32 v82, v20, v21
    v_exp_f32 v24, v24
    v_mfma_f32_32x32x16_bf16 v[64:79], a[28:31], v[110:113], 0
    v_exp_f32 v25, v25
    v_cvt_pk_bf16_f32 v83, v22, v23
    v_exp_f32 v26, v26
    v_exp_f32 v27, v27
    v_cvt_pk_bf16_f32 v84, v24, v25
    v_exp_f32 v28, v28
    v_mfma_f32_32x32x16_bf16 a[240:255], a[140:143], v[92:95], a[240:255]
    v_exp_f32 v29, v29
    v_cvt_pk_bf16_f32 v85, v26, v27
    v_exp_f32 v30, v30
    v_exp_f32 v31, v31
    v_cvt_pk_bf16_f32 v86, v28, v29
    v_cvt_pk_bf16_f32 v87, v30, v31
    v_mfma_f32_32x32x4_2b_bf16 v[48:79], a[78:79], v[114:115], v[48:79]
    v_exp_f32 v32, v32
    v_exp_f32 v33, v33
    v_exp_f32 v34, v34
    v_exp_f32 v35, v35
    v_cvt_pk_bf16_f32 v88, v32, v33
    v_exp_f32 v36, v36
    v_exp_f32 v37, v37
    v_cvt_pk_bf16_f32 v89, v34, v35
    v_exp_f32 v38, v38
    v_exp_f32 v39, v39
    buffer_load_dwordx4 a[24:27], v255, s[8:11], s34 offen offset:1024 sc1
    buffer_load_dwordx4 a[136:139], v4, s[8:11], s35 offen offset:0 sc1
    buffer_load_dwordx4 a[140:143], v4, s[8:11], s35 offen offset:1024 sc1
    v_mfma_f32_32x32x16_bf16 a[224:239], a[144:147], v[80:83], a[224:239]
    v_cvt_pk_bf16_f32 v90, v36, v37
    v_exp_f32 v40, v40
    v_exp_f32 v41, v41
    v_cvt_pk_bf16_f32 v91, v38, v39
    v_exp_f32 v42, v42
    v_exp_f32 v43, v43
    v_cvt_pk_bf16_f32 v92, v40, v41
    v_mfma_f32_32x32x16_bf16 a[224:239], a[148:151], v[84:87], a[224:239]
    v_exp_f32 v44, v44
    v_exp_f32 v45, v45
    v_cvt_pk_bf16_f32 v93, v42, v43
    v_exp_f32 v46, v46
    v_exp_f32 v47, v47
    v_cvt_pk_bf16_f32 v94, v44, v45
    v_cvt_pk_bf16_f32 v95, v46, v47
    v_mfma_f32_32x32x16_bf16 v[16:31], a[32:35], v[106:109], 0
    v_exp_f32 v48, v48
    v_exp_f32 v49, v49
    v_exp_f32 v50, v50
    v_exp_f32 v51, v51
    v_cvt_pk_bf16_f32 v80, v48, v49
    v_exp_f32 v52, v52
    v_mfma_f32_32x32x16_bf16 a[240:255], a[144:147], v[88:91], a[240:255]
    v_exp_f32 v53, v53
    v_cvt_pk_bf16_f32 v81, v50, v51
    v_exp_f32 v54, v54
    v_exp_f32 v55, v55
    v_cvt_pk_bf16_f32 v82, v52, v53
    v_exp_f32 v56, v56
    v_mfma_f32_32x32x16_bf16 v[32:47], a[32:35], v[110:113], 0
    v_exp_f32 v57, v57
    v_cvt_pk_bf16_f32 v83, v54, v55
    v_exp_f32 v58, v58
    v_exp_f32 v59, v59
    v_cvt_pk_bf16_f32 v84, v56, v57
    v_exp_f32 v60, v60
    v_mfma_f32_32x32x16_bf16 a[240:255], a[148:151], v[92:95], a[240:255]
    v_exp_f32 v61, v61
    v_cvt_pk_bf16_f32 v85, v58, v59
    v_exp_f32 v62, v62
    v_exp_f32 v63, v63
    v_cvt_pk_bf16_f32 v86, v60, v61
    v_cvt_pk_bf16_f32 v87, v62, v63
    v_mfma_f32_32x32x4_2b_bf16 v[16:47], a[80:81], v[114:115], v[16:47]
    v_exp_f32 v64, v64
    v_exp_f32 v65, v65
    v_exp_f32 v66, v66
    v_exp_f32 v67, v67
    v_cvt_pk_bf16_f32 v88, v64, v65
    v_exp_f32 v68, v68
    v_exp_f32 v69, v69
    v_cvt_pk_bf16_f32 v89, v66, v67
    v_exp_f32 v70, v70
    v_exp_f32 v71, v71
    buffer_load_dwordx4 a[28:31], v4, s[8:11], s35 offen offset:2048 sc1
    buffer_load_dwordx4 a[76:79], v4, s[8:11], s35 offen offset:3072 sc1
    buffer_load_dwordx4 a[144:147], v254, s[8:11], s35 offen offset:0 sc1
    buffer_load_dwordx4 a[148:151], v254, s[8:11], s35 offen offset:1024 sc1
    v_mfma_f32_32x32x16_bf16 a[224:239], a[152:155], v[80:83], a[224:239]
    v_cvt_pk_bf16_f32 v90, v68, v69
    v_exp_f32 v72, v72
    v_exp_f32 v73, v73
    v_cvt_pk_bf16_f32 v91, v70, v71
    v_exp_f32 v74, v74
    v_exp_f32 v75, v75
    v_cvt_pk_bf16_f32 v92, v72, v73
    v_mfma_f32_32x32x16_bf16 a[224:239], a[156:159], v[84:87], a[224:239]
    v_exp_f32 v76, v76
    v_exp_f32 v77, v77
    v_cvt_pk_bf16_f32 v93, v74, v75
    v_exp_f32 v78, v78
    v_exp_f32 v79, v79
    v_cvt_pk_bf16_f32 v94, v76, v77
    v_cvt_pk_bf16_f32 v95, v78, v79
    v_mfma_f32_32x32x16_bf16 v[48:63], a[36:39], v[106:109], 0
    v_exp_f32 v16, v16
    v_exp_f32 v17, v17
    v_exp_f32 v18, v18
    v_exp_f32 v19, v19
    v_cvt_pk_bf16_f32 v80, v16, v17
    v_exp_f32 v20, v20
    v_mfma_f32_32x32x16_bf16 a[240:255], a[152:155], v[88:91], a[240:255]
    v_exp_f32 v21, v21
    v_cvt_pk_bf16_f32 v81, v18, v19
    v_exp_f32 v22, v22
    v_exp_f32 v23, v23
    v_cvt_pk_bf16_f32 v82, v20, v21
    v_exp_f32 v24, v24
    v_mfma_f32_32x32x16_bf16 v[64:79], a[36:39], v[110:113], 0
    v_exp_f32 v25, v25
    v_cvt_pk_bf16_f32 v83, v22, v23
    v_exp_f32 v26, v26
    v_exp_f32 v27, v27
    v_cvt_pk_bf16_f32 v84, v24, v25
    v_exp_f32 v28, v28
    v_mfma_f32_32x32x16_bf16 a[240:255], a[156:159], v[92:95], a[240:255]
    v_exp_f32 v29, v29
    v_cvt_pk_bf16_f32 v85, v26, v27
    v_exp_f32 v30, v30
    v_exp_f32 v31, v31
    v_cvt_pk_bf16_f32 v86, v28, v29
    v_cvt_pk_bf16_f32 v87, v30, v31
    v_mfma_f32_32x32x4_2b_bf16 v[48:79], a[82:83], v[114:115], v[48:79]
    v_exp_f32 v32, v32
    v_exp_f32 v33, v33
    v_exp_f32 v34, v34
    v_exp_f32 v35, v35
    v_cvt_pk_bf16_f32 v88, v32, v33
    v_exp_f32 v36, v36
    v_exp_f32 v37, v37
    v_cvt_pk_bf16_f32 v89, v34, v35
    v_exp_f32 v38, v38
    v_exp_f32 v39, v39
    buffer_load_dwordx4 a[32:35], v254, s[8:11], s35 offen offset:2048 sc1
    buffer_load_dwordx4 a[152:155], v254, s[8:11], s35 offen offset:3072 sc1
    buffer_load_dwordx4 a[156:159], v255, s[8:11], s35 offen offset:0 sc1
    v_mfma_f32_32x32x16_bf16 a[224:239], a[160:163], v[80:83], a[224:239]
    v_cvt_pk_bf16_f32 v90, v36, v37
    v_exp_f32 v40, v40
    v_exp_f32 v41, v41
    v_cvt_pk_bf16_f32 v91, v38, v39
    v_exp_f32 v42, v42
    v_exp_f32 v43, v43
    v_cvt_pk_bf16_f32 v92, v40, v41
    v_mfma_f32_32x32x16_bf16 a[224:239], a[164:167], v[84:87], a[224:239]
    v_exp_f32 v44, v44
    v_exp_f32 v45, v45
    v_cvt_pk_bf16_f32 v93, v42, v43
    v_exp_f32 v46, v46
    v_exp_f32 v47, v47
    v_cvt_pk_bf16_f32 v94, v44, v45
    v_cvt_pk_bf16_f32 v95, v46, v47
    v_mfma_f32_32x32x16_bf16 v[16:31], a[40:43], v[106:109], 0
    v_exp_f32 v48, v48
    v_exp_f32 v49, v49
    v_exp_f32 v50, v50
    v_exp_f32 v51, v51
    v_cvt_pk_bf16_f32 v80, v48, v49
    v_exp_f32 v52, v52
    v_mfma_f32_32x32x16_bf16 a[240:255], a[160:163], v[88:91], a[240:255]
    v_exp_f32 v53, v53
    v_cvt_pk_bf16_f32 v81, v50, v51
    v_exp_f32 v54, v54
    v_exp_f32 v55, v55
    v_cvt_pk_bf16_f32 v82, v52, v53
    v_exp_f32 v56, v56
    v_mfma_f32_32x32x16_bf16 v[32:47], a[40:43], v[110:113], 0
    v_exp_f32 v57, v57
    v_cvt_pk_bf16_f32 v83, v54, v55
    v_exp_f32 v58, v58
    v_exp_f32 v59, v59
    v_cvt_pk_bf16_f32 v84, v56, v57
    v_exp_f32 v60, v60
    v_mfma_f32_32x32x16_bf16 a[240:255], a[164:167], v[92:95], a[240:255]
    v_exp_f32 v61, v61
    v_cvt_pk_bf16_f32 v85, v58, v59
    v_exp_f32 v62, v62
    v_exp_f32 v63, v63
    v_cvt_pk_bf16_f32 v86, v60, v61
    v_cvt_pk_bf16_f32 v87, v62, v63
    v_mfma_f32_32x32x4_2b_bf16 v[16:47], a[84:85], v[114:115], v[16:47]
    v_exp_f32 v64, v64
    v_exp_f32 v65, v65
    v_exp_f32 v66, v66
    v_exp_f32 v67, v67
    v_cvt_pk_bf16_f32 v88, v64, v65
    v_exp_f32 v68, v68
    v_exp_f32 v69, v69
    v_cvt_pk_bf16_f32 v89, v66, v67
    v_exp_f32 v70, v70
    v_exp_f32 v71, v71
    buffer_load_dwordx4 a[36:39], v255, s[8:11], s35 offen offset:1024 sc1
    buffer_load_dwordx4 a[80:83], v4, s[8:11], s36 offen offset:0 sc1
    buffer_load_dwordx4 a[160:163], v4, s[8:11], s36 offen offset:1024 sc1
    buffer_load_dwordx4 a[164:167], v4, s[8:11], s36 offen offset:2048 sc1
    v_mfma_f32_32x32x16_bf16 a[224:239], a[168:171], v[80:83], a[224:239]
    v_cvt_pk_bf16_f32 v90, v68, v69
    v_exp_f32 v72, v72
    v_exp_f32 v73, v73
    v_cvt_pk_bf16_f32 v91, v70, v71
    v_exp_f32 v74, v74
    v_exp_f32 v75, v75
    v_cvt_pk_bf16_f32 v92, v72, v73
    v_mfma_f32_32x32x16_bf16 a[224:239], a[172:175], v[84:87], a[224:239]
    v_exp_f32 v76, v76
    v_exp_f32 v77, v77
    v_cvt_pk_bf16_f32 v93, v74, v75
    v_exp_f32 v78, v78
    v_exp_f32 v79, v79
    v_cvt_pk_bf16_f32 v94, v76, v77
    v_cvt_pk_bf16_f32 v95, v78, v79
    v_mfma_f32_32x32x16_bf16 v[48:63], a[44:47], v[106:109], 0
    v_exp_f32 v16, v16
    v_exp_f32 v17, v17
    v_exp_f32 v18, v18
    v_exp_f32 v19, v19
    v_cvt_pk_bf16_f32 v80, v16, v17
    v_exp_f32 v20, v20
    v_mfma_f32_32x32x16_bf16 a[240:255], a[168:171], v[88:91], a[240:255]
    v_exp_f32 v21, v21
    v_cvt_pk_bf16_f32 v81, v18, v19
    v_exp_f32 v22, v22
    v_exp_f32 v23, v23
    v_cvt_pk_bf16_f32 v82, v20, v21
    v_exp_f32 v24, v24
    v_mfma_f32_32x32x16_bf16 v[64:79], a[44:47], v[110:113], 0
    v_exp_f32 v25, v25
    v_cvt_pk_bf16_f32 v83, v22, v23
    v_exp_f32 v26, v26
    v_exp_f32 v27, v27
    v_cvt_pk_bf16_f32 v84, v24, v25
    v_exp_f32 v28, v28
    v_mfma_f32_32x32x16_bf16 a[240:255], a[172:175], v[92:95], a[240:255]
    v_exp_f32 v29, v29
    v_cvt_pk_bf16_f32 v85, v26, v27
    v_exp_f32 v30, v30
    v_exp_f32 v31, v31
    v_cvt_pk_bf16_f32 v86, v28, v29
    v_cvt_pk_bf16_f32 v87, v30, v31
    v_mfma_f32_32x32x4_2b_bf16 v[48:79], a[86:87], v[114:115], v[48:79]
    v_exp_f32 v32, v32
    v_exp_f32 v33, v33
    v_exp_f32 v34, v34
    v_exp_f32 v35, v35
    v_cvt_pk_bf16_f32 v88, v32, v33
    v_exp_f32 v36, v36
    v_exp_f32 v37, v37
    v_cvt_pk_bf16_f32 v89, v34, v35
    v_exp_f32 v38, v38
    v_exp_f32 v39, v39
    buffer_load_dwordx4 a[40:43], v4, s[8:11], s36 offen offset:3072 sc1
    buffer_load_dwordx4 a[168:171], v254, s[8:11], s36 offen offset:0 sc1
    buffer_load_dwordx4 a[172:175], v254, s[8:11], s36 offen offset:1024 sc1
    v_mfma_f32_32x32x16_bf16 a[224:239], a[176:179], v[80:83], a[224:239]
    v_cvt_pk_bf16_f32 v90, v36, v37
    v_exp_f32 v40, v40
    v_exp_f32 v41, v41
    v_cvt_pk_bf16_f32 v91, v38, v39
    v_exp_f32 v42, v42
    v_exp_f32 v43, v43
    v_cvt_pk_bf16_f32 v92, v40, v41
    v_mfma_f32_32x32x16_bf16 a[224:239], a[180:183], v[84:87], a[224:239]
    v_exp_f32 v44, v44
    v_exp_f32 v45, v45
    v_cvt_pk_bf16_f32 v93, v42, v43
    v_exp_f32 v46, v46
    v_exp_f32 v47, v47
    v_cvt_pk_bf16_f32 v94, v44, v45
    v_cvt_pk_bf16_f32 v95, v46, v47
    s_bitcmp1_b32 s24, 3
    s_cbranch_scc1 L_lt1
L_lt1_ret:
    v_mfma_f32_32x32x16_bf16 v[16:31], a[48:51], v[106:109], 0
    v_exp_f32 v48, v48
    v_exp_f32 v49, v49
    v_exp_f32 v50, v50
    v_exp_f32 v51, v51
    v_cvt_pk_bf16_f32 v80, v48, v49
    v_exp_f32 v52, v52
    v_mfma_f32_32x32x16_bf16 a[240:255], a[176:179], v[88:91], a[240:255]
    v_exp_f32 v53, v53
    v_cvt_pk_bf16_f32 v81, v50, v51
    v_exp_f32 v54, v54
    v_exp_f32 v55, v55
    v_cvt_pk_bf16_f32 v82, v52, v53
    v_exp_f32 v56, v56
    v_mfma_f32_32x32x16_bf16 v[32:47], a[48:51], v[110:113], 0
    v_exp_f32 v57, v57
    v_cvt_pk_bf16_f32 v83, v54, v55
    v_exp_f32 v58, v58
    v_exp_f32 v59, v59
    v_cvt_pk_bf16_f32 v84, v56, v57
    v_exp_f32 v60, v60
    v_mfma_f32_32x32x16_bf16 a[240:255], a[180:183], v[92:95], a[240:255]
    v_exp_f32 v61, v61
    v_cvt_pk_bf16_f32 v85, v58, v59
    v_exp_f32 v62, v62
    v_exp_f32 v63, v63
    v_cvt_pk_bf16_f32 v86, v60, v61
    v_cvt_pk_bf16_f32 v87, v62, v63
    v_mfma_f32_32x32x4_2b_bf16 v[16:47], a[88:89], v[114:115], v[16:47]
    v_exp_f32 v64, v64
    v_exp_f32 v65, v65
    v_exp_f32 v66, v66
    v_exp_f32 v67, v67
    v_cvt_pk_bf16_f32 v88, v64, v65
    v_exp_f32 v68, v68
    v_exp_f32 v69, v69
    v_cvt_pk_bf16_f32 v89, v66, v67
    v_exp_f32 v70, v70
    v_exp_f32 v71, v71
    buffer_load_dwordx4 a[44:47], v254, s[8:11], s36 offen offset:2048 sc1
    buffer_load_dwordx4 a[84:87], v254, s[8:11], s36 offen offset:3072 sc1
    buffer_load_dwordx4 a[176:179], v255, s[8:11], s36 offen offset:0 sc1
    buffer_load_dwordx4 a[180:183], v255, s[8:11], s36 offen offset:1024 sc1
    v_mfma_f32_32x32x16_bf16 a[224:239], a[184:187], v[80:83], a[224:239]
    v_cvt_pk_bf16_f32 v90, v68, v69
    v_exp_f32 v72, v72
    v_exp_f32 v73, v73
    v_cvt_pk_bf16_f32 v91, v70, v71
    v_exp_f32 v74, v74
    v_exp_f32 v75, v75
    v_cvt_pk_bf16_f32 v92, v72, v73
    v_mfma_f32_32x32x16_bf16 a[224:239], a[188:191], v[84:87], a[224:239]
    v_exp_f32 v76, v76
    v_exp_f32 v77, v77
    v_cvt_pk_bf16_f32 v93, v74, v75
    v_exp_f32 v78, v78
    v_exp_f32 v79, v79
    v_cvt_pk_bf16_f32 v94, v76, v77
    v_cvt_pk_bf16_f32 v95, v78, v79
    v_mfma_f32_32x32x16_bf16 v[48:63], a[52:55], v[106:109], 0
    v_exp_f32 v16, v16
    v_exp_f32 v17, v17
    v_exp_f32 v18, v18
    v_exp_f32 v19, v19
    v_cvt_pk_bf16_f32 v80, v16, v17
    v_exp_f32 v20, v20
    v_mfma_f32_32x32x16_bf16 a[240:255], a[184:187], v[88:91], a[240:255]
    v_exp_f32 v21, v21
    v_cvt_pk_bf16_f32 v81, v18, v19
    v_exp_f32 v22, v22
    v_exp_f32 v23, v23
    v_cvt_pk_bf16_f32 v82, v20, v21
    v_exp_f32 v24, v24
    v_mfma_f32_32x32x16_bf16 v[64:79], a[52:55], v[110:113], 0
    v_exp_f32 v25, v25
    v_cvt_pk_bf16_f32 v83, v22, v23
    v_exp_f32 v26, v26
    v_exp_f32 v27, v27
    v_cvt_pk_bf16_f32 v84, v24, v25
    v_exp_f32 v28, v28
    v_mfma_f32_32x32x16_bf16 a[240:255], a[188:191], v[92:95], a[240:255]
    v_exp_f32 v29, v29
    v_cvt_pk_bf16_f32 v85, v26, v27
    v_exp_f32 v30, v30
    v_exp_f32 v31, v31
    v_cvt_pk_bf16_f32 v86, v28, v29
    v_cvt_pk_bf16_f32 v87, v30, v31
    v_mfma_f32_32x32x4_2b_bf16 v[48:79], a[90:91], v[114:115], v[48:79]
    v_exp_f32 v32, v32
    v_exp_f32 v33, v33
    v_exp_f32 v34, v34
    v_exp_f32 v35, v35
    v_cvt_pk_bf16_f32 v88, v32, v33
    v_exp_f32 v36, v36
    v_exp_f32 v37, v37
    v_cvt_pk_bf16_f32 v89, v34, v35
    v_exp_f32 v38, v38
    v_exp_f32 v39, v39
    buffer_load_dwordx4 a[48:51], v4, s[8:11], s37 offen offset:0 sc1
    buffer_load_dwordx4 a[184:187], v4, s[8:11], s37 offen offset:1024 sc1
    buffer_load_dwordx4 a[188:191], v4, s[8:11], s37 offen offset:2048 sc1
    v_mfma_f32_32x32x16_bf16 a[224:239], a[192:195], v[80:83], a[224:239]
    v_cvt_pk_bf16_f32 v90, v36, v37
    v_exp_f32 v40, v40
    v_exp_f32 v41, v41
    v_cvt_pk_bf16_f32 v91, v38, v39
    v_exp_f32 v42, v42
    v_exp_f32 v43, v43
    v_cvt_pk_bf16_f32 v92, v40, v41
    v_mfma_f32_32x32x16_bf16 a[224:239], a[196:199], v[84:87], a[224:239]
    v_exp_f32 v44, v44
    v_exp_f32 v45, v45
    v_cvt_pk_bf16_f32 v93, v42, v43
    v_exp_f32 v46, v46
    v_exp_f32 v47, v47
    v_cvt_pk_bf16_f32 v94, v44, v45
    v_cvt_pk_bf16_f32 v95, v46, v47
    v_mfma_f32_32x32x16_bf16 v[16:31], a[56:59], v[106:109], 0
    v_exp_f32 v48, v48
    v_exp_f32 v49, v49
    v_exp_f32 v50, v50
    v_exp_f32 v51, v51
    v_cvt_pk_bf16_f32 v80, v48, v49
    v_exp_f32 v52, v52
    v_mfma_f32_32x32x16_bf16 a[240:255], a[192:195], v[88:91], a[240:255]
    v_exp_f32 v53, v53
    v_cvt_pk_bf16_f32 v81, v50, v51
    v_exp_f32 v54, v54
    v_exp_f32 v55, v55
    v_cvt_pk_bf16_f32 v82, v52, v53
    v_exp_f32 v56, v56
    v_mfma_f32_32x32x16_bf16 v[32:47], a[56:59], v[110:113], 0
    v_exp_f32 v57, v57
    v_cvt_pk_bf16_f32 v83, v54, v55
    v_exp_f32 v58, v58
    v_exp_f32 v59, v59
    v_cvt_pk_bf16_f32 v84, v56, v57
    v_exp_f32 v60, v60
    v_mfma_f32_32x32x16_bf16 a[240:255], a[196:199], v[92:95], a[240:255]
    v_exp_f32 v61, v61
    v_cvt_pk_bf16_f32 v85, v58, v59
    v_exp_f32 v62, v62
    v_exp_f32 v63, v63
    v_cvt_pk_bf16_f32 v86, v60, v61
    v_cvt_pk_bf16_f32 v87, v62, v63
    v_mfma_f32_32x32x4_2b_bf16 v[16:47], a[92:93], v[114:115], v[16:47]
    v_exp_f32 v64, v64
    v_exp_f32 v65, v65
    v_exp_f32 v66, v66
    v_exp_f32 v67, v67
    v_cvt_pk_bf16_f32 v88, v64, v65
    v_exp_f32 v68, v68
    v_exp_f32 v69, v69
    v_cvt_pk_bf16_f32 v89, v66, v67
    v_exp_f32 v70, v70
    v_exp_f32 v71, v71
    buffer_load_dwordx4 a[52:55], v4, s[8:11], s37 offen offset:3072 sc1
    buffer_load_dwordx4 a[88:91], v254, s[8:11], s37 offen offset:0 sc1
    buffer_load_dwordx4 a[192:195], v254, s[8:11], s37 offen offset:1024 sc1
    buffer_load_dwordx4 a[196:199], v254, s[8:11], s37 offen offset:2048 sc1
    v_mfma_f32_32x32x16_bf16 a[224:239], a[200:203], v[80:83], a[224:239]
    v_cvt_pk_bf16_f32 v90, v68, v69
    v_exp_f32 v72, v72
    v_exp_f32 v73, v73
    v_cvt_pk_bf16_f32 v91, v70, v71
    v_exp_f32 v74, v74
    v_exp_f32 v75, v75
    v_cvt_pk_bf16_f32 v92, v72, v73
    v_mfma_f32_32x32x16_bf16 a[224:239], a[204:207], v[84:87], a[224:239]
    v_exp_f32 v76, v76
    v_exp_f32 v77, v77
    v_cvt_pk_bf16_f32 v93, v74, v75
    v_exp_f32 v78, v78
    v_exp_f32 v79, v79
    v_cvt_pk_bf16_f32 v94, v76, v77
    v_cvt_pk_bf16_f32 v95, v78, v79
    v_mfma_f32_32x32x16_bf16 v[48:63], a[60:63], v[106:109], 0
    v_exp_f32 v16, v16
    v_exp_f32 v17, v17
    v_exp_f32 v18, v18
    v_exp_f32 v19, v19
    v_cvt_pk_bf16_f32 v80, v16, v17
    v_exp_f32 v20, v20
    v_mfma_f32_32x32x16_bf16 a[240:255], a[200:203], v[88:91], a[240:255]
    v_exp_f32 v21, v21
    v_cvt_pk_bf16_f32 v81, v18, v19
    v_exp_f32 v22, v22
    v_exp_f32 v23, v23
    v_cvt_pk_bf16_f32 v82, v20, v21
    v_exp_f32 v24, v24
    v_mfma_f32_32x32x16_bf16 v[64:79], a[60:63], v[110:113], 0
    v_exp_f32 v25, v25
    v_cvt_pk_bf16_f32 v83, v22, v23
    v_exp_f32 v26, v26
    v_exp_f32 v27, v27
    v_cvt_pk_bf16_f32 v84, v24, v25
    v_exp_f32 v28, v28
    v_mfma_f32_32x32x16_bf16 a[240:255], a[204:207], v[92:95], a[240:255]
    v_exp_f32 v29, v29
    v_cvt_pk_bf16_f32 v85, v26, v27
    v_exp_f32 v30, v30
    v_exp_f32 v31, v31
    v_cvt_pk_bf16_f32 v86, v28, v29
    v_cvt_pk_bf16_f32 v87, v30, v31
    v_mfma_f32_32x32x4_2b_bf16 v[48:79], a[94:95], v[114:115], v[48:79]
    v_exp_f32 v32, v32
    v_exp_f32 v33, v33
    v_exp_f32 v34, v34
    v_exp_f32 v35, v35
    v_cvt_pk_bf16_f32 v88, v32, v33
    v_exp_f32 v36, v36
    v_exp_f32 v37, v37
    v_cvt_pk_bf16_f32 v89, v34, v35
    v_exp_f32 v38, v38
    v_exp_f32 v39, v39
    buffer_load_dwordx4 a[56:59], v254, s[8:11], s37 offen offset:3072 sc1
    buffer_load_dwordx4 a[200:203], v255, s[8:11], s37 offen offset:0 sc1
    buffer_load_dwordx4 a[204:207], v255, s[8:11], s37 offen offset:1024 sc1
    v_mfma_f32_32x32x16_bf16 a[224:239], a[208:211], v[80:83], a[224:239]
    v_cvt_pk_bf16_f32 v90, v36, v37
    v_exp_f32 v40, v40
    v_exp_f32 v41, v41
    v_cvt_pk_bf16_f32 v91, v38, v39
    v_exp_f32 v42, v42
    v_exp_f32 v43, v43
    v_cvt_pk_bf16_f32 v92, v40, v41
    v_mfma_f32_32x32x16_bf16 a[224:239], a[212:215], v[84:87], a[224:239]
    v_exp_f32 v44, v44
    v_exp_f32 v45, v45
    v_cvt_pk_bf16_f32 v93, v42, v43
    v_exp_f32 v46, v46
    v_exp_f32 v47, v47
    v_cvt_pk_bf16_f32 v94, v44, v45
    v_cvt_pk_bf16_f32 v95, v46, v47
    v_exp_f32 v48, v48
    v_exp_f32 v49, v49
    v_exp_f32 v50, v50
    v_exp_f32 v51, v51
    v_cvt_pk_bf16_f32 v80, v48, v49
    v_exp_f32 v52, v52
    v_mfma_f32_32x32x16_bf16 a[240:255], a[208:211], v[88:91], a[240:255]
    v_exp_f32 v53, v53
    v_cvt_pk_bf16_f32 v81, v50, v51
    v_exp_f32 v54, v54
    v_exp_f32 v55, v55
    v_cvt_pk_bf16_f32 v82, v52, v53
    v_exp_f32 v56, v56
    v_exp_f32 v57, v57
    v_cvt_pk_bf16_f32 v83, v54, v55
    v_exp_f32 v58, v58
    v_exp_f32 v59, v59
    v_cvt_pk_bf16_f32 v84, v56, v57
    v_exp_f32 v60, v60
    v_mfma_f32_32x32x16_bf16 a[240:255], a[212:215], v[92:95], a[240:255]
    v_exp_f32 v61, v61
    v_cvt_pk_bf16_f32 v85, v58, v59
    v_exp_f32 v62, v62
    v_exp_f32 v63, v63
    v_cvt_pk_bf16_f32 v86, v60, v61
    v_cvt_pk_bf16_f32 v87, v62, v63
    v_exp_f32 v64, v64
    v_exp_f32 v65, v65
    v_exp_f32 v66, v66
    v_exp_f32 v67, v67
    v_cvt_pk_bf16_f32 v88, v64, v65
    v_exp_f32 v68, v68
    v_exp_f32 v69, v69
    v_cvt_pk_bf16_f32 v89, v66, v67
    v_exp_f32 v70, v70
    v_exp_f32 v71, v71
    v_mfma_f32_32x32x16_bf16 a[224:239], a[216:219], v[80:83], a[224:239]
    v_cvt_pk_bf16_f32 v90, v68, v69
    v_exp_f32 v72, v72
    v_exp_f32 v73, v73
    v_cvt_pk_bf16_f32 v91, v70, v71
    v_exp_f32 v74, v74
    v_exp_f32 v75, v75
    v_cvt_pk_bf16_f32 v92, v72, v73
    v_mfma_f32_32x32x16_bf16 a[224:239], a[220:223], v[84:87], a[224:239]
    v_exp_f32 v76, v76
    v_exp_f32 v77, v77
    v_cvt_pk_bf16_f32 v93, v74, v75
    v_exp_f32 v78, v78
    v_exp_f32 v79, v79
    v_cvt_pk_bf16_f32 v94, v76, v77
    v_cvt_pk_bf16_f32 v95, v78, v79
    v_mfma_f32_32x32x16_bf16 a[240:255], a[216:219], v[88:91], a[240:255]
    v_mfma_f32_32x32x16_bf16 a[240:255], a[220:223], v[92:95], a[240:255]
    s_nop 7
    s_nop 1
    ds_write_b128 v14, a[224:227] offset:18432
    ds_write_b128 v14, a[228:231] offset:19456
    ds_write_b128 v14, a[232:235] offset:20480
    s_mul_i32 s52, s3, 6144
    v_add_u32 v6, s52, v4
    v_add_u32 v7, 49152, v6
    ds_write_b128 v14, a[240:243] offset:21504
    ds_write_b128 v14, a[244:247] offset:22528
    ds_write_b128 v14, a[248:251] offset:23552
    s_bitcmp1_b32 s24, 3
    s_cbranch_scc1 L_lt2
L_lt2_ret:
    s_waitcnt lgkmcnt(0)
    s_barrier
L_ored:
    ds_read_b128 v[16:19], v6 offset:0
    ds_read_b128 v[20:23], v6 offset:1024
    ds_read_b128 v[24:27], v6 offset:2048
    ds_read_b128 v[28:31], v6 offset:3072
    ds_read_b128 v[32:35], v6 offset:4096
    ds_read_b128 v[36:39], v6 offset:5120
    ds_read_b128 v[40:43], v6 offset:24576
    ds_read_b128 v[44:47], v6 offset:25600
    ds_read_b128 v[48:51], v6 offset:26624
    ds_read_b128 v[52:55], v6 offset:27648
    ds_read_b128 v[56:59], v6 offset:28672
    ds_read_b128 v[60:63], v6 offset:29696
    ds_read_b128 v[64:67], v7 offset:0
    ds_read_b128 v[68:71], v7 offset:1024
    ds_read_b128 v[72:75], v7 offset:2048
    ds_read_b128 v[76:79], v7 offset:3072
    ds_read_b128 v[80:83], v7 offset:4096
    ds_read_b128 v[84:87], v7 offset:5120
    ds_read_b128 v[88:91], v7 offset:24576
    ds_read_b128 v[92:95], v7 offset:25600
    ds_read_b128 v[96:99], v7 offset:26624
    ds_read_b128 v[100:103], v7 offset:27648
    ds_read_b128 v[104:107], v7 offset:28672
    ds_read_b128 v[108:111], v7 offset:29696
    s_mul_i32 s62, s4, 40960
    s_mul_i32 s53, s5, 10240
    s_add_u32 s61, s62, s53
    s_add_u32 s53, s61, 3145728
    s_mul_i32 s54, s3, 10240
    s_add_u32 s62, s62, s54
    v_bfe_u32 v5, v1, 3, 2
    v_mul_u32_u24 v5, 2560, v5
    v_lshl_add_u32 v5, v250, 4, v5
    v_lshl_add_u32 v9, v3, 9, v5
    v_lshl_add_u32 v10, v3, 30, v5
    s_waitcnt lgkmcnt(0)
    s_barrier
    v_pk_add_f32 v[16:17], v[16:17], v[40:41]
    v_pk_add_f32 v[18:19], v[18:19], v[42:43]
    v_pk_add_f32 v[20:21], v[20:21], v[44:45]
    v_pk_add_f32 v[22:23], v[22:23], v[46:47]
    v_pk_add_f32 v[24:25], v[24:25], v[48:49]
    v_pk_add_f32 v[26:27], v[26:27], v[50:51]
    v_pk_add_f32 v[28:29], v[28:29], v[52:53]
    v_pk_add_f32 v[30:31], v[30:31], v[54:55]
    v_pk_add_f32 v[32:33], v[32:33], v[56:57]
    v_pk_add_f32 v[34:35], v[34:35], v[58:59]
    v_pk_add_f32 v[36:37], v[36:37], v[60:61]
    v_pk_add_f32 v[38:39], v[38:39], v[62:63]
    v_pk_add_f32 v[64:65], v[64:65], v[88:89]
    v_pk_add_f32 v[66:67], v[66:67], v[90:91]
    v_pk_add_f32 v[68:69], v[68:69], v[92:93]
    v_pk_add_f32 v[70:71], v[70:71], v[94:95]
    v_pk_add_f32 v[72:73], v[72:73], v[96:97]
    v_pk_add_f32 v[74:75], v[74:75], v[98:99]
    v_pk_add_f32 v[76:77], v[76:77], v[100:101]
    v_pk_add_f32 v[78:79], v[78:79], v[102:103]
    v_pk_add_f32 v[80:81], v[80:81], v[104:105]
    v_pk_add_f32 v[82:83], v[82:83], v[106:107]
    v_pk_add_f32 v[84:85], v[84:85], v[108:109]
    v_pk_add_f32 v[86:87], v[86:87], v[110:111]
    v_pk_add_f32 v[16:17], v[16:17], v[64:65]
    v_pk_add_f32 v[18:19], v[18:19], v[66:67]
    v_pk_add_f32 v[20:21], v[20:21], v[68:69]
    v_pk_add_f32 v[22:23], v[22:23], v[70:71]
    v_pk_add_f32 v[24:25], v[24:25], v[72:73]
    v_pk_add_f32 v[26:27], v[26:27], v[74:75]
    v_pk_add_f32 v[28:29], v[28:29], v[76:77]
    v_pk_add_f32 v[30:31], v[30:31], v[78:79]
    v_pk_add_f32 v[32:33], v[32:33], v[80:81]
    v_pk_add_f32 v[34:35], v[34:35], v[82:83]
    v_pk_add_f32 v[36:37], v[36:37], v[84:85]
    v_pk_add_f32 v[38:39], v[38:39], v[86:87]
    s_bitcmp0_b32 s24, 3
    s_cbranch_scc1 Lla_14
    v_pk_add_f32 v[16:17], v[16:17], v[208:209]
    v_pk_add_f32 v[18:19], v[18:19], v[210:211]
    v_pk_add_f32 v[20:21], v[20:21], v[212:213]
    v_pk_add_f32 v[22:23], v[22:23], v[214:215]
    v_pk_add_f32 v[24:25], v[24:25], v[216:217]
    v_pk_add_f32 v[26:27], v[26:27], v[218:219]
    v_pk_add_f32 v[28:29], v[28:29], v[224:225]
    v_pk_add_f32 v[30:31], v[30:31], v[226:227]
    v_pk_add_f32 v[32:33], v[32:33], v[228:229]
    v_pk_add_f32 v[34:35], v[34:35], v[230:231]
    v_pk_add_f32 v[36:37], v[36:37], v[232:233]
    v_pk_add_f32 v[38:39], v[38:39], v[234:235]
Lla_14:
    s_mov_b32 s54, 562036736
    s_mov_b32 s55, 1400897536
    v_mul_f32 v40, 964689920, v25
    v_mul_f32 v41, 964689920, v37
    v_max_f32 v40, s54, v40
    v_max_f32 v41, s54, v41
    v_cmp_nle_f32 vcc, v40, v24
    v_cmp_nle_f32 s[56:57], v41, v36
    v_cmp_nge_f32 s[58:59], s55, v24
    v_cmp_nge_f32 s[32:33], s55, v36
    v_mov_b32 v5, v24
    v_mov_b32 v6, v24
    v_mov_b32 v7, v36
    v_mov_b32 v8, v36
    s_or_b32 s57, s57, vcc_hi
    s_or_b32 s59, s59, s33
    s_or_b32 s57, s57, s59
    s_cbranch_scc1 L_fb
L_fb_ret:
    v_permlane32_swap_b32 v5, v6
    v_permlane32_swap_b32 v7, v8
    s_nop 1
    v_rcp_f32 v6, v6
    v_rcp_f32 v8, v8
    s_nop 0
    v_mul_f32 v16, v16, v6
    v_mul_f32 v17, v17, v6
    v_mul_f32 v18, v18, v6
    v_mul_f32 v19, v19, v6
    v_mul_f32 v20, v20, v6
    v_mul_f32 v21, v21, v6
    v_mul_f32 v22, v22, v6
    v_mul_f32 v23, v23, v6
    v_mul_f32 v24, v24, v6
    v_mul_f32 v25, v25, v6
    v_mul_f32 v26, v26, v6
    v_mul_f32 v27, v27, v6
    v_mul_f32 v28, v28, v8
    v_mul_f32 v29, v29, v8
    v_mul_f32 v30, v30, v8
    v_mul_f32 v31, v31, v8
    v_mul_f32 v32, v32, v8
    v_mul_f32 v33, v33, v8
    v_mul_f32 v34, v34, v8
    v_mul_f32 v35, v35, v8
    v_mul_f32 v36, v36, v8
    v_mul_f32 v37, v37, v8
    v_mul_f32 v38, v38, v8
    v_mul_f32 v39, v39, v8
    v_cvt_pk_bf16_f32 v56, v16, v17
    v_cvt_pk_bf16_f32 v57, v18, v19
    v_cvt_pk_bf16_f32 v58, v20, v21
    v_cvt_pk_bf16_f32 v59, v22, v23
    v_cvt_pk_bf16_f32 v60, v28, v29
    v_cvt_pk_bf16_f32 v61, v30, v31
    v_cvt_pk_bf16_f32 v62, v32, v33
    v_cvt_pk_bf16_f32 v63, v34, v35
    v_cvt_pk_bf16_f32 v64, v24, v25
    v_cvt_pk_bf16_f32 v65, v26, v27
    v_cvt_pk_bf16_f32 v66, v36, v37
    v_cvt_pk_bf16_f32 v67, v38, v39
    s_add_u32 s52, s62, 3145728
    s_sub_u32 s44, s34, 819200
    s_sub_u32 s45, s35, 819200
    s_sub_u32 s46, s36, 819200
    s_sub_u32 s47, s37, 819200
    s_cmp_eq_u32 s7, 0
    s_cbranch_scc1 Lqs_15
    s_mov_b32 s44, 1073741824
    s_mov_b32 s45, 1073741824
    s_mov_b32 s46, 1073741824
    s_mov_b32 s47, 1073741824
Lqs_15:
    s_cmp_eq_u32 s39, 0
    s_cbranch_scc1 Lrm_16
    buffer_store_dwordx4 v[56:59], v9, s[8:11], s53 offen
    buffer_store_dwordx4 v[60:63], v9, s[8:11], s53 offen offset:1024
    buffer_store_dwordx4 v[64:67], v10, s[8:11], s53 offen offset:2048
    s_branch Lrd_17
Lrm_16:
    buffer_store_dwordx4 v[56:59], v9, s[8:11], s53 offen sc1
    buffer_store_dwordx4 v[60:63], v9, s[8:11], s53 offen offset:1024 sc1
    buffer_store_dwordx4 v[64:67], v10, s[8:11], s53 offen offset:2048 sc1
Lrd_17:
    s_mul_i32 s54, s3, 10240
    v_add_u32 v8, s54, v4
    s_mov_b32 s63, 0x80000
Lsp_18:
    s_add_u32 m0, s54, 0
    s_nop 0
    buffer_load_dwordx4 v4, s[8:11], s52 offen offset:0 sc1 lds
    buffer_load_dwordx4 v4, s[8:11], s52 offen offset:1024 sc1 lds
    buffer_load_dwordx4 v4, s[8:11], s52 offen offset:2048 sc1 lds
    buffer_load_dwordx4 v4, s[8:11], s52 offen offset:3072 sc1 lds
    s_add_u32 m0, s54, 4096
    s_nop 0
    buffer_load_dwordx4 v254, s[8:11], s52 offen offset:0 sc1 lds
    buffer_load_dwordx4 v254, s[8:11], s52 offen offset:1024 sc1 lds
    buffer_load_dwordx4 v254, s[8:11], s52 offen offset:2048 sc1 lds
    buffer_load_dwordx4 v254, s[8:11], s52 offen offset:3072 sc1 lds
    s_add_u32 m0, s54, 8192
    s_nop 0
    buffer_load_dwordx4 v255, s[8:11], s52 offen offset:0 sc1 lds
    buffer_load_dwordx4 v255, s[8:11], s52 offen offset:1024 sc1 lds
    s_waitcnt vmcnt(0)
    ds_read_b128 v[16:19], v8 offset:0
    ds_read_b128 v[20:23], v8 offset:1024
    ds_read_b128 v[24:27], v8 offset:2048
    ds_read_b128 v[28:31], v8 offset:3072
    ds_read_b128 v[32:35], v8 offset:4096
    ds_read_b128 v[36:39], v8 offset:5120
    ds_read_b128 v[40:43], v8 offset:6144
    ds_read_b128 v[44:47], v8 offset:7168
    ds_read_b128 v[48:51], v8 offset:8192
    ds_read_b128 v[52:55], v8 offset:9216
    s_waitcnt lgkmcnt(5)
    v_max3_u32 v5, v16, v17, v18
    v_max3_u32 v5, v5, v19, v20
    v_max3_u32 v5, v5, v21, v22
    v_max3_u32 v5, v5, v23, v24
    v_max3_u32 v5, v5, v25, v26
    v_max3_u32 v5, v5, v27, v28
    v_max3_u32 v5, v5, v29, v30
    v_max3_u32 v5, v5, v31, v32
    v_max3_u32 v5, v5, v33, v34
    v_max_u32 v5, v5, v35
    s_waitcnt lgkmcnt(0)
    v_max3_u32 v6, v36, v37, v38
    v_max3_u32 v6, v6, v39, v40
    v_max3_u32 v6, v6, v41, v42
    v_max3_u32 v6, v6, v43, v44
    v_max3_u32 v6, v6, v45, v46
    v_max3_u32 v6, v6, v47, v48
    v_max3_u32 v6, v6, v49, v50
    v_max3_u32 v6, v6, v51, v52
    v_max3_u32 v6, v6, v53, v54
    v_max_u32 v6, v6, v55
    v_max_u32 v5, v5, v6
    v_cmp_eq_u32 vcc, -1, v5
    s_sub_u32 s63, s63, 1
    s_cbranch_scc1 Lsd_19
    s_nop 2
    s_cbranch_vccnz Lsp_18
Lsd_19:
    v_mfma_f32_32x32x16_bf16 a[240:255], a[0:3], v[16:19], 0
    buffer_load_dwordx4 a[60:63], v254, s[8:11], s44 offen offset:0 sc1
    v_mfma_f32_32x32x16_bf16 a[240:255], a[4:7], v[20:23], a[240:255]
    buffer_load_dwordx4 a[92:95], v254, s[8:11], s44 offen offset:1024 sc1
    s_add_u32 s59, s3, 1
    s_and_b32 s59, s59, 3
    s_mul_i32 s59, s59, 10240
    v_add_u32 v7, s59, v4
    v_mfma_f32_32x32x16_bf16 a[240:255], a[64:67], v[24:27], a[240:255]
    buffer_load_dwordx4 a[208:211], v254, s[8:11], s44 offen offset:2048 sc1
    s_add_u32 s59, s3, 2
    s_and_b32 s59, s59, 3
    s_mul_i32 s59, s59, 10240
    v_add_u32 v8, s59, v4
    v_mfma_f32_32x32x16_bf16 a[240:255], a[96:99], v[28:31], a[240:255]
    buffer_load_dwordx4 a[212:215], v254, s[8:11], s44 offen offset:3072 sc1
    s_add_u32 s59, s3, 3
    s_and_b32 s59, s59, 3
    s_mul_i32 s59, s59, 10240
    v_add_u32 v9, s59, v4
    v_mfma_f32_32x32x16_bf16 a[240:255], a[100:103], v[32:35], a[240:255]
    buffer_load_dwordx4 a[216:219], v255, s[8:11], s44 offen offset:0 sc1
    s_barrier
    ds_read_b128 v[68:71], v7 offset:0
    v_mfma_f32_32x32x16_bf16 a[240:255], a[8:11], v[36:39], a[240:255]
    buffer_load_dwordx4 a[220:223], v255, s[8:11], s44 offen offset:1024 sc1
    ds_read_b128 v[72:75], v7 offset:1024
    v_mfma_f32_32x32x16_bf16 a[240:255], a[104:107], v[40:43], a[240:255]
    ds_read_b128 v[76:79], v7 offset:2048
    v_mfma_f32_32x32x16_bf16 a[240:255], a[108:111], v[44:47], a[240:255]
    ds_read_b128 v[80:83], v7 offset:3072
    v_mfma_f32_32x32x16_bf16 a[240:255], a[12:15], v[48:51], a[240:255]
    ds_read_b128 v[84:87], v7 offset:4096
    v_mfma_f32_32x32x16_bf16 a[240:255], a[68:71], v[52:55], a[240:255]
    ds_read_b128 v[88:91], v7 offset:5120
    v_mfma_f32_32x32x16_bf16 v[96:111], a[112:115], v[16:19], 0
    s_lshl_b32 s59, s3, 12
    s_add_u32 s59, s59, 40960
    v_add_u32 v10, s59, v4
    s_lshl_b32 s59, s3, 10
    s_add_u32 s59, s59, 40960
    v_add_u32 v56, s59, v4
    buffer_load_dwordx4 a[0:3], v4, s[8:11], s45 offen offset:0 sc1
    v_mfma_f32_32x32x16_bf16 v[96:111], a[116:119], v[20:23], v[96:111]
    v_mfma_f32_32x32x16_bf16 v[96:111], a[16:19], v[24:27], v[96:111]
    buffer_load_dwordx4 a[4:7], v4, s[8:11], s45 offen offset:1024 sc1
    v_mfma_f32_32x32x16_bf16 v[96:111], a[120:123], v[28:31], v[96:111]
    v_mfma_f32_32x32x16_bf16 v[96:111], a[124:127], v[32:35], v[96:111]
    buffer_load_dwordx4 a[64:67], v4, s[8:11], s45 offen offset:2048 sc1
    v_mfma_f32_32x32x16_bf16 v[96:111], a[20:23], v[36:39], v[96:111]
    v_mfma_f32_32x32x16_bf16 v[96:111], a[72:75], v[40:43], v[96:111]
    ds_write_b128 v10, a[240:243] offset:0
    ds_write_b128 v10, a[244:247] offset:1024
    ds_write_b128 v10, a[248:251] offset:2048
    ds_write_b128 v10, a[252:255] offset:3072
    buffer_load_dwordx4 a[96:99], v4, s[8:11], s45 offen offset:3072 sc1
    v_mfma_f32_32x32x16_bf16 v[96:111], a[128:131], v[44:47], v[96:111]
    v_mfma_f32_32x32x16_bf16 v[96:111], a[132:135], v[48:51], v[96:111]
    buffer_load_dwordx4 a[100:103], v254, s[8:11], s45 offen offset:0 sc1
    v_mfma_f32_32x32x16_bf16 v[96:111], a[24:27], v[52:55], v[96:111]
    s_waitcnt lgkmcnt(5)
    v_mfma_f32_32x32x16_bf16 v[96:111], a[136:139], v[68:71], v[96:111]
    ds_read_b128 v[92:95], v7 offset:6144
    buffer_load_dwordx4 a[8:11], v254, s[8:11], s45 offen offset:1024 sc1
    s_waitcnt lgkmcnt(5)
    v_mfma_f32_32x32x16_bf16 v[96:111], a[140:143], v[72:75], v[96:111]
    ds_read_b128 v[68:71], v7 offset:7168
    s_waitcnt lgkmcnt(5)
    v_mfma_f32_32x32x16_bf16 v[96:111], a[28:31], v[76:79], v[96:111]
    ds_read_b128 v[72:75], v7 offset:8192
    buffer_load_dwordx4 a[104:107], v254, s[8:11], s45 offen offset:2048 sc1
    s_waitcnt lgkmcnt(5)
    v_mfma_f32_32x32x16_bf16 v[96:111], a[76:79], v[80:83], v[96:111]
    ds_read_b128 v[76:79], v7 offset:9216
    s_waitcnt lgkmcnt(5)
    v_mfma_f32_32x32x16_bf16 v[96:111], a[144:147], v[84:87], v[96:111]
    ds_read_b128 v[80:83], v8 offset:0
    buffer_load_dwordx4 a[108:111], v254, s[8:11], s45 offen offset:3072 sc1
    s_waitcnt lgkmcnt(5)
    v_mfma_f32_32x32x16_bf16 v[96:111], a[148:151], v[88:91], v[96:111]
    ds_read_b128 v[84:87], v8 offset:1024
    s_waitcnt lgkmcnt(5)
    v_mfma_f32_32x32x16_bf16 v[96:111], a[32:35], v[92:95], v[96:111]
    ds_read_b128 v[88:91], v8 offset:2048
    buffer_load_dwordx4 a[12:15], v255, s[8:11], s45 offen offset:0 sc1
    s_waitcnt lgkmcnt(5)
    v_mfma_f32_32x32x16_bf16 v[96:111], a[152:155], v[68:71], v[96:111]
    ds_read_b128 v[92:95], v8 offset:3072
    s_waitcnt lgkmcnt(5)
    v_mfma_f32_32x32x16_bf16 v[96:111], a[156:159], v[72:75], v[96:111]
    ds_read_b128 v[68:71], v8 offset:4096
    buffer_load_dwordx4 a[68:71], v255, s[8:11], s45 offen offset:1024 sc1
    s_waitcnt lgkmcnt(5)
    v_mfma_f32_32x32x16_bf16 v[96:111], a[36:39], v[76:79], v[96:111]
    ds_read_b128 v[72:75], v8 offset:5120
    s_waitcnt lgkmcnt(5)
    v_mfma_f32_32x32x16_bf16 v[96:111], a[80:83], v[80:83], v[96:111]
    ds_read_b128 v[76:79], v8 offset:6144
    buffer_load_dwordx4 a[112:115], v4, s[8:11], s46 offen offset:0 sc1
    s_waitcnt lgkmcnt(5)
    v_mfma_f32_32x32x16_bf16 v[96:111], a[160:163], v[84:87], v[96:111]
    ds_read_b128 v[80:83], v8 offset:7168
    s_waitcnt lgkmcnt(5)
    v_mfma_f32_32x32x16_bf16 v[96:111], a[164:167], v[88:91], v[96:111]
    ds_read_b128 v[84:87], v8 offset:8192
    buffer_load_dwordx4 a[116:119], v4, s[8:11], s46 offen offset:1024 sc1
    s_waitcnt lgkmcnt(5)
    v_mfma_f32_32x32x16_bf16 v[96:111], a[40:43], v[92:95], v[96:111]
    ds_read_b128 v[88:91], v8 offset:9216
    s_waitcnt lgkmcnt(5)
    v_mfma_f32_32x32x16_bf16 v[96:111], a[168:171], v[68:71], v[96:111]
    ds_read_b128 v[92:95], v9 offset:0
    buffer_load_dwordx4 a[16:19], v4, s[8:11], s46 offen offset:2048 sc1
    s_waitcnt lgkmcnt(5)
    v_mfma_f32_32x32x16_bf16 v[96:111], a[172:175], v[72:75], v[96:111]
    ds_read_b128 v[68:71], v9 offset:1024
    s_waitcnt lgkmcnt(5)
    v_mfma_f32_32x32x16_bf16 v[96:111], a[44:47], v[76:79], v[96:111]
    ds_read_b128 v[72:75], v9 offset:2048
    buffer_load_dwordx4 a[120:123], v4, s[8:11], s46 offen offset:3072 sc1
    s_waitcnt lgkmcnt(5)
    v_mfma_f32_32x32x16_bf16 v[96:111], a[84:87], v[80:83], v[96:111]
    ds_read_b128 v[76:79], v9 offset:3072
    s_waitcnt lgkmcnt(5)
    v_mfma_f32_32x32x16_bf16 v[96:111], a[176:179], v[84:87], v[96:111]
    ds_read_b128 v[80:83], v9 offset:4096
    buffer_load_dwordx4 a[124:127], v254, s[8:11], s46 offen offset:0 sc1
    s_waitcnt lgkmcnt(5)
    v_mfma_f32_32x32x16_bf16 v[96:111], a[180:183], v[88:91], v[96:111]
    ds_read_b128 v[84:87], v9 offset:5120
    s_waitcnt lgkmcnt(5)
    v_mfma_f32_32x32x16_bf16 v[96:111], a[48:51], v[92:95], v[96:111]
    ds_read_b128 v[88:91], v9 offset:6144
    buffer_load_dwordx4 a[20:23], v254, s[8:11], s46 offen offset:1024 sc1
    s_waitcnt lgkmcnt(5)
    v_mfma_f32_32x32x16_bf16 v[96:111], a[184:187], v[68:71], v[96:111]
    ds_read_b128 v[92:95], v9 offset:7168
    s_waitcnt lgkmcnt(5)
    v_mfma_f32_32x32x16_bf16 v[96:111], a[188:191], v[72:75], v[96:111]
    ds_read_b128 v[68:71], v9 offset:8192
    buffer_load_dwordx4 a[72:75], v254, s[8:11], s46 offen offset:2048 sc1
    s_waitcnt lgkmcnt(5)
    v_mfma_f32_32x32x16_bf16 v[96:111], a[52:55], v[76:79], v[96:111]
    ds_read_b128 v[72:75], v9 offset:9216
    s_barrier
    s_waitcnt lgkmcnt(5)
    v_mfma_f32_32x32x16_bf16 v[96:111], a[88:91], v[80:83], v[96:111]
    buffer_load_dwordx4 a[128:131], v254, s[8:11], s46 offen offset:3072 sc1
    s_waitcnt lgkmcnt(4)
    v_mfma_f32_32x32x16_bf16 v[96:111], a[192:195], v[84:87], v[96:111]
    s_waitcnt lgkmcnt(3)
    v_mfma_f32_32x32x16_bf16 v[96:111], a[196:199], v[88:91], v[96:111]
    buffer_load_dwordx4 a[132:135], v255, s[8:11], s46 offen offset:0 sc1
    s_waitcnt lgkmcnt(2)
    v_mfma_f32_32x32x16_bf16 v[96:111], a[56:59], v[92:95], v[96:111]
    s_waitcnt lgkmcnt(1)
    v_mfma_f32_32x32x16_bf16 v[96:111], a[200:203], v[68:71], v[96:111]
    buffer_load_dwordx4 a[24:27], v255, s[8:11], s46 offen offset:1024 sc1
    s_waitcnt lgkmcnt(0)
    v_mfma_f32_32x32x16_bf16 v[96:111], a[204:207], v[72:75], v[96:111]
    ds_read_b128 v[68:71], v56 offset:0
    ds_read_b128 v[72:75], v56 offset:4096
    ds_read_b128 v[76:79], v56 offset:8192
    ds_read_b128 v[80:83], v56 offset:12288
    s_waitcnt lgkmcnt(0)
    s_barrier
    v_pk_add_f32 v[68:69], v[68:69], v[72:73]
    v_pk_add_f32 v[70:71], v[70:71], v[74:75]
    v_pk_add_f32 v[76:77], v[76:77], v[80:81]
    v_pk_add_f32 v[78:79], v[78:79], v[82:83]
    v_pk_add_f32 v[112:113], v[68:69], v[76:77]
    v_pk_add_f32 v[114:115], v[70:71], v[78:79]
    s_nop 1
    v_lshlrev_b32 v5, 16, v116
    v_and_b32 v6, 0xffff0000, v116
    v_add_f32 v5, v5, v96
    v_add_f32 v6, v6, v97
    v_cvt_pk_bf16_f32 v116, v5, v6
    v_lshlrev_b32 v5, 16, v117
    v_and_b32 v6, 0xffff0000, v117
    v_add_f32 v5, v5, v98
    v_add_f32 v6, v6, v99
    v_cvt_pk_bf16_f32 v117, v5, v6
    v_lshlrev_b32 v5, 16, v118
    v_and_b32 v6, 0xffff0000, v118
    v_add_f32 v5, v5, v100
    v_add_f32 v6, v6, v101
    v_cvt_pk_bf16_f32 v118, v5, v6
    v_lshlrev_b32 v5, 16, v119
    v_and_b32 v6, 0xffff0000, v119
    v_add_f32 v5, v5, v102
    v_add_f32 v6, v6, v103
    v_cvt_pk_bf16_f32 v119, v5, v6
    v_lshlrev_b32 v5, 16, v120
    v_and_b32 v6, 0xffff0000, v120
    v_add_f32 v5, v5, v104
    v_add_f32 v6, v6, v105
    v_cvt_pk_bf16_f32 v120, v5, v6
    v_lshlrev_b32 v5, 16, v121
    v_and_b32 v6, 0xffff0000, v121
    v_add_f32 v5, v5, v106
    v_add_f32 v6, v6, v107
    v_cvt_pk_bf16_f32 v121, v5, v6
    v_lshlrev_b32 v5, 16, v122
    v_and_b32 v6, 0xffff0000, v122
    v_add_f32 v5, v5, v108
    v_add_f32 v6, v6, v109
    v_cvt_pk_bf16_f32 v122, v5, v6
    v_lshlrev_b32 v5, 16, v123
    v_and_b32 v6, 0xffff0000, v123
    v_add_f32 v5, v5, v110
    v_add_f32 v6, v6, v111
    v_cvt_pk_bf16_f32 v123, v5, v6
    v_lshlrev_b32 v5, 16, v124
    v_and_b32 v6, 0xffff0000, v124
    v_add_f32 v5, v5, v112
    v_add_f32 v6, v6, v113
    v_cvt_pk_bf16_f32 v124, v5, v6
    v_lshlrev_b32 v5, 16, v125
    v_and_b32 v6, 0xffff0000, v125
    v_add_f32 v5, v5, v114
    v_add_f32 v6, v6, v115
    v_cvt_pk_bf16_f32 v125, v5, v6
    s_mul_i32 s52, s3, 2560
    s_add_u32 s52, s52, s61
    s_add_u32 s52, s52, 5767168
    v_lshlrev_b32 v7, 4, v2
    v_lshl_add_u32 v7, v3, 3, v7
    s_add_u32 s53, s62, 5767168
    s_cmp_eq_u32 s39, 0
    s_cbranch_scc1 Lrm_20
    buffer_store_dwordx4 v[116:119], v4, s[8:11], s52 offen
    buffer_store_dwordx4 v[120:123], v4, s[8:11], s52 offen offset:1024
    buffer_store_dwordx2 v[124:125], v7, s[8:11], s52 offen offset:2048
    s_branch Lrd_21
Lrm_20:
    buffer_store_dwordx4 v[116:119], v4, s[8:11], s52 offen sc1
    buffer_store_dwordx4 v[120:123], v4, s[8:11], s52 offen offset:1024 sc1
    buffer_store_dwordx2 v[124:125], v7, s[8:11], s52 offen offset:2048 sc1
Lrd_21:
    s_mul_i32 s54, s3, 10240
    v_add_u32 v8, s54, v4
    s_mov_b32 s63, 0x80000
Lsp_22:
    s_add_u32 m0, s54, 0
    s_nop 0
    buffer_load_dwordx4 v4, s[8:11], s53 offen offset:0 sc1 lds
    buffer_load_dwordx4 v4, s[8:11], s53 offen offset:1024 sc1 lds
    buffer_load_dwordx4 v4, s[8:11], s53 offen offset:2048 sc1 lds
    buffer_load_dwordx4 v4, s[8:11], s53 offen offset:3072 sc1 lds
    s_add_u32 m0, s54, 4096
    s_nop 0
    buffer_load_dwordx4 v254, s[8:11], s53 offen offset:0 sc1 lds
    buffer_load_dwordx4 v254, s[8:11], s53 offen offset:1024 sc1 lds
    buffer_load_dwordx4 v254, s[8:11], s53 offen offset:2048 sc1 lds
    buffer_load_dwordx4 v254, s[8:11], s53 offen offset:3072 sc1 lds
    s_add_u32 m0, s54, 8192
    s_nop 0
    buffer_load_dwordx4 v255, s[8:11], s53 offen offset:0 sc1 lds
    buffer_load_dwordx4 v255, s[8:11], s53 offen offset:1024 sc1 lds
    s_waitcnt vmcnt(0)
    ds_read_b128 v[16:19], v8 offset:0
    ds_read_b128 v[20:23], v8 offset:1024
    ds_read_b128 v[24:27], v8 offset:2048
    ds_read_b128 v[28:31], v8 offset:3072
    ds_read_b128 v[32:35], v8 offset:4096
    ds_read_b128 v[36:39], v8 offset:5120
    ds_read_b128 v[40:43], v8 offset:6144
    ds_read_b128 v[44:47], v8 offset:7168
    ds_read_b128 v[48:51], v8 offset:8192
    ds_read_b128 v[52:55], v8 offset:9216
    s_waitcnt lgkmcnt(5)
    v_max3_u32 v5, v16, v17, v18
    v_max3_u32 v5, v5, v19, v20
    v_max3_u32 v5, v5, v21, v22
    v_max3_u32 v5, v5, v23, v24
    v_max3_u32 v5, v5, v25, v26
    v_max3_u32 v5, v5, v27, v28
    v_max3_u32 v5, v5, v29, v30
    v_max3_u32 v5, v5, v31, v32
    v_max3_u32 v5, v5, v33, v34
    v_max_u32 v5, v5, v35
    s_waitcnt lgkmcnt(0)
    v_max3_u32 v6, v36, v37, v38
    v_max3_u32 v6, v6, v39, v40
    v_max3_u32 v6, v6, v41, v42
    v_max3_u32 v6, v6, v43, v44
    v_max3_u32 v6, v6, v45, v46
    v_max3_u32 v6, v6, v47, v48
    v_max3_u32 v6, v6, v49, v50
    v_max3_u32 v6, v6, v51, v52
    v_max3_u32 v6, v6, v53, v54
    v_max_u32 v6, v6, v55
    v_max_u32 v5, v5, v6
    v_cmp_eq_u32 vcc, -1, v5
    s_sub_u32 s63, s63, 1
    s_cbranch_scc1 Lsd_23
    s_nop 2
    s_cbranch_vccnz Lsp_22
Lsd_23:
    v_mov_b32 v6, 0
    v_mov_b32 v7, 0
    v_mfma_f32_32x32x16_bf16 v[64:79], v[128:131], v[16:19], 0
    v_dot2_f32_bf16 v6, v16, v16, v6
    v_dot2_f32_bf16 v7, v17, v17, v7
    v_dot2_f32_bf16 v6, v18, v18, v6
    v_dot2_f32_bf16 v7, v19, v19, v7
    buffer_load_dwordx4 a[136:139], v4, s[8:11], s47 offen offset:0 sc1
    v_mfma_f32_32x32x16_bf16 v[64:79], v[132:135], v[20:23], v[64:79]
    v_dot2_f32_bf16 v6, v20, v20, v6
    v_dot2_f32_bf16 v7, v21, v21, v7
    v_dot2_f32_bf16 v6, v22, v22, v6
    v_dot2_f32_bf16 v7, v23, v23, v7
    buffer_load_dwordx4 a[140:143], v4, s[8:11], s47 offen offset:1024 sc1
    v_mfma_f32_32x32x16_bf16 v[64:79], v[136:139], v[24:27], v[64:79]
    v_dot2_f32_bf16 v6, v24, v24, v6
    v_dot2_f32_bf16 v7, v25, v25, v7
    v_dot2_f32_bf16 v6, v26, v26, v6
    v_dot2_f32_bf16 v7, v27, v27, v7
    buffer_load_dwordx4 a[28:31], v4, s[8:11], s47 offen offset:2048 sc1
    v_mfma_f32_32x32x16_bf16 v[64:79], v[140:143], v[28:31], v[64:79]
    v_dot2_f32_bf16 v6, v28, v28, v6
    v_dot2_f32_bf16 v7, v29, v29, v7
    v_dot2_f32_bf16 v6, v30, v30, v6
    v_dot2_f32_bf16 v7, v31, v31, v7
    buffer_load_dwordx4 a[76:79], v4, s[8:11], s47 offen offset:3072 sc1
    v_mfma_f32_32x32x16_bf16 v[64:79], v[144:147], v[32:35], v[64:79]
    v_dot2_f32_bf16 v6, v32, v32, v6
    v_dot2_f32_bf16 v7, v33, v33, v7
    v_dot2_f32_bf16 v6, v34, v34, v6
    v_dot2_f32_bf16 v7, v35, v35, v7
    buffer_load_dwordx4 a[144:147], v254, s[8:11], s47 offen offset:0 sc1
    v_mfma_f32_32x32x16_bf16 v[64:79], v[148:151], v[36:39], v[64:79]
    v_dot2_f32_bf16 v6, v36, v36, v6
    v_dot2_f32_bf16 v7, v37, v37, v7
    v_dot2_f32_bf16 v6, v38, v38, v6
    v_dot2_f32_bf16 v7, v39, v39, v7
    buffer_load_dwordx4 a[148:151], v254, s[8:11], s47 offen offset:1024 sc1
    v_mfma_f32_32x32x16_bf16 v[64:79], v[152:155], v[40:43], v[64:79]
    v_dot2_f32_bf16 v6, v40, v40, v6
    v_dot2_f32_bf16 v7, v41, v41, v7
    v_dot2_f32_bf16 v6, v42, v42, v6
    v_dot2_f32_bf16 v7, v43, v43, v7
    buffer_load_dwordx4 a[32:35], v254, s[8:11], s47 offen offset:2048 sc1
    v_mfma_f32_32x32x16_bf16 v[64:79], v[156:159], v[44:47], v[64:79]
    v_dot2_f32_bf16 v6, v44, v44, v6
    v_dot2_f32_bf16 v7, v45, v45, v7
    v_dot2_f32_bf16 v6, v46, v46, v6
    v_dot2_f32_bf16 v7, v47, v47, v7
    buffer_load_dwordx4 a[152:155], v254, s[8:11], s47 offen offset:3072 sc1
    v_mfma_f32_32x32x16_bf16 v[64:79], v[160:163], v[48:51], v[64:79]
    v_dot2_f32_bf16 v6, v48, v48, v6
    v_dot2_f32_bf16 v7, v49, v49, v7
    v_dot2_f32_bf16 v6, v50, v50, v6
    v_dot2_f32_bf16 v7, v51, v51, v7
    buffer_load_dwordx4 a[156:159], v255, s[8:11], s47 offen offset:0 sc1
    v_mfma_f32_32x32x16_bf16 v[64:79], v[164:167], v[52:55], v[64:79]
    v_dot2_f32_bf16 v6, v52, v52, v6
    v_dot2_f32_bf16 v7, v53, v53, v7
    v_dot2_f32_bf16 v6, v54, v54, v6
    v_dot2_f32_bf16 v7, v55, v55, v7
    buffer_load_dwordx4 a[36:39], v255, s[8:11], s47 offen offset:1024 sc1
    s_lshl_b32 s52, s3, 4
    s_add_u32 s52, s52, 159744
    v_lshlrev_b32 v8, 6, v2
    v_add_f32 v7, v6, v7
    v_add_u32 v9, s52, v8
    v_add_u32 v8, 159744, v8
    v_mov_b32 v6, v7
    s_mul_i32 s52, s3, 3072
    s_add_u32 s52, s52, 147456
    v_permlane32_swap_b32 v6, v7
    v_add_u32 v10, s52, v4
    s_min_u32 s52, s3, 2
    s_lshl_b32 s53, s52, 10
    s_add_u32 s53, s53, 147456
    v_add_f32 v78, v6, v7
    ds_write_b128 v10, v[64:67] offset:0
    ds_write_b128 v10, v[68:71] offset:1024
    ds_write_b128 v10, v[72:75] offset:2048
    s_mov_b64 exec, 0xffffffff
    ds_write_b128 v9, v[76:79]
    s_mov_b64 exec, -1
    v_add_u32 v9, s53, v4
    s_waitcnt lgkmcnt(0)
    s_barrier
    ds_read_b128 v[80:83], v8 offset:0
    ds_read_b128 v[84:87], v8 offset:16
    ds_read_b128 v[88:91], v8 offset:32
    ds_read_b128 v[92:95], v8 offset:48
    ds_read_b128 v[64:67], v9 offset:0
    ds_read_b128 v[68:71], v9 offset:3072
    ds_read_b128 v[72:75], v9 offset:6144
    ds_read_b128 v[76:79], v9 offset:9216
    s_waitcnt lgkmcnt(4)
    v_pk_add_f32 v[80:81], v[80:81], v[84:85]
    v_pk_add_f32 v[82:83], v[82:83], v[86:87]
    v_pk_add_f32 v[88:89], v[88:89], v[92:93]
    v_pk_add_f32 v[90:91], v[90:91], v[94:95]
    v_pk_add_f32 v[80:81], v[80:81], v[88:89]
    v_pk_add_f32 v[82:83], v[82:83], v[90:91]
    v_mul_f32 v12, 986500301, v80
    v_mul_f32 v5, 986500301, v82
    v_fma_f32 v5, -v12, v12, v5
    v_max_f32 v5, 0, v5
    v_add_f32 v6, 925353388, v5
    v_rsq_f32 v13, v6
    s_waitcnt lgkmcnt(0)
    v_pk_add_f32 v[64:65], v[64:65], v[68:69]
    v_pk_add_f32 v[66:67], v[66:67], v[70:71]
    v_pk_add_f32 v[72:73], v[72:73], v[76:77]
    v_pk_add_f32 v[74:75], v[74:75], v[78:79]
    v_pk_add_f32 v[112:113], v[64:65], v[72:73]
    v_pk_add_f32 v[114:115], v[66:67], v[74:75]
    v_add_f32 v6, 1.0, v13
    v_mul_f32 v7, v6, v6
    v_mov_b32 v8, 925353388
    v_fmac_f32 v8, v5, v7
    v_rsq_f32 v8, v8
    v_fma_f32 v112, -v12, v244, v112
    v_fma_f32 v113, -v12, v245, v113
    v_fma_f32 v114, -v12, v246, v114
    v_fma_f32 v115, -v12, v247, v115
    v_mul_f32 v11, v6, v8
    s_cmp_lg_u32 s7, 0
    s_cbranch_scc1 Lnk_24
    s_add_u32 s64, s64, 0x40000
    s_add_u32 s66, s66, 0x4000
    v_mul_f32 v56, v112, v11
    v_mul_f32 v57, v113, v11
    v_mul_f32 v58, v114, v11
    v_mul_f32 v59, v115, v11
    s_cmp_ge_u32 s5, 2
    s_cbranch_scc1 Lk_25
    s_cmp_eq_u32 s3, 3
    s_cbranch_scc1 Lk_25
    s_lshl_b32 s52, s3, 9
    s_add_u32 s52, s52, 161792
    s_cmp_eq_u32 s5, 1
    s_cbranch_scc1 Lkv_26
    v_cvt_pk_bf16_f32 v60, v56, v57
    v_cvt_pk_bf16_f32 v61, v58, v59
    v_lshl_add_u32 v5, v1, 3, s52
    ds_write_b64 v5, v[60:61]
    s_branch Lk_25
Lkv_26:
    s_cmp_lg_u32 s3, 2
    s_cbranch_scc1 Lk_27
    v_cmp_eq_u32 vcc, 1, v3
    s_nop 1
    v_cndmask_b32 v56, v56, 1.0, vcc
Lk_27:
    v_cvt_pk_bf16_f32 v60, v56, v57
    v_cvt_pk_bf16_f32 v61, v58, v59
    v_and_b32 v5, 0x13, v2
    v_bfe_u32 v6, v2, 2, 1
    v_lshl_add_u32 v5, v6, 3, v5
    v_bfe_u32 v6, v2, 3, 1
    v_lshl_add_u32 v5, v6, 2, v5
    v_lshlrev_b32 v5, 1, v5
    v_lshl_add_u32 v5, v3, 8, v5
    v_add_u32 v5, s52, v5
    ds_write_b16 v5, v60
    ds_write_b16_d16_hi v5, v60 offset:64
    ds_write_b16 v5, v61 offset:128
    ds_write_b16_d16_hi v5, v61 offset:192
Lk_25:
    s_waitcnt lgkmcnt(0)
    s_barrier
    s_cmp_ge_u32 s5, 2
    s_cbranch_scc1 Lk_28
    s_cmp_lg_u32 s3, 0
    s_cbranch_scc1 Lk_28
    s_cmp_eq_u32 s5, 1
    s_cbranch_scc1 Lk_29
    v_lshlrev_b32 v5, 3, v1
    v_add_u32 v5, 161792, v5
    ds_read_b64 v[56:57], v5
    ds_read_b64 v[58:59], v5 offset:512
    ds_read_b64 v[60:61], v5 offset:1024
    s_lshl_b32 s52, s4, 10
    s_add_u32 s52, s52, s64
    s_lshr_b32 s53, s4, 1
    s_lshl_b32 s53, s53, 10
    s_and_b32 s54, s4, 1
    s_lshl_b32 s54, s54, 3
    s_add_u32 s53, s53, s54
    s_add_u32 s53, s53, s64
    s_add_u32 s53, s53, 65536
    s_waitcnt lgkmcnt(0)
    buffer_store_dwordx4 v[56:59], v4, s[8:11], s52 offen sc1
    buffer_store_dwordx2 v[60:61], v4, s[8:11], s53 offen sc1
    s_branch Lk_28
Lk_29:
    v_min_u32 v5, 23, v2
    v_lshlrev_b32 v5, 6, v5
    v_lshl_add_u32 v5, v3, 4, v5
    v_add_u32 v5, 161792, v5
    ds_read_b128 v[56:59], v5
    ds_read_b128 v[60:63], v5 offset:32
    s_mul_i32 s52, s4, 1344
    s_add_u32 s52, s52, s64
    s_add_u32 s52, s52, 98304
    s_waitcnt lgkmcnt(0)
    buffer_store_dwordx4 v[56:59], v15, s[8:11], s52 offen sc1
    buffer_store_dwordx4 v[60:63], v15, s[8:11], s52 offen offset:672 sc1
Lk_28:
Lnk_24:
    v_fma_f32 v7, -v12, v248, v81
    v_mul_f32 v7, v7, v13
    s_lshl_b32 s52, s4, 5
    s_sub_u32 s52, 2047, s52
    s_mov_b32 s53, 0xfffff800
    v_ashrrev_i32 v6, 31, v7
    v_or_b32 v6, 0x80000000, v6
    v_xor_b32 v6, v6, v7
    v_sub_u32 v5, s52, v2
    v_and_or_b32 v249, v6, s53, v5
    v_mov_b32 v10, v249
    s_nop 1
    v_max_u32_dpp v10, v10, v10 row_ror:8 row_mask:0xf bank_mask:0xf
    s_nop 1
    v_max_u32_dpp v10, v10, v10 row_ror:4 row_mask:0xf bank_mask:0xf
    s_nop 1
    v_max_u32_dpp v10, v10, v10 row_ror:2 row_mask:0xf bank_mask:0xf
    s_nop 1
    v_max_u32_dpp v10, v10, v10 row_ror:1 row_mask:0xf bank_mask:0xf
    s_nop 1
    v_readlane_b32 s56, v10, 0
    v_readlane_b32 s57, v10, 16
    s_nop 3
    s_max_u32 s60, s56, s57
    v_cmp_eq_u32 s[32:33], s60, v249
    s_nop 1
    v_cndmask_b32 v8, v249, 0, s[32:33]
    v_mov_b32 v10, v8
    s_nop 1
    v_max_u32_dpp v10, v10, v10 row_ror:8 row_mask:0xf bank_mask:0xf
    s_nop 1
    v_max_u32_dpp v10, v10, v10 row_ror:4 row_mask:0xf bank_mask:0xf
    s_nop 1
    v_max_u32_dpp v10, v10, v10 row_ror:2 row_mask:0xf bank_mask:0xf
    s_nop 1
    v_max_u32_dpp v10, v10, v10 row_ror:1 row_mask:0xf bank_mask:0xf
    s_nop 1
    v_readlane_b32 s56, v10, 0
    v_readlane_b32 s57, v10, 16
    s_nop 3
    s_max_u32 s61, s56, s57
    v_cmp_eq_u32 vcc, s61, v249
    s_mul_i32 s52, s4, 2560
    s_mul_i32 s53, s5, 320
    s_add_u32 s52, s52, s53
    s_mul_i32 s53, s3, 80
    s_add_u32 s52, s52, s53
    s_add_u32 s52, s52, s65
    s_add_u32 s52, s52, 32768
    v_cndmask_b32 v5, 0, 1, vcc
    s_or_b64 exec, vcc, s[32:33]
    v_mul_u32_u24 v6, 1280, v5
    v_lshl_add_u32 v8, v3, 4, v6
    v_lshl_add_u32 v9, v3, 3, v6
    s_mov_b32 s54, s52
    s_or_b32 s52, s5, s3
    s_cmp_lg_u32 s52, 0
    s_cbranch_scc1 Lr_30
    v_mov_b32 v56, v249
    v_mov_b32 v57, v12
    v_mov_b32 v58, v13
    v_mov_b32 v59, v7
    v_lshlrev_b32 v5, 4, v5
    v_lshl_add_u32 v5, v3, 30, v5
    s_lshl_b32 s52, s4, 5
    s_add_u32 s52, s52, s65
    s_add_u32 s52, s52, 196608
    buffer_store_dwordx4 v[56:59], v5, s[8:11], s52 offen offset:0 sc1
    buffer_store_dwordx4 v[56:59], v5, s[8:11], s52 offen offset:2048 sc1
    s_add_u32 s52, s52, 4096
    buffer_store_dwordx4 v[56:59], v5, s[8:11], s52 offen offset:0 sc1
    buffer_store_dwordx4 v[56:59], v5, s[8:11], s52 offen offset:2048 sc1
    s_add_u32 s52, s52, 4096
    buffer_store_dwordx4 v[56:59], v5, s[8:11], s52 offen offset:0 sc1
    buffer_store_dwordx4 v[56:59], v5, s[8:11], s52 offen offset:2048 sc1
    s_add_u32 s52, s52, 4096
    buffer_store_dwordx4 v[56:59], v5, s[8:11], s52 offen offset:0 sc1
    buffer_store_dwordx4 v[56:59], v5, s[8:11], s52 offen offset:2048 sc1
Lr_30:
    buffer_store_dwordx4 v[116:119], v8, s[8:11], s54 offen sc1
    buffer_store_dwordx4 v[120:123], v8, s[8:11], s54 offen offset:32 sc1
    buffer_store_dwordx2 v[124:125], v9, s[8:11], s54 offen offset:64 sc1
    s_mov_b64 exec, -1
    s_cmp_lg_u32 s7, 0
    s_cbranch_scc1 L_tail
    v_mul_f32 v7, v12, v13
    v_add_f32 v8, 1.0, v13
    v_lshlrev_b32 v5, 16, v116
    v_and_b32 v6, 0xffff0000, v116
    v_fma_f32 v5, v5, v8, -v7
    v_fma_f32 v6, v6, v8, -v7
    v_cvt_pk_bf16_f32 v116, v5, v6
    v_lshlrev_b32 v5, 16, v117
    v_and_b32 v6, 0xffff0000, v117
    v_fma_f32 v5, v5, v8, -v7
    v_fma_f32 v6, v6, v8, -v7
    v_cvt_pk_bf16_f32 v117, v5, v6
    v_lshlrev_b32 v5, 16, v118
    v_and_b32 v6, 0xffff0000, v118
    v_fma_f32 v5, v5, v8, -v7
    v_fma_f32 v6, v6, v8, -v7
    v_cvt_pk_bf16_f32 v118, v5, v6
    v_lshlrev_b32 v5, 16, v119
    v_and_b32 v6, 0xffff0000, v119
    v_fma_f32 v5, v5, v8, -v7
    v_fma_f32 v6, v6, v8, -v7
    v_cvt_pk_bf16_f32 v119, v5, v6
    v_lshlrev_b32 v5, 16, v120
    v_and_b32 v6, 0xffff0000, v120
    v_fma_f32 v5, v5, v8, -v7
    v_fma_f32 v6, v6, v8, -v7
    v_cvt_pk_bf16_f32 v120, v5, v6
    v_lshlrev_b32 v5, 16, v121
    v_and_b32 v6, 0xffff0000, v121
    v_fma_f32 v5, v5, v8, -v7
    v_fma_f32 v6, v6, v8, -v7
    v_cvt_pk_bf16_f32 v121, v5, v6
    v_lshlrev_b32 v5, 16, v122
    v_and_b32 v6, 0xffff0000, v122
    v_fma_f32 v5, v5, v8, -v7
    v_fma_f32 v6, v6, v8, -v7
    v_cvt_pk_bf16_f32 v122, v5, v6
    v_lshlrev_b32 v5, 16, v123
    v_and_b32 v6, 0xffff0000, v123
    v_fma_f32 v5, v5, v8, -v7
    v_fma_f32 v6, v6, v8, -v7
    v_cvt_pk_bf16_f32 v123, v5, v6
    v_lshlrev_b32 v5, 16, v124
    v_and_b32 v6, 0xffff0000, v124
    v_fma_f32 v5, v5, v8, -v7
    v_fma_f32 v6, v6, v8, -v7
    v_cvt_pk_bf16_f32 v124, v5, v6
    v_lshlrev_b32 v5, 16, v125
    v_and_b32 v6, 0xffff0000, v125
    v_fma_f32 v5, v5, v8, -v7
    v_fma_f32 v6, v6, v8, -v7
    v_cvt_pk_bf16_f32 v125, v5, v6
    s_and_b32 s60, s60, 31
    s_and_b32 s61, s61, 31
    s_sub_u32 s60, 31, s60
    s_sub_u32 s61, 31, s61
    s_cmp_eq_u32 s61, 31
    s_cselect_b32 s56, 30, 31
    s_cmp_eq_u32 s60, 29
    s_cselect_b32 s57, 28, 29
    s_cmp_ge_u32 s60, 24
    s_cselect_b32 s60, s56, s60
    s_cmp_ge_u32 s61, 24
    s_cselect_b32 s61, s57, s61
    v_mov_b32 v5, v251
    v_cmp_eq_u32 vcc, s60, v5
    v_mov_b32 v6, s56
    s_nop 0
    v_cndmask_b32 v251, v251, v6, vcc
    v_cmp_eq_u32 vcc, s56, v5
    v_mov_b32 v6, s60
    s_nop 0
    v_cndmask_b32 v251, v251, v6, vcc
    v_cmp_eq_u32 vcc, s61, v5
    v_mov_b32 v6, s57
    s_nop 0
    v_cndmask_b32 v251, v251, v6, vcc
    v_cmp_eq_u32 vcc, s57, v5
    v_mov_b32 v6, s61
    s_nop 0
    v_cndmask_b32 v251, v251, v6, vcc
    v_mov_b32 v5, v250
    v_cmp_eq_u32 vcc, s60, v5
    v_mov_b32 v6, s56
    s_nop 0
    v_cndmask_b32 v250, v250, v6, vcc
    v_cmp_eq_u32 vcc, s56, v5
    v_mov_b32 v6, s60
    s_nop 0
    v_cndmask_b32 v250, v250, v6, vcc
    v_cmp_eq_u32 vcc, s61, v5
    v_mov_b32 v6, s57
    s_nop 0
    v_cndmask_b32 v250, v250, v6, vcc
    v_cmp_eq_u32 vcc, s57, v5
    v_mov_b32 v6, s61
    s_nop 0
    v_cndmask_b32 v250, v250, v6, vcc
    s_mov_b32 s7, 1
    s_mov_b32 s67, s65
    s_add_u32 s65, s65, 229376
    v_mfma_f32_32x32x16_bf16 a[240:255], v[168:171], v[16:19], 0
    v_mfma_f32_32x32x16_bf16 a[240:255], v[172:175], v[20:23], a[240:255]
    s_add_u32 s59, s3, 1
    s_and_b32 s59, s59, 3
    s_mul_i32 s59, s59, 10240
    v_add_u32 v7, s59, v4
    v_mfma_f32_32x32x16_bf16 a[240:255], v[176:179], v[24:27], a[240:255]
    s_add_u32 s59, s3, 2
    s_and_b32 s59, s59, 3
    s_mul_i32 s59, s59, 10240
    v_add_u32 v8, s59, v4
    v_mfma_f32_32x32x16_bf16 a[240:255], v[180:183], v[28:31], a[240:255]
    s_add_u32 s59, s3, 3
    s_and_b32 s59, s59, 3
    s_mul_i32 s59, s59, 10240
    v_add_u32 v9, s59, v4
    v_mfma_f32_32x32x16_bf16 a[240:255], v[184:187], v[32:35], a[240:255]
    ds_read_b128 v[68:71], v7 offset:0
    v_mfma_f32_32x32x16_bf16 a[240:255], v[188:191], v[36:39], a[240:255]
    ds_read_b128 v[72:75], v7 offset:1024
    v_mfma_f32_32x32x16_bf16 a[240:255], v[192:195], v[40:43], a[240:255]
    ds_read_b128 v[76:79], v7 offset:2048
    v_mfma_f32_32x32x16_bf16 a[240:255], v[196:199], v[44:47], a[240:255]
    ds_read_b128 v[80:83], v7 offset:3072
    v_mfma_f32_32x32x16_bf16 a[240:255], v[200:203], v[48:51], a[240:255]
    ds_read_b128 v[84:87], v7 offset:4096
    v_mfma_f32_32x32x16_bf16 a[240:255], v[204:207], v[52:55], a[240:255]
    ds_read_b128 v[88:91], v7 offset:5120
    s_cmp_lg_u32 s3, 0
    s_cbranch_scc1 Lkf_31
    s_lshl_b32 s62, s2, 6
    s_add_u32 s62, s62, s66
    s_waitcnt vmcnt(0)
    v_mov_b32 v5, s6
    v_mov_b32 v6, 0
    s_mov_b64 exec, 1
    buffer_store_dword v5, v6, s[8:11], s62 offen sc1
    s_mov_b64 exec, -1
Lkf_31:
    v_mfma_f32_32x32x16_bf16 v[96:111], v[208:211], v[16:19], 0
    s_lshl_b32 s59, s3, 12
    s_add_u32 s59, s59, 40960
    v_add_u32 v10, s59, v4
    s_lshl_b32 s59, s3, 10
    s_add_u32 s59, s59, 40960
    v_add_u32 v56, s59, v4
    v_mfma_f32_32x32x16_bf16 v[96:111], v[212:215], v[20:23], v[96:111]
    v_mfma_f32_32x32x16_bf16 v[96:111], v[216:219], v[24:27], v[96:111]
    v_mfma_f32_32x32x16_bf16 v[96:111], v[220:223], v[28:31], v[96:111]
    s_waitcnt vmcnt(3)
    v_mfma_f32_32x32x16_bf16 v[96:111], a[60:63], v[32:35], v[96:111]
    v_mfma_f32_32x32x16_bf16 v[96:111], a[92:95], v[36:39], v[96:111]
    v_mfma_f32_32x32x16_bf16 v[96:111], a[208:211], v[40:43], v[96:111]
    ds_write_b128 v10, a[240:243] offset:0
    ds_write_b128 v10, a[244:247] offset:1024
    ds_write_b128 v10, a[248:251] offset:2048
    ds_write_b128 v10, a[252:255] offset:3072
    v_mfma_f32_32x32x16_bf16 v[96:111], a[212:215], v[44:47], v[96:111]
    v_mfma_f32_32x32x16_bf16 v[96:111], a[216:219], v[48:51], v[96:111]
    v_mfma_f32_32x32x16_bf16 v[96:111], a[220:223], v[52:55], v[96:111]
    s_waitcnt lgkmcnt(5)
    v_mfma_f32_32x32x16_bf16 v[96:111], a[0:3], v[68:71], v[96:111]
    ds_read_b128 v[92:95], v7 offset:6144
    s_waitcnt lgkmcnt(5)
    v_mfma_f32_32x32x16_bf16 v[96:111], a[4:7], v[72:75], v[96:111]
    ds_read_b128 v[68:71], v7 offset:7168
    s_waitcnt lgkmcnt(5)
    v_mfma_f32_32x32x16_bf16 v[96:111], a[64:67], v[76:79], v[96:111]
    ds_read_b128 v[72:75], v7 offset:8192
    s_waitcnt lgkmcnt(5)
    v_mfma_f32_32x32x16_bf16 v[96:111], a[96:99], v[80:83], v[96:111]
    ds_read_b128 v[76:79], v7 offset:9216
    s_waitcnt lgkmcnt(5)
    v_mfma_f32_32x32x16_bf16 v[96:111], a[100:103], v[84:87], v[96:111]
    ds_read_b128 v[80:83], v8 offset:0
    s_waitcnt lgkmcnt(5)
    v_mfma_f32_32x32x16_bf16 v[96:111], a[8:11], v[88:91], v[96:111]
    ds_read_b128 v[84:87], v8 offset:1024
    s_waitcnt lgkmcnt(5)
    v_mfma_f32_32x32x16_bf16 v[96:111], a[104:107], v[92:95], v[96:111]
    ds_read_b128 v[88:91], v8 offset:2048
    s_waitcnt lgkmcnt(5)
    v_mfma_f32_32x32x16_bf16 v[96:111], a[108:111], v[68:71], v[96:111]
    ds_read_b128 v[92:95], v8 offset:3072
    s_waitcnt lgkmcnt(5)
    v_mfma_f32_32x32x16_bf16 v[96:111], a[12:15], v[72:75], v[96:111]
    ds_read_b128 v[68:71], v8 offset:4096
    s_waitcnt lgkmcnt(5)
    v_mfma_f32_32x32x16_bf16 v[96:111], a[68:71], v[76:79], v[96:111]
    ds_read_b128 v[72:75], v8 offset:5120
    s_waitcnt lgkmcnt(5)
    v_mfma_f32_32x32x16_bf16 v[96:111], a[112:115], v[80:83], v[96:111]
    ds_read_b128 v[76:79], v8 offset:6144
    s_waitcnt lgkmcnt(5)
    v_mfma_f32_32x32x16_bf16 v[96:111], a[116:119], v[84:87], v[96:111]
    ds_read_b128 v[80:83], v8 offset:7168
    s_waitcnt lgkmcnt(5)
    v_mfma_f32_32x32x16_bf16 v[96:111], a[16:19], v[88:91], v[96:111]
    ds_read_b128 v[84:87], v8 offset:8192
    s_waitcnt lgkmcnt(5)
    v_mfma_f32_32x32x16_bf16 v[96:111], a[120:123], v[92:95], v[96:111]
    ds_read_b128 v[88:91], v8 offset:9216
    s_waitcnt lgkmcnt(5)
    v_mfma_f32_32x32x16_bf16 v[96:111], a[124:127], v[68:71], v[96:111]
    ds_read_b128 v[92:95], v9 offset:0
    s_waitcnt lgkmcnt(5)
    v_mfma_f32_32x32x16_bf16 v[96:111], a[20:23], v[72:75], v[96:111]
    ds_read_b128 v[68:71], v9 offset:1024
    s_waitcnt lgkmcnt(5)
    v_mfma_f32_32x32x16_bf16 v[96:111], a[72:75], v[76:79], v[96:111]
    ds_read_b128 v[72:75], v9 offset:2048
    s_waitcnt lgkmcnt(5)
    v_mfma_f32_32x32x16_bf16 v[96:111], a[128:131], v[80:83], v[96:111]
    ds_read_b128 v[76:79], v9 offset:3072
    s_waitcnt lgkmcnt(5)
    v_mfma_f32_32x32x16_bf16 v[96:111], a[132:135], v[84:87], v[96:111]
    ds_read_b128 v[80:83], v9 offset:4096
    s_waitcnt lgkmcnt(5)
    v_mfma_f32_32x32x16_bf16 v[96:111], a[24:27], v[88:91], v[96:111]
    ds_read_b128 v[84:87], v9 offset:5120
    s_waitcnt lgkmcnt(5)
    v_mfma_f32_32x32x16_bf16 v[96:111], a[136:139], v[92:95], v[96:111]
    ds_read_b128 v[88:91], v9 offset:6144
    s_waitcnt lgkmcnt(5)
    v_mfma_f32_32x32x16_bf16 v[96:111], a[140:143], v[68:71], v[96:111]
    ds_read_b128 v[92:95], v9 offset:7168
    s_waitcnt lgkmcnt(5)
    v_mfma_f32_32x32x16_bf16 v[96:111], a[28:31], v[72:75], v[96:111]
    ds_read_b128 v[68:71], v9 offset:8192
    s_waitcnt lgkmcnt(5)
    v_mfma_f32_32x32x16_bf16 v[96:111], a[76:79], v[76:79], v[96:111]
    ds_read_b128 v[72:75], v9 offset:9216
    s_barrier
    s_waitcnt lgkmcnt(5)
    v_mfma_f32_32x32x16_bf16 v[96:111], a[144:147], v[80:83], v[96:111]
    s_waitcnt lgkmcnt(4)
    v_mfma_f32_32x32x16_bf16 v[96:111], a[148:151], v[84:87], v[96:111]
    s_waitcnt lgkmcnt(3)
    v_mfma_f32_32x32x16_bf16 v[96:111], a[32:35], v[88:91], v[96:111]
    s_waitcnt lgkmcnt(2)
    v_mfma_f32_32x32x16_bf16 v[96:111], a[152:155], v[92:95], v[96:111]
    s_waitcnt lgkmcnt(1)
    v_mfma_f32_32x32x16_bf16 v[96:111], a[156:159], v[68:71], v[96:111]
    s_waitcnt lgkmcnt(0)
    v_mfma_f32_32x32x16_bf16 v[96:111], a[36:39], v[72:75], v[96:111]
    ds_read_b128 v[68:71], v56 offset:0
    ds_read_b128 v[72:75], v56 offset:4096
    ds_read_b128 v[76:79], v56 offset:8192
    ds_read_b128 v[80:83], v56 offset:12288
    s_waitcnt lgkmcnt(0)
    s_barrier
    v_pk_add_f32 v[68:69], v[68:69], v[72:73]
    v_pk_add_f32 v[70:71], v[70:71], v[74:75]
    v_pk_add_f32 v[76:77], v[76:77], v[80:81]
    v_pk_add_f32 v[78:79], v[78:79], v[82:83]
    v_pk_add_f32 v[112:113], v[68:69], v[76:77]
    v_pk_add_f32 v[114:115], v[70:71], v[78:79]
    s_branch L_qpost
L_tail:
    s_mov_b32 s67, s65
    s_and_b32 s52, s2, 7
    s_lshl_b32 s52, s52, 11
    s_add_u32 s52, s52, s67
    s_add_u32 s52, s52, 196608
    buffer_load_dwordx4 v[208:211], v4, s[8:11], s52 offen sc1
    buffer_load_dwordx4 v[212:215], v4, s[8:11], s52 offen offset:1024 sc1
    v_cmp_eq_u32 vcc, s60, v249
    v_cmp_eq_u32 s[32:33], s61, v249
    v_mul_f32 v7, v12, v13
    v_add_f32 v8, 1.0, v13
    v_lshlrev_b32 v5, 16, v116
    v_and_b32 v6, 0xffff0000, v116
    v_fma_f32 v5, v5, v8, -v7
    v_fma_f32 v6, v6, v8, -v7
    v_cvt_pk_bf16_f32 v116, v5, v6
    v_lshlrev_b32 v5, 16, v117
    v_and_b32 v6, 0xffff0000, v117
    v_fma_f32 v5, v5, v8, -v7
    v_fma_f32 v6, v6, v8, -v7
    v_cvt_pk_bf16_f32 v117, v5, v6
    v_lshlrev_b32 v5, 16, v118
    v_and_b32 v6, 0xffff0000, v118
    v_fma_f32 v5, v5, v8, -v7
    v_fma_f32 v6, v6, v8, -v7
    v_cvt_pk_bf16_f32 v118, v5, v6
    v_lshlrev_b32 v5, 16, v119
    v_and_b32 v6, 0xffff0000, v119
    v_fma_f32 v5, v5, v8, -v7
    v_fma_f32 v6, v6, v8, -v7
    v_cvt_pk_bf16_f32 v119, v5, v6
    v_lshlrev_b32 v5, 16, v120
    v_and_b32 v6, 0xffff0000, v120
    v_fma_f32 v5, v5, v8, -v7
    v_fma_f32 v6, v6, v8, -v7
    v_cvt_pk_bf16_f32 v120, v5, v6
    v_lshlrev_b32 v5, 16, v121
    v_and_b32 v6, 0xffff0000, v121
    v_fma_f32 v5, v5, v8, -v7
    v_fma_f32 v6, v6, v8, -v7
    v_cvt_pk_bf16_f32 v121, v5, v6
    v_lshlrev_b32 v5, 16, v122
    v_and_b32 v6, 0xffff0000, v122
    v_fma_f32 v5, v5, v8, -v7
    v_fma_f32 v6, v6, v8, -v7
    v_cvt_pk_bf16_f32 v122, v5, v6
    v_lshlrev_b32 v5, 16, v123
    v_and_b32 v6, 0xffff0000, v123
    v_fma_f32 v5, v5, v8, -v7
    v_fma_f32 v6, v6, v8, -v7
    v_cvt_pk_bf16_f32 v123, v5, v6
    v_lshlrev_b32 v5, 16, v124
    v_and_b32 v6, 0xffff0000, v124
    v_fma_f32 v5, v5, v8, -v7
    v_fma_f32 v6, v6, v8, -v7
    v_cvt_pk_bf16_f32 v124, v5, v6
    v_lshlrev_b32 v5, 16, v125
    v_and_b32 v6, 0xffff0000, v125
    v_fma_f32 v5, v5, v8, -v7
    v_fma_f32 v6, v6, v8, -v7
    v_cvt_pk_bf16_f32 v125, v5, v6
    s_or_b64 s[60:61], vcc, s[32:33]
    s_mov_b32 s12, s88
    s_mov_b32 s13, s89
    s_mov_b32 s14, 2621440
    s_mov_b32 s15, 0x20000
    s_mul_i32 s56, s5, 320
    s_mul_i32 s57, s3, 80
    s_add_u32 s56, s56, s57
    s_mul_i32 s52, s4, 40960
    s_add_u32 s56, s56, s52
    v_mul_u32_u24 v5, 1280, v2
    v_lshl_add_u32 v6, v3, 3, v5
    v_lshl_add_u32 v5, v3, 4, v5
    s_andn2_b64 exec, exec, s[60:61]
    buffer_store_dwordx4 v[116:119], v5, s[12:15], s56 offen
    buffer_store_dwordx4 v[120:123], v5, s[12:15], s56 offen offset:32
    buffer_store_dwordx2 v[124:125], v6, s[12:15], s56 offen offset:64
    s_mov_b64 exec, -1
    v_mov_b32 v5, 0x3f803f80
    v_cmp_eq_u32 vcc, 2, v2
    s_nop 1
    v_cndmask_b32 v168, 0, v5, vcc
    v_mov_b32 v169, v168
    v_mov_b32 v170, v168
    v_mov_b32 v171, v168
    v_mov_b32 v172, v168
    v_mov_b32 v173, v168
    v_mov_b32 v174, v168
    v_mov_b32 v175, v168
    v_mov_b32 v176, v168
    v_mov_b32 v177, v168
    v_mov_b32 v178, v168
    v_mov_b32 v179, v168
    v_mov_b32 v180, v168
    v_mov_b32 v181, v168
    v_mov_b32 v182, v168
    v_mov_b32 v183, v168
    v_mov_b32 v184, v168
    v_mov_b32 v185, v168
    v_mov_b32 v186, v168
    v_mov_b32 v187, v168
    v_mov_b32 v188, v168
    v_mov_b32 v189, v168
    v_mov_b32 v190, v168
    v_mov_b32 v191, v168
    v_mov_b32 v192, v168
    v_mov_b32 v193, v168
    v_mov_b32 v194, v168
    v_mov_b32 v195, v168
    v_mov_b32 v196, v168
    v_mov_b32 v197, v168
    v_mov_b32 v198, v168
    v_mov_b32 v199, v168
    v_mov_b32 v200, v168
    v_mov_b32 v201, v168
    v_mov_b32 v202, v168
    v_mov_b32 v203, v168
    v_mov_b32 v204, v168
    v_mov_b32 v205, v168
    v_mov_b32 v206, v168
    v_mov_b32 v207, v168
    s_waitcnt vmcnt(3)
L_top2:
    s_mov_b32 s63, 0x80000
Lrt_32:
    v_max3_u32 v5, v208, v209, v210
    v_max3_u32 v5, v5, v211, v212
    v_max3_u32 v5, v5, v213, v214
    v_max_u32 v5, v5, v215
    v_cmp_eq_u32 vcc, -1, v5
    s_sub_u32 s63, s63, 1
    s_cbranch_scc1 Lrt_33
    s_nop 2
    s_cbranch_vccz Lrt_33
    s_and_b32 s52, s2, 7
    s_lshl_b32 s52, s52, 11
    s_add_u32 s52, s52, s67
    s_add_u32 s52, s52, 196608
    buffer_load_dwordx4 v[208:211], v4, s[8:11], s52 offen sc1
    buffer_load_dwordx4 v[212:215], v4, s[8:11], s52 offen offset:1024 sc1
    s_waitcnt vmcnt(0)
    s_branch Lrt_32
Lrt_33:
    v_max_u32 v8, v208, v212
    v_min_u32 v9, v208, v212
    v_mov_b32 v10, v8
    s_nop 1
    v_max_u32_dpp v10, v10, v10 row_ror:8 row_mask:0xf bank_mask:0xf
    s_nop 1
    v_max_u32_dpp v10, v10, v10 row_ror:4 row_mask:0xf bank_mask:0xf
    s_nop 1
    v_max_u32_dpp v10, v10, v10 row_ror:2 row_mask:0xf bank_mask:0xf
    s_nop 1
    v_max_u32_dpp v10, v10, v10 row_ror:1 row_mask:0xf bank_mask:0xf
    s_nop 1
    v_readlane_b32 s56, v10, 0
    v_readlane_b32 s57, v10, 16
    v_readlane_b32 s58, v10, 32
    v_readlane_b32 s59, v10, 48
    s_nop 1
    s_max_u32 s56, s56, s57
    s_max_u32 s58, s58, s59
    s_max_u32 s28, s56, s58
    v_cmp_eq_u32 vcc, s28, v8
    s_nop 1
    v_cndmask_b32 v8, v8, v9, vcc
    v_mov_b32 v10, v8
    s_nop 1
    v_max_u32_dpp v10, v10, v10 row_ror:8 row_mask:0xf bank_mask:0xf
    s_nop 1
    v_max_u32_dpp v10, v10, v10 row_ror:4 row_mask:0xf bank_mask:0xf
    s_nop 1
    v_max_u32_dpp v10, v10, v10 row_ror:2 row_mask:0xf bank_mask:0xf
    s_nop 1
    v_max_u32_dpp v10, v10, v10 row_ror:1 row_mask:0xf bank_mask:0xf
    s_nop 1
    v_readlane_b32 s56, v10, 0
    v_readlane_b32 s57, v10, 16
    v_readlane_b32 s58, v10, 32
    v_readlane_b32 s59, v10, 48
    s_nop 1
    s_max_u32 s56, s56, s57
    s_max_u32 s58, s58, s59
    s_max_u32 s29, s56, s58
    v_cmp_eq_u32 vcc, s28, v212
    v_cmp_eq_u32 s[32:33], s28, v208
    s_and_b32 s26, s28, 2047
    s_sub_u32 s26, 2047, s26
    v_cndmask_b32 v5, v209, v213, vcc
    v_cndmask_b32 v6, v210, v214, vcc
    v_cndmask_b32 v7, v211, v215, vcc
    s_cmp_lg_u64 vcc, 0
    s_cselect_b32 s53, 64, 0
    s_or_b64 vcc, vcc, s[32:33]
    s_ff1_i32_b64 s52, vcc
    s_add_u32 s53, s53, s52
    s_mul_i32 s100, s53, 1280
    s_nop 1
    v_readlane_b32 s78, v5, s52
    v_readlane_b32 s90, v6, s52
    v_readlane_b32 s0, v7, s52
    v_cmp_eq_u32 vcc, s29, v212
    v_cmp_eq_u32 s[32:33], s29, v208
    s_and_b32 s27, s29, 2047
    s_sub_u32 s27, 2047, s27
    v_cndmask_b32 v5, v209, v213, vcc
    v_cndmask_b32 v6, v210, v214, vcc
    v_cndmask_b32 v7, v211, v215, vcc
    s_cmp_lg_u64 vcc, 0
    s_cselect_b32 s53, 64, 0
    s_or_b64 vcc, vcc, s[32:33]
    s_ff1_i32_b64 s52, vcc
    s_add_u32 s53, s53, s52
    s_mul_i32 s101, s53, 1280
    s_nop 1
    v_readlane_b32 s79, v5, s52
    v_readlane_b32 s91, v6, s52
    v_readlane_b32 s1, v7, s52
    s_lshl_b32 s52, s4, 5
    v_add_u32 v5, s52, v2
    v_cmp_eq_u32 vcc, s26, v5
    v_cmp_eq_u32 s[32:33], s27, v5
    s_mov_b32 s24, 8
    s_nop 2
    s_or_b64 s[30:31], vcc, s[32:33]
    s_cselect_b32 s24, 12, 8
    s_cmp_ge_u32 s2, 128
    s_cbranch_scc1 L_d1
    s_cmp_ge_u32 s2, 108
    s_cbranch_scc1 L_nof
    s_or_b32 s24, s24, 1
    v_mul_u32_u24 v5, 13, v1
    v_lshrrev_b32 v5, 8, v5
    s_mul_i32 s54, s3, 320
    v_cmp_eq_u32 vcc, 1, v5
    s_add_u32 s54, s54, s67
    s_add_u32 s54, s54, 32768
    v_mov_b32 v7, s100
    v_mov_b32 v10, s101
    v_cndmask_b32 v7, v7, v10, vcc
    v_mul_u32_u24 v6, 320, v5
    v_sub_u32 v6, v4, v6
    v_lshrrev_b32 v5, 1, v5
    v_lshl_add_u32 v6, v5, 28, v6
    v_add_u32 v7, v7, v6
    buffer_load_dwordx4 v[228:231], v7, s[8:11], s54 offen sc1
    s_cmp_eq_u32 s67, 2686976
    s_cbranch_scc1 L_top2_ret
    s_mov_b32 s12, s88
    s_mov_b32 s13, s89
    s_mov_b32 s14, 2621440
    s_mov_b32 s15, 0x20000
    s_mul_i32 s56, s5, 320
    s_mul_i32 s57, s3, 80
    s_add_u32 s56, s56, s57
    s_mul_i32 s52, s4, 40960
    s_add_u32 s56, s56, s52
    v_mul_u32_u24 v5, 1280, v2
    v_lshl_add_u32 v6, v3, 3, v5
    v_lshl_add_u32 v5, v3, 4, v5
    s_andn2_b64 exec, s[60:61], s[30:31]
    buffer_store_dwordx4 v[116:119], v5, s[12:15], s56 offen
    buffer_store_dwordx4 v[120:123], v5, s[12:15], s56 offen offset:32
    buffer_store_dwordx2 v[124:125], v6, s[12:15], s56 offen offset:64
    s_mov_b64 exec, -1
L_u2:
    s_mul_i32 s52, s3, 10240
    s_add_u32 s52, s52, 98304
    v_bfe_u32 v5, v1, 2, 2
    v_lshl_add_u32 v5, v3, 3, v5
    v_lshlrev_b32 v5, 5, v5
    v_and_b32 v6, 3, v1
    v_lshl_add_u32 v5, v6, 3, v5
    v_bfe_u32 v6, v1, 4, 1
    v_mul_u32_u24 v6, 5120, v6
    v_add3_u32 v11, v5, v6, s52
    ds_read_b64_tr_b16 v[208:209], v11 offset:0
    ds_read_b64_tr_b16 v[210:211], v11 offset:128
    ds_read_b64_tr_b16 v[212:213], v11 offset:512
    ds_read_b64_tr_b16 v[214:215], v11 offset:640
    ds_read_b64_tr_b16 v[216:217], v11 offset:1024
    ds_read_b64_tr_b16 v[218:219], v11 offset:1152
    ds_read_b64_tr_b16 v[220:221], v11 offset:1536
    ds_read_b64_tr_b16 v[222:223], v11 offset:1664
    ds_read_b64_tr_b16 v[224:225], v11 offset:2048
    ds_read_b64_tr_b16 v[226:227], v11 offset:2176
    s_cmp_eq_u32 s67, 2686976
    s_cbranch_scc1 Luw_34
    s_waitcnt vmcnt(3)
Luw_34:
    s_mov_b32 s63, 0x80000
Lrt_35:
    s_waitcnt vmcnt(17)
    v_max3_u32 v5, v228, v229, v230
    v_max_u32 v5, v5, v231
    v_cmp_eq_u32 vcc, -1, v5
    s_sub_u32 s63, s63, 1
    s_cbranch_scc1 Lrt_36
    s_nop 2
    s_cbranch_vccz Lrt_36
    v_mul_u32_u24 v5, 13, v1
    v_lshrrev_b32 v5, 8, v5
    s_mul_i32 s54, s3, 320
    v_cmp_eq_u32 vcc, 1, v5
    s_add_u32 s54, s54, s67
    s_add_u32 s54, s54, 32768
    v_mov_b32 v7, s100
    v_mov_b32 v10, s101
    v_cndmask_b32 v7, v7, v10, vcc
    v_mul_u32_u24 v6, 320, v5
    v_sub_u32 v6, v4, v6
    v_lshrrev_b32 v5, 1, v5
    v_lshl_add_u32 v6, v5, 28, v6
    v_add_u32 v7, v7, v6
    buffer_load_dwordx4 v[228:231], v7, s[8:11], s54 offen sc1
    s_waitcnt vmcnt(0)
    s_branch Lrt_35
Lrt_36:
    s_lshl_b32 s52, s3, 10
    s_add_u32 s52, s52, 139264
    v_add_u32 v5, s52, v4
    v_mul_u32_u24 v6, 320, v2
    ds_write_b128 v5, v[228:231]
    v_lshl_add_u32 v6, v3, 4, v6
    s_mov_b32 s32, 3
    s_mov_b32 s33, 3
    v_add_u32 v6, s52, v6
    s_mov_b64 exec, s[32:33]
    ds_read_b128 v[168:171], v6 offset:0
    ds_read_b128 v[172:175], v6 offset:32
    ds_read_b128 v[176:179], v6 offset:64
    ds_read_b128 v[180:183], v6 offset:96
    ds_read_b128 v[184:187], v6 offset:128
    ds_read_b128 v[188:191], v6 offset:160
    ds_read_b128 v[192:195], v6 offset:192
    ds_read_b128 v[196:199], v6 offset:224
    ds_read_b128 v[200:203], v6 offset:256
    ds_read_b128 v[204:207], v6 offset:288
    s_mov_b64 exec, -1
    s_waitcnt lgkmcnt(0)
    v_mfma_f32_32x32x16_bf16 v[228:243], v[208:211], v[168:171], 0
    v_mfma_f32_32x32x16_bf16 v[228:243], v[212:215], v[172:175], v[228:243]
    v_mfma_f32_32x32x16_bf16 v[228:243], v[216:219], v[176:179], v[228:243]
    v_mfma_f32_32x32x16_bf16 v[228:243], v[220:223], v[180:183], v[228:243]
    v_mfma_f32_32x32x16_bf16 v[228:243], v[224:227], v[184:187], v[228:243]
    ds_read_b64_tr_b16 v[208:209], v11 offset:2560
    ds_read_b64_tr_b16 v[210:211], v11 offset:2688
    ds_read_b64_tr_b16 v[212:213], v11 offset:3072
    ds_read_b64_tr_b16 v[214:215], v11 offset:3200
    ds_read_b64_tr_b16 v[216:217], v11 offset:3584
    ds_read_b64_tr_b16 v[218:219], v11 offset:3712
    ds_read_b64_tr_b16 v[220:221], v11 offset:4096
    ds_read_b64_tr_b16 v[222:223], v11 offset:4224
    ds_read_b64_tr_b16 v[224:225], v11 offset:4608
    ds_read_b64_tr_b16 v[226:227], v11 offset:4736
    s_waitcnt lgkmcnt(0)
    v_mfma_f32_32x32x16_bf16 v[228:243], v[208:211], v[188:191], v[228:243]
    v_mfma_f32_32x32x16_bf16 v[228:243], v[212:215], v[192:195], v[228:243]
    v_mfma_f32_32x32x16_bf16 v[228:243], v[216:219], v[196:199], v[228:243]
    v_mfma_f32_32x32x16_bf16 v[228:243], v[220:223], v[200:203], v[228:243]
    v_mfma_f32_32x32x16_bf16 v[228:243], v[224:227], v[204:207], v[228:243]
    s_lshl_b32 s52, s3, 10
    s_add_u32 s52, s52, 139264
    v_lshl_add_u32 v5, v3, 3, v2
    v_lshl_add_u32 v5, v5, 4, s52
    s_mov_b32 s32, 0xff
    s_mov_b32 s33, 0xff
    s_nop 5
    s_mov_b64 exec, s[32:33]
    ds_write_b128 v5, v[228:231] offset:0
    ds_write_b128 v5, v[232:235] offset:256
    ds_write_b128 v5, v[236:239] offset:512
    ds_write_b128 v5, v[240:243] offset:768
    s_mov_b64 exec, -1
    s_waitcnt lgkmcnt(0)
    s_barrier
    s_cmp_lg_u32 s3, 0
    s_cbranch_scc1 Lue_37
    v_bfe_u32 v5, v1, 3, 1
    v_lshlrev_b32 v5, 8, v5
    v_bfe_u32 v6, v1, 2, 1
    v_lshl_add_u32 v5, v6, 7, v5
    v_and_b32 v7, 3, v1
    v_lshl_add_u32 v5, v7, 2, v5
    v_add_u32 v5, 139264, v5
    v_bfe_u32 v6, v1, 4, 1
    v_lshl_add_u32 v7, v6, 4, v5
    v_cmp_eq_u32 vcc, 1, v6
    ds_read_b32 v208, v7 offset:0
    ds_read_b32 v212, v7 offset:512
    ds_read_b32 v216, v5 offset:32
    ds_read_b32 v220, v5 offset:544
    ds_read_b32 v209, v7 offset:1024
    ds_read_b32 v213, v7 offset:1536
    ds_read_b32 v217, v5 offset:1056
    ds_read_b32 v221, v5 offset:1568
    ds_read_b32 v210, v7 offset:2048
    ds_read_b32 v214, v7 offset:2560
    ds_read_b32 v218, v5 offset:2080
    ds_read_b32 v222, v5 offset:2592
    ds_read_b32 v211, v7 offset:3072
    ds_read_b32 v215, v7 offset:3584
    ds_read_b32 v219, v5 offset:3104
    ds_read_b32 v223, v5 offset:3616
    v_mov_b32 v8, s78
    v_mov_b32 v10, s79
    v_cndmask_b32 v8, v8, v10, vcc
    v_mov_b32 v9, s90
    v_mov_b32 v10, s91
    v_cndmask_b32 v9, v9, v10, vcc
    s_waitcnt lgkmcnt(0)
    v_add_f32 v208, v208, v209
    v_add_f32 v210, v210, v211
    v_add_f32 v208, v208, v210
    v_add_f32 v212, v212, v213
    v_add_f32 v214, v214, v215
    v_add_f32 v212, v212, v214
    v_add_f32 v216, v216, v217
    v_add_f32 v218, v218, v219
    v_add_f32 v216, v216, v218
    v_add_f32 v220, v220, v221
    v_add_f32 v222, v222, v223
    v_add_f32 v220, v220, v222
    v_fma_f32 v208, -v8, v216, v208
    v_fma_f32 v212, -v8, v220, v212
    v_mul_f32 v208, v208, v9
    v_mul_f32 v212, v212, v9
    v_mul_f32 v209, 3216550459, v208
    v_exp_f32 v209, v209
    v_mul_f32 v208, v208, v212
    v_add_f32 v209, 1.0, v209
    v_rcp_f32 v209, v209
    v_mul_u32_u24 v6, 32, v6
    v_mul_f32 v208, v208, v209
    v_and_b32 v7, 15, v1
    v_lshl_add_u32 v6, v7, 1, v6
    v_mov_b32_dpp v209, v208 quad_perm:[1,0,3,2] row_mask:0xf bank_mask:0xf
    s_lshl_b32 s52, s2, 6
    v_cvt_pk_bf16_f32 v208, v208, v209
    s_add_u32 s52, s52, s67
    s_add_u32 s52, s52, 212992
    s_add_u32 s53, s52, 0x2000
    s_mov_b64 exec, 0x55555555
    buffer_store_dword v208, v6, s[8:11], s52 offen sc1
    buffer_store_dword v208, v6, s[8:11], s53 offen sc1
    s_mov_b64 exec, -1
Lue_37:
    s_cmp_eq_u32 s67, 2686976
    s_cbranch_scc1 L_u2_ret
    s_branch L_final
L_nof2:
    s_cmp_le_u32 s2, 228
    s_cselect_b32 s52, 16, 0
    s_cmp_eq_u32 s2, 232
    s_cselect_b32 s52, 16, s52
    s_or_b32 s24, s24, s52
L_nof:
    s_cmp_eq_u32 s67, 2686976
    s_cbranch_scc1 L_top2_ret
    s_mov_b32 s12, s88
    s_mov_b32 s13, s89
    s_mov_b32 s14, 2621440
    s_mov_b32 s15, 0x20000
    s_mul_i32 s56, s5, 320
    s_mul_i32 s57, s3, 80
    s_add_u32 s56, s56, s57
    s_mul_i32 s52, s4, 40960
    s_add_u32 s56, s56, s52
    v_mul_u32_u24 v5, 1280, v2
    v_lshl_add_u32 v6, v3, 3, v5
    v_lshl_add_u32 v5, v3, 4, v5
    s_andn2_b64 exec, s[60:61], s[30:31]
    buffer_store_dwordx4 v[116:119], v5, s[12:15], s56 offen
    buffer_store_dwordx4 v[120:123], v5, s[12:15], s56 offen offset:32
    buffer_store_dwordx2 v[124:125], v6, s[12:15], s56 offen offset:64
    s_mov_b64 exec, -1
    s_branch L_final
L_d1:
    s_cmp_ge_u32 s2, 208
    s_cbranch_scc1 L_nof2
    s_or_b32 s24, s24, 2
    s_mul_i32 s52, s3, 10240
    s_add_u32 s52, s52, 98304
    v_bfe_u32 v5, v1, 2, 2
    v_lshl_add_u32 v5, v3, 3, v5
    v_bfe_u32 v6, v1, 4, 1
    v_lshl_add_u32 v5, v6, 5, v5
    v_bfe_u32 v6, v1, 1, 1
    v_lshl_add_u32 v5, v6, 4, v5
    v_lshlrev_b32 v5, 4, v5
    v_and_b32 v6, 1, v1
    v_lshl_add_u32 v5, v6, 3, v5
    v_add_u32 v5, s52, v5
    ds_read_b64_tr_b16 v[212:213], v5 offset:0
    ds_read_b64_tr_b16 v[214:215], v5 offset:64
    ds_read_b64_tr_b16 v[216:217], v5 offset:1024
    ds_read_b64_tr_b16 v[218:219], v5 offset:1088
    ds_read_b64_tr_b16 v[220:221], v5 offset:2048
    ds_read_b64_tr_b16 v[222:223], v5 offset:2112
    ds_read_b64_tr_b16 v[224:225], v5 offset:3072
    ds_read_b64_tr_b16 v[226:227], v5 offset:3136
    ds_read_b64_tr_b16 v[228:229], v5 offset:4096
    ds_read_b64_tr_b16 v[230:231], v5 offset:4160
    ds_read_b64_tr_b16 v[232:233], v5 offset:5120
    ds_read_b64_tr_b16 v[234:235], v5 offset:5184
    ds_read_b64_tr_b16 v[236:237], v5 offset:6144
    ds_read_b64_tr_b16 v[238:239], v5 offset:6208
    v_bfe_u32 v5, v1, 3, 1
    v_cmp_eq_u32 vcc, 1, v5
    v_mov_b32 v242, s0
    v_mov_b32 v10, s1
    v_cndmask_b32 v242, v242, v10, vcc
    v_mov_b32 v241, s100
    v_mov_b32 v10, s101
    v_cndmask_b32 v241, v241, v10, vcc
    v_and_b32 v7, 7, v1
    v_lshl_add_u32 v241, v7, 1, v241
    v_bfe_u32 v5, v1, 2, 1
    v_mul_u32_u24 v5, 32, v5
    v_and_b32 v6, 3, v1
    v_lshl_add_u32 v5, v6, 6, v5
    v_lshl_add_u32 v5, v3, 4, v5
    v_lshrrev_b32 v6, 3, v2
    v_mul_f32 v242, 3216550459, v242
    v_exp_f32 v242, v242
    v_lshl_add_u32 v240, v6, 28, v5
    v_add_f32 v242, 1.0, v242
    v_rcp_f32 v242, v242
    s_cmp_eq_u32 s67, 2686976
    s_cbranch_scc1 L_top2_ret
    s_mov_b32 s12, s88
    s_mov_b32 s13, s89
    s_mov_b32 s14, 2621440
    s_mov_b32 s15, 0x20000
    s_mul_i32 s56, s5, 320
    s_mul_i32 s57, s3, 80
    s_add_u32 s56, s56, s57
    s_mul_i32 s52, s4, 40960
    s_add_u32 s56, s56, s52
    v_mul_u32_u24 v5, 1280, v2
    v_lshl_add_u32 v6, v3, 3, v5
    v_lshl_add_u32 v5, v3, 4, v5
    s_andn2_b64 exec, s[60:61], s[30:31]
    buffer_store_dwordx4 v[116:119], v5, s[12:15], s56 offen
    buffer_store_dwordx4 v[120:123], v5, s[12:15], s56 offen offset:32
    buffer_store_dwordx2 v[124:125], v6, s[12:15], s56 offen offset:64
    s_mov_b64 exec, -1
L_dh:
    s_sub_u32 s55, s2, 128
    s_lshl_b32 s56, s55, 4
    s_add_u32 s56, s56, s67
    s_add_u32 s56, s56, 32768
    s_mul_i32 s52, s3, 1792
    s_add_u32 s52, s52, s67
    s_add_u32 s52, s52, 212992
    s_and_b32 s53, s2, 1
    s_lshl_b32 s53, s53, 13
    s_add_u32 s52, s52, s53
    s_cmp_eq_u32 s3, 3
    s_cselect_b32 s53, 1073741824, s52
    buffer_load_dwordx4 v[168:171], v240, s[8:11], s52 offen offset:0 sc1
    buffer_load_dwordx4 v[172:175], v240, s[8:11], s52 offen offset:256 sc1
    buffer_load_dwordx4 v[176:179], v240, s[8:11], s52 offen offset:512 sc1
    buffer_load_dwordx4 v[180:183], v240, s[8:11], s52 offen offset:768 sc1
    buffer_load_dwordx4 v[184:187], v240, s[8:11], s52 offen offset:1024 sc1
    buffer_load_dwordx4 v[188:191], v240, s[8:11], s52 offen offset:1280 sc1
    buffer_load_dwordx4 v[192:195], v240, s[8:11], s53 offen offset:1536 sc1
    buffer_load_ushort v243, v241, s[8:11], s56 offen sc1
    s_cmp_eq_u32 s67, 2686976
    s_cbranch_scc1 L_dh_ret
L_d2:
    s_mov_b32 s63, 0x80000
Lrt_38:
    s_waitcnt vmcnt(0)
    v_max3_u32 v5, v168, v169, v170
    v_max3_u32 v6, v182, v183, v184
    v_max3_u32 v5, v5, v171, v172
    v_max3_u32 v6, v6, v185, v186
    v_max3_u32 v5, v5, v173, v174
    v_max3_u32 v6, v6, v187, v188
    v_max3_u32 v5, v5, v175, v176
    v_max3_u32 v6, v6, v189, v190
    v_max3_u32 v5, v5, v177, v178
    v_max3_u32 v6, v6, v191, v192
    v_max3_u32 v5, v5, v179, v180
    v_max3_u32 v6, v6, v193, v194
    v_max3_u32 v5, v5, v181, v195
    v_max_u32 v5, v5, v6
    v_lshl_or_b32 v6, v243, 16, v243
    v_max_u32 v5, v5, v6
    v_cmp_eq_u32 vcc, -1, v5
    s_sub_u32 s63, s63, 1
    s_cbranch_scc1 Lrt_39
    s_nop 2
    s_cbranch_vccz Lrt_39
    s_sub_u32 s55, s2, 128
    s_lshl_b32 s56, s55, 4
    s_add_u32 s56, s56, s67
    s_add_u32 s56, s56, 32768
    s_mul_i32 s52, s3, 1792
    s_add_u32 s52, s52, s67
    s_add_u32 s52, s52, 212992
    s_and_b32 s53, s2, 1
    s_lshl_b32 s53, s53, 13
    s_add_u32 s52, s52, s53
    s_cmp_eq_u32 s3, 3
    s_cselect_b32 s53, 1073741824, s52
    buffer_load_dwordx4 v[168:171], v240, s[8:11], s52 offen offset:0 sc1
    buffer_load_dwordx4 v[172:175], v240, s[8:11], s52 offen offset:256 sc1
    buffer_load_dwordx4 v[176:179], v240, s[8:11], s52 offen offset:512 sc1
    buffer_load_dwordx4 v[180:183], v240, s[8:11], s52 offen offset:768 sc1
    buffer_load_dwordx4 v[184:187], v240, s[8:11], s52 offen offset:1024 sc1
    buffer_load_dwordx4 v[188:191], v240, s[8:11], s52 offen offset:1280 sc1
    buffer_load_dwordx4 v[192:195], v240, s[8:11], s53 offen offset:1536 sc1
    buffer_load_ushort v243, v241, s[8:11], s56 offen sc1
    s_waitcnt vmcnt(0)
    s_branch Lrt_38
Lrt_39:
    s_waitcnt lgkmcnt(0)
    v_mfma_f32_32x32x16_bf16 v[196:211], v[212:215], v[168:171], 0
    v_mfma_f32_32x32x16_bf16 v[196:211], v[216:219], v[172:175], v[196:211]
    v_mfma_f32_32x32x16_bf16 v[196:211], v[220:223], v[176:179], v[196:211]
    v_mfma_f32_32x32x16_bf16 v[196:211], v[224:227], v[180:183], v[196:211]
    v_mfma_f32_32x32x16_bf16 v[196:211], v[228:231], v[184:187], v[196:211]
    v_mfma_f32_32x32x16_bf16 v[196:211], v[232:235], v[188:191], v[196:211]
    v_mfma_f32_32x32x16_bf16 v[196:211], v[236:239], v[192:195], v[196:211]
    s_lshl_b32 s52, s3, 10
    s_add_u32 s52, s52, 139264
    v_lshl_add_u32 v5, v3, 3, v2
    v_lshl_add_u32 v5, v5, 4, s52
    s_mov_b32 s32, 0xff
    s_mov_b32 s33, 0xff
    s_nop 5
    s_mov_b64 exec, s[32:33]
    ds_write_b128 v5, v[196:199] offset:0
    ds_write_b128 v5, v[200:203] offset:256
    ds_write_b128 v5, v[204:207] offset:512
    ds_write_b128 v5, v[208:211] offset:768
    s_mov_b64 exec, -1
    s_waitcnt lgkmcnt(0)
    s_barrier
    s_cmp_lg_u32 s3, 0
    s_cbranch_scc1 Lde_41
    v_bfe_u32 v11, v1, 3, 1
    v_lshlrev_b32 v5, 6, v11
    v_bfe_u32 v6, v1, 2, 1
    v_lshl_add_u32 v5, v6, 7, v5
    v_and_b32 v6, 3, v1
    v_lshl_add_u32 v5, v6, 2, v5
    v_add_u32 v5, 139264, v5
    v_cmp_eq_u32 vcc, 1, v11
    ds_read_b32 v168, v5 offset:0
    ds_read_b32 v169, v5 offset:272
    ds_read_b32 v170, v5 offset:544
    ds_read_b32 v171, v5 offset:816
    ds_read_b32 v172, v5 offset:1024
    ds_read_b32 v173, v5 offset:1296
    ds_read_b32 v174, v5 offset:1568
    ds_read_b32 v175, v5 offset:1840
    ds_read_b32 v176, v5 offset:2048
    ds_read_b32 v177, v5 offset:2320
    ds_read_b32 v178, v5 offset:2592
    ds_read_b32 v179, v5 offset:2864
    ds_read_b32 v180, v5 offset:3072
    ds_read_b32 v181, v5 offset:3344
    ds_read_b32 v182, v5 offset:3616
    ds_read_b32 v183, v5 offset:3888
    v_mov_b32 v8, s78
    v_mov_b32 v10, s79
    v_cndmask_b32 v8, v8, v10, vcc
    v_mov_b32 v9, s90
    v_mov_b32 v10, s91
    v_cndmask_b32 v9, v9, v10, vcc
    v_mov_b32 v7, s26
    v_mov_b32 v10, s27
    v_cndmask_b32 v7, v7, v10, vcc
    v_lshlrev_b32 v243, 16, v243
    v_sub_f32 v241, v243, v8
    v_fmac_f32 v243, v241, v9
    v_and_b32 v6, 7, v1
    s_sub_u32 s52, s2, 128
    s_lshl_b32 s52, s52, 4
    s_waitcnt lgkmcnt(0)
    v_add_f32 v168, v168, v169
    v_add_f32 v170, v170, v171
    v_add_f32 v172, v172, v173
    v_add_f32 v174, v174, v175
    v_add_f32 v168, v168, v170
    v_add_f32 v172, v172, v174
    v_add_f32 v168, v168, v172
    v_add_f32 v176, v176, v177
    v_add_f32 v178, v178, v179
    v_add_f32 v180, v180, v181
    v_add_f32 v182, v182, v183
    v_add_f32 v176, v176, v178
    v_add_f32 v180, v180, v182
    v_add_f32 v176, v176, v180
    v_add_f32 v168, v168, v176
    v_fmac_f32 v243, v168, v242
    v_lshlrev_b32 v6, 1, v6
    s_cmp_lg_u32 s67, 2686976
    v_mov_b32_dpp v241, v243 quad_perm:[1,0,3,2] row_mask:0xf bank_mask:0xf
    s_nop 0
    v_cvt_pk_bf16_f32 v243, v243, v241
    s_cbranch_scc1 Ldo_40
    v_mul_u32_u24 v5, 1280, v11
    v_add_u32 v6, v5, v6
    s_add_u32 s52, s52, 2699264
    s_mov_b64 exec, 0x5555
    buffer_store_dword v243, v6, s[8:11], s52 offen sc1
    s_mov_b64 exec, -1
    s_branch L_d2_ret
Ldo_40:
    s_mov_b32 s12, s88
    s_mov_b32 s13, s89
    s_mov_b32 s14, 2621440
    s_mov_b32 s15, 0x20000
    v_mul_u32_u24 v5, 1280, v7
    v_add_u32 v6, v5, v6
    s_mov_b64 exec, 0x5555
    buffer_store_dword v243, v6, s[12:15], s52 offen
    s_mov_b64 exec, -1
Lde_41:
    s_cmp_eq_u32 s67, 2686976
    s_cbranch_scc1 L_d2_ret
L_final:
L_dump:
L_exit2:
    s_endpgm
L_h1:
    s_sub_u32 s52, s2, 208
    s_min_u32 s52, s52, 19
    s_mul_i32 s29, s52, 40960
    s_mul_i32 s52, s3, 10240
    s_add_u32 s29, s29, s52
    s_add_u32 s29, s29, 1048576
    buffer_load_dwordx4 v[224:227], v4, s[8:11], s29 offen offset:0 sc1
    buffer_load_dwordx4 v[228:231], v4, s[8:11], s29 offen offset:1024 sc1
    buffer_load_dwordx4 v[232:235], v4, s[8:11], s29 offen offset:2048 sc1
    buffer_load_dwordx4 v[236:239], v4, s[8:11], s29 offen offset:3072 sc1
    buffer_load_dwordx4 v[240:243], v254, s[8:11], s29 offen offset:0 sc1
    v_mul_u32_u24 v5, 13, v1
    v_lshrrev_b32 v5, 8, v5
    s_mul_i32 s54, s3, 320
    v_mul_u32_u24 v6, 960, v5
    s_add_u32 s54, s54, 2699264
    v_lshrrev_b32 v5, 1, v5
    v_lshl_add_u32 v6, v5, 28, v6
    v_add_u32 v7, v4, v6
    buffer_load_dwordx4 v[208:211], v7, s[8:11], s54 offen sc1
    s_cmp_lt_u32 s2, 228
    s_cbranch_scc1 L_h1_ret
    v_cmp_eq_u32 vcc, 1, v3
    v_mov_b32 v5, s26
    v_mov_b32 v10, s27
    v_cndmask_b32 v5, v5, v10, vcc
    v_lshrrev_b32 v6, 5, v5
    s_cmp_eq_u32 s2, 232
    s_cbranch_scc0 Lhk_42
    v_mul_u32_u24 v6, 1344, v6
    v_bfe_u32 v7, v5, 4, 1
    v_mul_u32_u24 v7, 672, v7
    v_bfe_u32 v8, v5, 2, 1
    v_mul_u32_u24 v8, 336, v8
    v_add3_u32 v6, v6, v7, v8
    v_bfe_u32 v7, v5, 3, 1
    v_lshl_add_u32 v6, v7, 3, v6
    v_and_b32 v7, 3, v5
    v_lshl_add_u32 v6, v7, 1, v6
    v_lshl_add_u32 v6, v2, 4, v6
    s_add_u32 s52, s64, 98304
    buffer_load_ushort v13, v6, s[8:11], s52 offen sc1
    s_branch L_h1_ret
Lhk_42:
    v_bfe_u32 v7, v2, 2, 1
    v_and_b32 v8, 31, v5
    v_lshl_add_u32 v8, v7, 5, v8
    v_lshlrev_b32 v8, 4, v8
    v_and_b32 v9, 3, v2
    v_lshl_add_u32 v8, v9, 1, v8
    v_lshl_add_u32 v9, v6, 10, v8
    v_bfe_u32 v7, v2, 3, 1
    v_lshl_add_u32 v9, v7, 3, v9
    v_lshrrev_b32 v7, 1, v6
    v_lshl_add_u32 v8, v7, 10, v8
    v_and_b32 v7, 1, v6
    v_lshl_add_u32 v8, v7, 3, v8
    v_add_u32 v8, 65536, v8
    v_cmp_lt_u32 vcc, 15, v2
    s_nop 1
    v_cndmask_b32 v9, v9, v8, vcc
    v_and_b32 v9, -4, v9
    buffer_load_dword v13, v9, s[8:11], s64 offen sc1
    s_branch L_h1_ret
L_h2:
    s_mov_b32 s63, 0x80000
Lrt_43:
    s_waitcnt vmcnt(0)
    v_max3_u32 v5, v208, v209, v210
    v_max_u32 v5, v5, v211
    v_cmp_eq_u32 vcc, -1, v5
    s_sub_u32 s63, s63, 1
    s_cbranch_scc1 Lrt_44
    s_nop 2
    s_cbranch_vccz Lrt_44
    v_mul_u32_u24 v5, 13, v1
    v_lshrrev_b32 v5, 8, v5
    s_mul_i32 s54, s3, 320
    v_mul_u32_u24 v6, 960, v5
    s_add_u32 s54, s54, 2699264
    v_lshrrev_b32 v5, 1, v5
    v_lshl_add_u32 v6, v5, 28, v6
    v_add_u32 v7, v4, v6
    buffer_load_dwordx4 v[208:211], v7, s[8:11], s54 offen sc1
    s_waitcnt vmcnt(0)
    s_branch Lrt_43
Lrt_44:
    s_lshl_b32 s52, s3, 10
    s_add_u32 s52, s52, 139264
    v_add_u32 v5, s52, v4
    v_mul_u32_u24 v6, 320, v2
    ds_write_b128 v5, v[208:211]
    v_lshl_add_u32 v6, v3, 4, v6
    s_mov_b32 s32, 3
    s_mov_b32 s33, 3
    v_add_u32 v6, s52, v6
    s_mov_b64 exec, s[32:33]
    ds_read_b128 v[168:171], v6 offset:0
    ds_read_b128 v[172:175], v6 offset:32
    ds_read_b128 v[176:179], v6 offset:64
    ds_read_b128 v[180:183], v6 offset:96
    ds_read_b128 v[184:187], v6 offset:128
    ds_read_b128 v[188:191], v6 offset:160
    ds_read_b128 v[192:195], v6 offset:192
    ds_read_b128 v[196:199], v6 offset:224
    ds_read_b128 v[200:203], v6 offset:256
    ds_read_b128 v[204:207], v6 offset:288
    s_mov_b64 exec, -1
    s_waitcnt lgkmcnt(0)
    s_cmp_ge_u32 s2, 228
    s_cbranch_scc1 L_h2kv
    v_mfma_f32_32x32x16_bf16 v[208:223], v[224:227], v[168:171], 0
    v_mfma_f32_16x16x32_bf16 v[6:9], v[168:171], v[168:171], 0
    v_mfma_f32_16x16x32_bf16 v[6:9], v[172:175], v[172:175], v[6:9]
    v_mfma_f32_32x32x16_bf16 v[208:223], v[228:231], v[172:175], v[208:223]
    v_mfma_f32_16x16x32_bf16 v[6:9], v[176:179], v[176:179], v[6:9]
    v_mfma_f32_16x16x32_bf16 v[6:9], v[180:183], v[180:183], v[6:9]
    v_mfma_f32_32x32x16_bf16 v[208:223], v[232:235], v[176:179], v[208:223]
    v_mfma_f32_16x16x32_bf16 v[6:9], v[184:187], v[184:187], v[6:9]
    v_mfma_f32_16x16x32_bf16 v[6:9], v[188:191], v[188:191], v[6:9]
    v_mfma_f32_32x32x16_bf16 v[208:223], v[236:239], v[180:183], v[208:223]
    v_mfma_f32_16x16x32_bf16 v[6:9], v[192:195], v[192:195], v[6:9]
    v_mfma_f32_16x16x32_bf16 v[6:9], v[196:199], v[196:199], v[6:9]
    v_mfma_f32_32x32x16_bf16 v[208:223], v[240:243], v[184:187], v[208:223]
    v_mfma_f32_16x16x32_bf16 v[6:9], v[200:203], v[200:203], v[6:9]
    v_mfma_f32_16x16x32_bf16 v[6:9], v[204:207], v[204:207], v[6:9]
    s_add_u32 s29, s29, 5120
    buffer_load_dwordx4 v[224:227], v4, s[8:11], s29 offen offset:0 sc1
    buffer_load_dwordx4 v[228:231], v4, s[8:11], s29 offen offset:1024 sc1
    buffer_load_dwordx4 v[232:235], v4, s[8:11], s29 offen offset:2048 sc1
    buffer_load_dwordx4 v[236:239], v4, s[8:11], s29 offen offset:3072 sc1
    buffer_load_dwordx4 v[240:243], v254, s[8:11], s29 offen offset:0 sc1
    s_lshl_b32 s52, s3, 10
    s_add_u32 s52, s52, 139264
    v_lshl_add_u32 v5, v2, 4, s52
    v_cmp_eq_u32 vcc, 1, v2
    s_nop 3
    v_cndmask_b32 v6, v6, v7, vcc
    s_mov_b64 exec, 3
    ds_write_b32 v5, v8 offset:768
    ds_write_b32 v5, v6 offset:776
    s_mov_b64 exec, -1
    s_branch L_h2_ret
L_h2kv:
    v_mfma_f32_32x32x16_bf16 v[208:223], v[128:131], v[168:171], 0
    v_mfma_f32_16x16x32_bf16 v[6:9], v[168:171], v[168:171], 0
    v_mfma_f32_32x32x16_bf16 v[208:223], v[132:135], v[172:175], v[208:223]
    v_mfma_f32_16x16x32_bf16 v[6:9], v[172:175], v[172:175], v[6:9]
    v_mfma_f32_32x32x16_bf16 v[208:223], v[136:139], v[176:179], v[208:223]
    v_mfma_f32_16x16x32_bf16 v[6:9], v[176:179], v[176:179], v[6:9]
    v_mfma_f32_32x32x16_bf16 v[208:223], v[140:143], v[180:183], v[208:223]
    v_mfma_f32_16x16x32_bf16 v[6:9], v[180:183], v[180:183], v[6:9]
    v_mfma_f32_32x32x16_bf16 v[208:223], v[144:147], v[184:187], v[208:223]
    v_mfma_f32_16x16x32_bf16 v[6:9], v[184:187], v[184:187], v[6:9]
    v_mfma_f32_32x32x16_bf16 v[208:223], v[148:151], v[188:191], v[208:223]
    v_mfma_f32_16x16x32_bf16 v[6:9], v[188:191], v[188:191], v[6:9]
    v_mfma_f32_32x32x16_bf16 v[208:223], v[152:155], v[192:195], v[208:223]
    v_mfma_f32_16x16x32_bf16 v[6:9], v[192:195], v[192:195], v[6:9]
    v_mfma_f32_32x32x16_bf16 v[208:223], v[156:159], v[196:199], v[208:223]
    v_mfma_f32_16x16x32_bf16 v[6:9], v[196:199], v[196:199], v[6:9]
    v_mfma_f32_32x32x16_bf16 v[208:223], v[160:163], v[200:203], v[208:223]
    v_mfma_f32_16x16x32_bf16 v[6:9], v[200:203], v[200:203], v[6:9]
    v_mfma_f32_32x32x16_bf16 v[208:223], v[164:167], v[204:207], v[208:223]
    v_mfma_f32_16x16x32_bf16 v[6:9], v[204:207], v[204:207], v[6:9]
    s_nop 3
    s_lshl_b32 s52, s3, 10
    s_add_u32 s52, s52, 139264
    v_lshl_add_u32 v5, v3, 3, v2
    v_lshl_add_u32 v5, v5, 4, s52
    s_mov_b32 s32, 0xff
    s_mov_b32 s33, 0xff
    s_nop 5
    s_mov_b64 exec, s[32:33]
    ds_write_b128 v5, v[208:211] offset:0
    ds_write_b128 v5, v[212:215] offset:256
    ds_write_b128 v5, v[216:219] offset:512
    ds_write_b128 v5, v[220:223] offset:768
    s_mov_b64 exec, -1
    s_lshl_b32 s52, s3, 10
    s_add_u32 s52, s52, 139264
    v_lshl_add_u32 v5, v2, 4, s52
    v_cmp_eq_u32 vcc, 1, v2
    s_nop 3
    v_cndmask_b32 v6, v6, v7, vcc
    s_mov_b64 exec, 3
    ds_write_b32 v5, v8 offset:768
    ds_write_b32 v5, v6 offset:776
    s_mov_b64 exec, -1
    s_branch L_h2_ret
L_h3:
    s_cmp_ge_u32 s2, 228
    s_cbranch_scc1 L_h3kv
    s_waitcnt vmcnt(1)
    v_mfma_f32_32x32x16_bf16 v[208:223], v[224:227], v[188:191], v[208:223]
    v_mfma_f32_32x32x16_bf16 v[208:223], v[228:231], v[192:195], v[208:223]
    v_mfma_f32_32x32x16_bf16 v[208:223], v[232:235], v[196:199], v[208:223]
    v_mfma_f32_32x32x16_bf16 v[208:223], v[236:239], v[200:203], v[208:223]
    v_mfma_f32_32x32x16_bf16 v[208:223], v[240:243], v[204:207], v[208:223]
    s_lshl_b32 s52, s3, 10
    s_add_u32 s52, s52, 143360
    v_lshl_add_u32 v5, v3, 3, v2
    v_lshl_add_u32 v5, v5, 4, s52
    s_mov_b32 s32, 0xff
    s_mov_b32 s33, 0xff
    s_nop 5
    s_mov_b64 exec, s[32:33]
    ds_write_b128 v5, v[208:211] offset:0
    ds_write_b128 v5, v[212:215] offset:256
    ds_write_b128 v5, v[216:219] offset:512
    ds_write_b128 v5, v[220:223] offset:768
    s_mov_b64 exec, -1
L_h3kv:
    s_waitcnt lgkmcnt(0)
    s_barrier
    s_cmp_lg_u32 s3, 0
    s_cbranch_scc1 L_h3_ret
    s_cmp_lt_u32 s2, 228
    s_cselect_b32 s52, 4096, 0
    s_add_u32 s52, s52, 139264
    v_lshrrev_b32 v5, 3, v2
    v_lshlrev_b32 v5, 8, v5
    v_bfe_u32 v6, v2, 2, 1
    v_lshl_add_u32 v5, v6, 7, v5
    v_and_b32 v7, 3, v2
    v_lshl_add_u32 v5, v7, 2, v5
    v_add_u32 v5, s52, v5
    v_lshl_add_u32 v6, v3, 4, v5
    v_lshlrev_b32 v7, 4, v3
    v_add_u32 v7, 140032, v7
    ds_read_b32 v208, v6 offset:0
    ds_read_b32 v212, v5 offset:32
    ds_read_b32 v216, v7 offset:0
    ds_read_b32 v220, v7 offset:8
    ds_read_b32 v209, v6 offset:1024
    ds_read_b32 v213, v5 offset:1056
    ds_read_b32 v217, v7 offset:1024
    ds_read_b32 v221, v7 offset:1032
    ds_read_b32 v210, v6 offset:2048
    ds_read_b32 v214, v5 offset:2080
    ds_read_b32 v218, v7 offset:2048
    ds_read_b32 v222, v7 offset:2056
    ds_read_b32 v211, v6 offset:3072
    ds_read_b32 v215, v5 offset:3104
    ds_read_b32 v219, v7 offset:3072
    ds_read_b32 v223, v7 offset:3080
    s_waitcnt lgkmcnt(0)
    v_add_f32 v208, v208, v209
    v_add_f32 v210, v210, v211
    v_add_f32 v208, v208, v210
    v_add_f32 v212, v212, v213
    v_add_f32 v214, v214, v215
    v_add_f32 v212, v212, v214
    v_add_f32 v216, v216, v217
    v_add_f32 v218, v218, v219
    v_add_f32 v216, v216, v218
    v_add_f32 v220, v220, v221
    v_add_f32 v222, v222, v223
    v_add_f32 v220, v220, v222
    v_mul_f32 v216, 986500301, v216
    v_mul_f32 v220, 986500301, v220
    v_fma_f32 v220, -v216, v216, v220
    v_max_f32 v220, 0, v220
    v_add_f32 v220, 925353388, v220
    v_rsq_f32 v220, v220
    v_fma_f32 v208, -v216, v212, v208
    v_mul_f32 v208, v208, v220
    s_cmp_eq_u32 s2, 232
    s_cbranch_scc1 Lhv_46
    s_cmp_lt_u32 s2, 228
    s_cselect_b32 s52, 1051011932, 1.0
    v_mul_f32 v208, s52, v208
    s_mov_b32 s32, 0x55555555
    s_mov_b32 s33, 0x55555555
    v_mov_b32_dpp v209, v208 quad_perm:[1,0,3,2] row_mask:0xf bank_mask:0xf
    s_nop 0
    v_cvt_pk_bf16_f32 v208, v208, v209
    s_cbranch_scc1 Lhq_45
    v_bfe_u32 v5, v2, 2, 1
    v_lshl_add_u32 v5, v3, 2, v5
    v_and_b32 v6, 3, v2
    v_lshlrev_b32 v6, 1, v6
    v_lshl_add_u32 v7, v5, 4, v6
    v_bfe_u32 v209, v2, 3, 1
    v_lshl_add_u32 v7, v209, 3, v7
    v_lshl_add_u32 v6, v5, 3, v6
    v_add_u32 v6, 256, v6
    v_cmp_lt_u32 vcc, 15, v2
    v_add_u32 v5, 32, v7
    v_add_u32 v209, 16, v6
    v_cndmask_b32 v7, v7, v6, vcc
    v_cndmask_b32 v5, v5, v209, vcc
    s_mov_b32 s52, 2703360
    s_mov_b32 s32, 0x555555
    s_mov_b32 s33, 0x555555
    s_mov_b64 exec, s[32:33]
    buffer_store_dword v13, v7, s[8:11], s52 offen sc1
    buffer_store_dword v208, v5, s[8:11], s52 offen sc1
    s_mov_b64 exec, -1
    s_branch L_h3_ret
Lhq_45:
    v_mul_u32_u24 v5, 1280, v3
    v_lshl_add_u32 v5, v2, 1, v5
    s_sub_u32 s52, s2, 208
    s_lshl_b32 s52, s52, 6
    s_add_u32 s52, s52, 2707456
    s_mov_b64 exec, s[32:33]
    buffer_store_dword v208, v5, s[8:11], s52 offen sc1
    s_mov_b64 exec, -1
    s_branch L_h3_ret
Lhv_46:
    v_cvt_pk_bf16_f32 v208, v208, v208
    v_xor_b32 v13, 0x8000, v13
    v_mov_b32 v5, 0x3f80bf80
    v_mov_b32 v6, 0x00003f80
    v_cmp_eq_u32 vcc, 20, v2
    v_lshl_or_b32 v208, v208, 16, v13
    v_lshlrev_b32 v7, 3, v2
    v_cndmask_b32 v208, v208, v5, vcc
    v_cmp_eq_u32 vcc, 21, v2
    v_lshl_add_u32 v7, v3, 2, v7
    s_mov_b32 s52, 2703872
    v_cndmask_b32 v208, v208, v6, vcc
    s_mov_b32 s32, 0x3fffff
    s_mov_b32 s33, 0x3fffff
    s_mov_b64 exec, s[32:33]
    buffer_store_dword v208, v7, s[8:11], s52 offen sc1
    s_mov_b64 exec, -1
    s_branch L_h3_ret
L_s1:
    s_lshl_b32 s52, s4, 5
    s_sub_u32 s52, s27, s52
    v_cmp_eq_u32 vcc, s52, v2
    s_mul_i32 s56, s5, 320
    s_mul_i32 s57, s3, 80
    v_cndmask_b32 v5, 0, 1, vcc
    v_mul_u32_u24 v5, 1280, v5
    v_lshl_add_u32 v7, v3, 3, v5
    v_lshl_add_u32 v8, v3, 4, v5
    s_add_u32 s52, s56, 2707456
    s_lshl_b32 s53, s3, 6
    s_add_u32 s53, s53, s52
    s_lshl_b32 s54, s3, 4
    s_add_u32 s54, s54, s52
    s_add_u32 s56, s56, s57
    s_add_u32 s56, s56, 2699264
    s_mov_b64 exec, s[30:31]
    buffer_load_dwordx2 v[168:169], v7, s[8:11], s53 offen offset:0 sc1
    buffer_load_dwordx2 v[170:171], v7, s[8:11], s53 offen offset:16 sc1
    buffer_load_dwordx2 v[172:173], v7, s[8:11], s53 offen offset:32 sc1
    buffer_load_dwordx2 v[174:175], v7, s[8:11], s53 offen offset:48 sc1
    buffer_load_dwordx2 v[176:177], v7, s[8:11], s54 offen offset:256 sc1
    buffer_load_dwordx4 v[116:119], v8, s[8:11], s56 offen sc1
    buffer_load_dwordx4 v[120:123], v8, s[8:11], s56 offen offset:32 sc1
    buffer_load_dwordx2 v[124:125], v7, s[8:11], s56 offen offset:64 sc1
    s_mov_b64 exec, -1
    s_branch L_s1_ret
L_s2:
    s_mov_b64 exec, s[30:31]
    s_mov_b32 s63, 0x80000
Lrt_47:
    s_waitcnt vmcnt(0)
    v_max3_u32 v5, v168, v169, v170
    v_max3_u32 v6, v116, v117, v118
    v_max3_u32 v5, v5, v171, v172
    v_max3_u32 v6, v6, v119, v120
    v_max3_u32 v5, v5, v173, v174
    v_max3_u32 v6, v6, v121, v122
    v_max3_u32 v5, v5, v175, v176
    v_max3_u32 v6, v6, v123, v124
    v_max3_u32 v5, v5, v177, v125
    v_max_u32 v5, v5, v6
    v_cmp_eq_u32 vcc, -1, v5
    s_sub_u32 s63, s63, 1
    s_cbranch_scc1 Lrt_48
    s_nop 2
    s_cbranch_vccz Lrt_48
    s_mov_b64 exec, -1
    s_lshl_b32 s52, s4, 5
    s_sub_u32 s52, s27, s52
    v_cmp_eq_u32 vcc, s52, v2
    s_mul_i32 s56, s5, 320
    s_mul_i32 s57, s3, 80
    v_cndmask_b32 v5, 0, 1, vcc
    v_mul_u32_u24 v5, 1280, v5
    v_lshl_add_u32 v7, v3, 3, v5
    v_lshl_add_u32 v8, v3, 4, v5
    s_add_u32 s52, s56, 2707456
    s_lshl_b32 s53, s3, 6
    s_add_u32 s53, s53, s52
    s_lshl_b32 s54, s3, 4
    s_add_u32 s54, s54, s52
    s_add_u32 s56, s56, s57
    s_add_u32 s56, s56, 2699264
    s_mov_b64 exec, s[30:31]
    buffer_load_dwordx2 v[168:169], v7, s[8:11], s53 offen offset:0 sc1
    buffer_load_dwordx2 v[170:171], v7, s[8:11], s53 offen offset:16 sc1
    buffer_load_dwordx2 v[172:173], v7, s[8:11], s53 offen offset:32 sc1
    buffer_load_dwordx2 v[174:175], v7, s[8:11], s53 offen offset:48 sc1
    buffer_load_dwordx2 v[176:177], v7, s[8:11], s54 offen offset:256 sc1
    buffer_load_dwordx4 v[116:119], v8, s[8:11], s56 offen sc1
    buffer_load_dwordx4 v[120:123], v8, s[8:11], s56 offen offset:32 sc1
    buffer_load_dwordx2 v[124:125], v7, s[8:11], s56 offen offset:64 sc1
    s_waitcnt vmcnt(0)
    s_branch Lrt_47
Lrt_48:
    s_lshl_b32 s52, s3, 11
    s_add_u32 s52, s52, 147456
    s_lshl_b32 s53, s3, 9
    s_add_u32 s53, s53, 155648
    v_lshl_add_u32 v7, v3, 5, v251
    v_lshl_add_u32 v6, v7, 4, s52
    v_lshl_add_u32 v7, v7, 3, s53
    ds_write_b128 v6, v[168:171]
    ds_write_b128 v6, v[172:175] offset:1024
    ds_write_b64 v7, v[176:177]
    s_mov_b64 exec, -1
    s_waitcnt lgkmcnt(0)
    s_barrier
    s_branch L_s2_ret
L_lt1:
    v_lshl_add_u32 v5, v2, 1, v3
    v_lshrrev_b32 v6, 2, v2
    v_lshlrev_b32 v6, 28, v6
    v_lshl_add_u32 v7, v5, 4, v6
    v_lshl_add_u32 v8, v5, 3, v6
    v_cmp_lt_u32 vcc, 21, v1
    v_lshlrev_b32 v9, 3, v1
    v_mov_b32 v10, 1073741824
    s_mov_b32 s52, 2703360
    v_cndmask_b32 v9, v9, v10, vcc
    buffer_load_dwordx4 v[168:171], v7, s[8:11], s52 offen sc1
    buffer_load_dwordx2 v[172:173], v8, s[8:11], s52 offen offset:256 sc1
    buffer_load_dwordx2 v[176:177], v9, s[8:11], s52 offen offset:512 sc1
    s_lshl_b32 s52, s3, 7
    s_lshl_b32 s53, s3, 6
    v_add_u32 v5, s52, v126
    v_add_u32 v6, s53, v127
    ds_read_b128 v[180:183], v5
    ds_read_b128 v[184:187], v5 offset:1024
    ds_read_b64 v[188:189], v6
    v_mov_b32 v178, 0
    v_mov_b32 v179, 0
    s_branch L_lt1_ret
L_lt2:
    v_mov_b32 v190, v6
    v_mov_b32 v191, v7
    s_mov_b32 s63, 0x80000
Lrt_49:
    s_waitcnt vmcnt(14)
    v_max3_u32 v5, v168, v169, v170
    v_max3_u32 v5, v5, v171, v172
    v_max3_u32 v5, v5, v173, v176
    v_max_u32 v5, v5, v177
    v_cmp_eq_u32 vcc, -1, v5
    s_sub_u32 s63, s63, 1
    s_cbranch_scc1 Lrt_50
    s_nop 2
    s_cbranch_vccz Lrt_50
    v_lshl_add_u32 v5, v2, 1, v3
    v_lshrrev_b32 v6, 2, v2
    v_lshlrev_b32 v6, 28, v6
    v_lshl_add_u32 v7, v5, 4, v6
    v_lshl_add_u32 v8, v5, 3, v6
    v_cmp_lt_u32 vcc, 21, v1
    v_lshlrev_b32 v9, 3, v1
    v_mov_b32 v10, 1073741824
    s_mov_b32 s52, 2703360
    v_cndmask_b32 v9, v9, v10, vcc
    buffer_load_dwordx4 v[168:171], v7, s[8:11], s52 offen sc1
    buffer_load_dwordx2 v[172:173], v8, s[8:11], s52 offen offset:256 sc1
    buffer_load_dwordx2 v[176:177], v9, s[8:11], s52 offen offset:512 sc1
    s_waitcnt vmcnt(0)
    s_branch Lrt_49
Lrt_50:
    v_mfma_f32_32x32x16_bf16 v[16:31], v[168:171], v[180:183], 0
    v_mfma_f32_32x32x16_bf16 v[32:47], v[168:171], v[184:187], 0
    v_mov_b32 v6, v190
    v_mov_b32 v7, v191
    s_nop 7
    v_mfma_f32_32x32x4_2b_bf16 v[16:47], v[172:173], v[188:189], v[16:47]
    s_nop 15
    s_nop 3
    v_exp_f32 v16, v16
    v_exp_f32 v17, v17
    v_exp_f32 v18, v18
    v_exp_f32 v19, v19
    v_exp_f32 v32, v32
    v_exp_f32 v33, v33
    v_exp_f32 v34, v34
    v_exp_f32 v35, v35
    s_nop 0
    v_cvt_pk_bf16_f32 v80, v16, v17
    v_cvt_pk_bf16_f32 v81, v18, v19
    v_mov_b32 v82, 0
    v_mov_b32 v83, 0
    v_cvt_pk_bf16_f32 v88, v32, v33
    v_cvt_pk_bf16_f32 v89, v34, v35
    v_mov_b32 v90, 0
    v_mov_b32 v91, 0
    s_nop 1
    v_mfma_f32_32x32x16_bf16 v[208:223], v[176:179], v[80:83], 0
    v_mfma_f32_32x32x16_bf16 v[224:239], v[176:179], v[88:91], 0
    s_branch L_lt2_ret
L_fb:
    s_lshl_b32 s54, s3, 7
    s_lshl_b32 s55, s3, 6
    v_add_u32 v5, s54, v126
    v_add_u32 v6, s55, v127
    ds_read_b128 v[96:99], v5
    ds_read_b128 v[100:103], v5 offset:1024
    ds_read_b64 v[104:105], v6
    v_mov_b32 v64, 4286578688
    v_mov_b32 v65, 4286578688
    v_mov_b32 v67, 4286578688
    v_lshlrev_b32 v66, 2, v3
    s_mov_b32 s54, 0
    v_accvgpr_write_b32 a224, 0
    v_accvgpr_write_b32 a225, 0
    v_accvgpr_write_b32 a226, 0
    v_accvgpr_write_b32 a227, 0
    v_accvgpr_write_b32 a228, 0
    v_accvgpr_write_b32 a229, 0
    v_accvgpr_write_b32 a230, 0
    v_accvgpr_write_b32 a231, 0
    v_accvgpr_write_b32 a232, 0
    v_accvgpr_write_b32 a233, 0
    v_accvgpr_write_b32 a234, 0
    v_accvgpr_write_b32 a235, 0
    v_accvgpr_write_b32 a236, 0
    v_accvgpr_write_b32 a237, 0
    v_accvgpr_write_b32 a238, 0
    v_accvgpr_write_b32 a239, 0
    v_accvgpr_write_b32 a240, 0
    v_accvgpr_write_b32 a241, 0
    v_accvgpr_write_b32 a242, 0
    v_accvgpr_write_b32 a243, 0
    v_accvgpr_write_b32 a244, 0
    v_accvgpr_write_b32 a245, 0
    v_accvgpr_write_b32 a246, 0
    v_accvgpr_write_b32 a247, 0
    v_accvgpr_write_b32 a248, 0
    v_accvgpr_write_b32 a249, 0
    v_accvgpr_write_b32 a250, 0
    v_accvgpr_write_b32 a251, 0
    v_accvgpr_write_b32 a252, 0
    v_accvgpr_write_b32 a253, 0
    v_accvgpr_write_b32 a254, 0
    v_accvgpr_write_b32 a255, 0
L_fb_pass:
    s_mov_b32 s55, 0
L_fb_t:
    s_lshl_b32 s56, s55, 10
    s_add_u32 s56, s56, s64
    s_lshr_b32 s57, s55, 1
    s_lshl_b32 s57, s57, 10
    s_and_b32 s58, s55, 1
    s_lshl_b32 s58, s58, 3
    s_add_u32 s57, s57, s58
    s_add_u32 s57, s57, s64
    s_add_u32 s57, s57, 65536
    s_mul_i32 s58, s55, 1344
    s_add_u32 s58, s58, s64
    s_add_u32 s58, s58, 98304
    buffer_load_dwordx4 v[48:51], v4, s[8:11], s56 offen sc1
    buffer_load_dwordx2 v[52:53], v4, s[8:11], s57 offen sc1
    buffer_load_dwordx4 v[56:59], v15, s[8:11], s58 offen sc1
    buffer_load_dwordx4 v[60:63], v15, s[8:11], s58 offen offset:672 sc1
    s_waitcnt vmcnt(0) lgkmcnt(0)
    v_mfma_f32_32x32x16_bf16 v[16:31], v[48:51], v[96:99], 0
    v_mfma_f32_32x32x16_bf16 v[32:47], v[48:51], v[100:103], 0
    s_nop 7
    s_nop 1
    v_mfma_f32_32x32x4_2b_bf16 v[16:47], v[52:53], v[104:105], v[16:47]
    s_nop 15
    s_nop 3
    s_bitcmp0_b32 s24, 3
    s_cbranch_scc1 L_fb_nm
    s_lshl_b32 s56, s55, 5
    s_sub_u32 s57, s26, s56
    s_sub_u32 s58, s27, s56
    s_min_u32 s56, s57, s58
    s_cmp_ge_u32 s56, 32
    s_cbranch_scc1 L_fb_nm
    v_add_u32 v5, 0, v66
    v_cmp_eq_u32 vcc, s57, v5
    v_cmp_eq_u32 s[32:33], s58, v5
    s_nop 3
    s_or_b64 vcc, vcc, s[32:33]
    v_cndmask_b32 v16, v16, v67, vcc
    v_cndmask_b32 v32, v32, v67, vcc
    v_add_u32 v5, 1, v66
    v_cmp_eq_u32 vcc, s57, v5
    v_cmp_eq_u32 s[32:33], s58, v5
    s_nop 3
    s_or_b64 vcc, vcc, s[32:33]
    v_cndmask_b32 v17, v17, v67, vcc
    v_cndmask_b32 v33, v33, v67, vcc
    v_add_u32 v5, 2, v66
    v_cmp_eq_u32 vcc, s57, v5
    v_cmp_eq_u32 s[32:33], s58, v5
    s_nop 3
    s_or_b64 vcc, vcc, s[32:33]
    v_cndmask_b32 v18, v18, v67, vcc
    v_cndmask_b32 v34, v34, v67, vcc
    v_add_u32 v5, 3, v66
    v_cmp_eq_u32 vcc, s57, v5
    v_cmp_eq_u32 s[32:33], s58, v5
    s_nop 3
    s_or_b64 vcc, vcc, s[32:33]
    v_cndmask_b32 v19, v19, v67, vcc
    v_cndmask_b32 v35, v35, v67, vcc
    v_add_u32 v5, 8, v66
    v_cmp_eq_u32 vcc, s57, v5
    v_cmp_eq_u32 s[32:33], s58, v5
    s_nop 3
    s_or_b64 vcc, vcc, s[32:33]
    v_cndmask_b32 v20, v20, v67, vcc
    v_cndmask_b32 v36, v36, v67, vcc
    v_add_u32 v5, 9, v66
    v_cmp_eq_u32 vcc, s57, v5
    v_cmp_eq_u32 s[32:33], s58, v5
    s_nop 3
    s_or_b64 vcc, vcc, s[32:33]
    v_cndmask_b32 v21, v21, v67, vcc
    v_cndmask_b32 v37, v37, v67, vcc
    v_add_u32 v5, 10, v66
    v_cmp_eq_u32 vcc, s57, v5
    v_cmp_eq_u32 s[32:33], s58, v5
    s_nop 3
    s_or_b64 vcc, vcc, s[32:33]
    v_cndmask_b32 v22, v22, v67, vcc
    v_cndmask_b32 v38, v38, v67, vcc
    v_add_u32 v5, 11, v66
    v_cmp_eq_u32 vcc, s57, v5
    v_cmp_eq_u32 s[32:33], s58, v5
    s_nop 3
    s_or_b64 vcc, vcc, s[32:33]
    v_cndmask_b32 v23, v23, v67, vcc
    v_cndmask_b32 v39, v39, v67, vcc
    v_add_u32 v5, 16, v66
    v_cmp_eq_u32 vcc, s57, v5
    v_cmp_eq_u32 s[32:33], s58, v5
    s_nop 3
    s_or_b64 vcc, vcc, s[32:33]
    v_cndmask_b32 v24, v24, v67, vcc
    v_cndmask_b32 v40, v40, v67, vcc
    v_add_u32 v5, 17, v66
    v_cmp_eq_u32 vcc, s57, v5
    v_cmp_eq_u32 s[32:33], s58, v5
    s_nop 3
    s_or_b64 vcc, vcc, s[32:33]
    v_cndmask_b32 v25, v25, v67, vcc
    v_cndmask_b32 v41, v41, v67, vcc
    v_add_u32 v5, 18, v66
    v_cmp_eq_u32 vcc, s57, v5
    v_cmp_eq_u32 s[32:33], s58, v5
    s_nop 3
    s_or_b64 vcc, vcc, s[32:33]
    v_cndmask_b32 v26, v26, v67, vcc
    v_cndmask_b32 v42, v42, v67, vcc
    v_add_u32 v5, 19, v66
    v_cmp_eq_u32 vcc, s57, v5
    v_cmp_eq_u32 s[32:33], s58, v5
    s_nop 3
    s_or_b64 vcc, vcc, s[32:33]
    v_cndmask_b32 v27, v27, v67, vcc
    v_cndmask_b32 v43, v43, v67, vcc
    v_add_u32 v5, 24, v66
    v_cmp_eq_u32 vcc, s57, v5
    v_cmp_eq_u32 s[32:33], s58, v5
    s_nop 3
    s_or_b64 vcc, vcc, s[32:33]
    v_cndmask_b32 v28, v28, v67, vcc
    v_cndmask_b32 v44, v44, v67, vcc
    v_add_u32 v5, 25, v66
    v_cmp_eq_u32 vcc, s57, v5
    v_cmp_eq_u32 s[32:33], s58, v5
    s_nop 3
    s_or_b64 vcc, vcc, s[32:33]
    v_cndmask_b32 v29, v29, v67, vcc
    v_cndmask_b32 v45, v45, v67, vcc
    v_add_u32 v5, 26, v66
    v_cmp_eq_u32 vcc, s57, v5
    v_cmp_eq_u32 s[32:33], s58, v5
    s_nop 3
    s_or_b64 vcc, vcc, s[32:33]
    v_cndmask_b32 v30, v30, v67, vcc
    v_cndmask_b32 v46, v46, v67, vcc
    v_add_u32 v5, 27, v66
    v_cmp_eq_u32 vcc, s57, v5
    v_cmp_eq_u32 s[32:33], s58, v5
    s_nop 3
    s_or_b64 vcc, vcc, s[32:33]
    v_cndmask_b32 v31, v31, v67, vcc
    v_cndmask_b32 v47, v47, v67, vcc
L_fb_nm:
    s_cmp_lg_u32 s54, 0
    s_cbranch_scc1 L_fb_p2
    v_max3_f32 v64, v64, v16, v17
    v_max3_f32 v65, v65, v32, v33
    v_max3_f32 v64, v64, v18, v19
    v_max3_f32 v65, v65, v34, v35
    v_max3_f32 v64, v64, v20, v21
    v_max3_f32 v65, v65, v36, v37
    v_max3_f32 v64, v64, v22, v23
    v_max3_f32 v65, v65, v38, v39
    v_max3_f32 v64, v64, v24, v25
    v_max3_f32 v65, v65, v40, v41
    v_max3_f32 v64, v64, v26, v27
    v_max3_f32 v65, v65, v42, v43
    v_max3_f32 v64, v64, v28, v29
    v_max3_f32 v65, v65, v44, v45
    v_max3_f32 v64, v64, v30, v31
    v_max3_f32 v65, v65, v46, v47
    s_branch L_fb_n
L_fb_p2:
    v_sub_f32 v16, v16, v64
    v_sub_f32 v32, v32, v65
    v_sub_f32 v17, v17, v64
    v_sub_f32 v33, v33, v65
    v_sub_f32 v18, v18, v64
    v_sub_f32 v34, v34, v65
    v_sub_f32 v19, v19, v64
    v_sub_f32 v35, v35, v65
    v_sub_f32 v20, v20, v64
    v_sub_f32 v36, v36, v65
    v_sub_f32 v21, v21, v64
    v_sub_f32 v37, v37, v65
    v_sub_f32 v22, v22, v64
    v_sub_f32 v38, v38, v65
    v_sub_f32 v23, v23, v64
    v_sub_f32 v39, v39, v65
    v_sub_f32 v24, v24, v64
    v_sub_f32 v40, v40, v65
    v_sub_f32 v25, v25, v64
    v_sub_f32 v41, v41, v65
    v_sub_f32 v26, v26, v64
    v_sub_f32 v42, v42, v65
    v_sub_f32 v27, v27, v64
    v_sub_f32 v43, v43, v65
    v_sub_f32 v28, v28, v64
    v_sub_f32 v44, v44, v65
    v_sub_f32 v29, v29, v64
    v_sub_f32 v45, v45, v65
    v_sub_f32 v30, v30, v64
    v_sub_f32 v46, v46, v65
    v_sub_f32 v31, v31, v64
    v_sub_f32 v47, v47, v65
    v_exp_f32 v16, v16
    v_exp_f32 v32, v32
    v_exp_f32 v17, v17
    v_exp_f32 v33, v33
    v_exp_f32 v18, v18
    v_exp_f32 v34, v34
    v_exp_f32 v19, v19
    v_exp_f32 v35, v35
    v_exp_f32 v20, v20
    v_exp_f32 v36, v36
    v_exp_f32 v21, v21
    v_exp_f32 v37, v37
    v_exp_f32 v22, v22
    v_exp_f32 v38, v38
    v_exp_f32 v23, v23
    v_exp_f32 v39, v39
    v_exp_f32 v24, v24
    v_exp_f32 v40, v40
    v_exp_f32 v25, v25
    v_exp_f32 v41, v41
    v_exp_f32 v26, v26
    v_exp_f32 v42, v42
    v_exp_f32 v27, v27
    v_exp_f32 v43, v43
    v_exp_f32 v28, v28
    v_exp_f32 v44, v44
    v_exp_f32 v29, v29
    v_exp_f32 v45, v45
    v_exp_f32 v30, v30
    v_exp_f32 v46, v46
    v_exp_f32 v31, v31
    v_exp_f32 v47, v47
    v_cvt_pk_bf16_f32 v80, v16, v17
    v_cvt_pk_bf16_f32 v88, v32, v33
    v_cvt_pk_bf16_f32 v81, v18, v19
    v_cvt_pk_bf16_f32 v89, v34, v35
    v_cvt_pk_bf16_f32 v82, v20, v21
    v_cvt_pk_bf16_f32 v90, v36, v37
    v_cvt_pk_bf16_f32 v83, v22, v23
    v_cvt_pk_bf16_f32 v91, v38, v39
    v_cvt_pk_bf16_f32 v84, v24, v25
    v_cvt_pk_bf16_f32 v92, v40, v41
    v_cvt_pk_bf16_f32 v85, v26, v27
    v_cvt_pk_bf16_f32 v93, v42, v43
    v_cvt_pk_bf16_f32 v86, v28, v29
    v_cvt_pk_bf16_f32 v94, v44, v45
    v_cvt_pk_bf16_f32 v87, v30, v31
    v_cvt_pk_bf16_f32 v95, v46, v47
    s_nop 1
    v_mfma_f32_32x32x16_bf16 a[224:239], v[56:59], v[80:83], a[224:239]
    v_mfma_f32_32x32x16_bf16 a[240:255], v[56:59], v[88:91], a[240:255]
    v_mfma_f32_32x32x16_bf16 a[224:239], v[60:63], v[84:87], a[224:239]
    v_mfma_f32_32x32x16_bf16 a[240:255], v[60:63], v[92:95], a[240:255]
L_fb_n:
    s_add_u32 s55, s55, 1
    s_cmp_lt_u32 s55, 64
    s_cbranch_scc1 L_fb_t
    s_bitcmp0_b32 s24, 3
    s_cbranch_scc1 L_fb_nl
    v_mfma_f32_32x32x16_bf16 v[16:31], v[168:171], v[96:99], 0
    v_mfma_f32_32x32x16_bf16 v[32:47], v[168:171], v[100:103], 0
    s_nop 7
    s_nop 1
    v_mfma_f32_32x32x4_2b_bf16 v[16:47], v[172:173], v[104:105], v[16:47]
    s_nop 15
    s_nop 3
    v_cmp_eq_u32 vcc, 1, v3
    v_mov_b32 v16, v67
    v_mov_b32 v18, v67
    v_mov_b32 v32, v67
    v_mov_b32 v34, v67
    v_cndmask_b32 v17, v17, v67, vcc
    v_cndmask_b32 v19, v19, v67, vcc
    v_cndmask_b32 v33, v33, v67, vcc
    v_cndmask_b32 v35, v35, v67, vcc
    s_cmp_lg_u32 s54, 0
    s_cbranch_scc1 L_fb_l2
    v_max3_f32 v64, v64, v16, v17
    v_max3_f32 v65, v65, v32, v33
    v_max3_f32 v64, v64, v18, v19
    v_max3_f32 v65, v65, v34, v35
    s_branch L_fb_nl
L_fb_l2:
    v_sub_f32 v16, v16, v64
    v_sub_f32 v32, v32, v65
    v_sub_f32 v17, v17, v64
    v_sub_f32 v33, v33, v65
    v_sub_f32 v18, v18, v64
    v_sub_f32 v34, v34, v65
    v_sub_f32 v19, v19, v64
    v_sub_f32 v35, v35, v65
    v_exp_f32 v16, v16
    v_exp_f32 v32, v32
    v_exp_f32 v17, v17
    v_exp_f32 v33, v33
    v_exp_f32 v18, v18
    v_exp_f32 v34, v34
    v_exp_f32 v19, v19
    v_exp_f32 v35, v35
    v_cvt_pk_bf16_f32 v80, v16, v17
    v_cvt_pk_bf16_f32 v88, v32, v33
    v_cvt_pk_bf16_f32 v81, v18, v19
    v_cvt_pk_bf16_f32 v89, v34, v35
    v_mov_b32 v82, 0
    v_mov_b32 v83, 0
    v_mov_b32 v90, 0
    v_mov_b32 v91, 0
    s_nop 1
    v_mfma_f32_32x32x16_bf16 a[224:239], v[176:179], v[80:83], a[224:239]
    v_mfma_f32_32x32x16_bf16 a[240:255], v[176:179], v[88:91], a[240:255]
L_fb_nl:
    s_cmp_lg_u32 s54, 0
    s_cbranch_scc1 L_fb_end
    s_mov_b32 s54, 1
    v_mov_b32 v5, v64
    v_mov_b32 v6, v65
    s_nop 1
    v_permlane32_swap_b32 v64, v5
    v_permlane32_swap_b32 v65, v6
    s_nop 0
    v_max_f32 v64, v64, v5
    v_max_f32 v65, v65, v6
    s_branch L_fb_pass
L_fb_end:
    s_nop 15
    v_accvgpr_read_b32 v16, a224
    v_accvgpr_read_b32 v28, a240
    v_accvgpr_read_b32 v17, a225
    v_accvgpr_read_b32 v29, a241
    v_accvgpr_read_b32 v18, a226
    v_accvgpr_read_b32 v30, a242
    v_accvgpr_read_b32 v19, a227
    v_accvgpr_read_b32 v31, a243
    v_accvgpr_read_b32 v20, a228
    v_accvgpr_read_b32 v32, a244
    v_accvgpr_read_b32 v21, a229
    v_accvgpr_read_b32 v33, a245
    v_accvgpr_read_b32 v22, a230
    v_accvgpr_read_b32 v34, a246
    v_accvgpr_read_b32 v23, a231
    v_accvgpr_read_b32 v35, a247
    v_accvgpr_read_b32 v24, a232
    v_accvgpr_read_b32 v36, a248
    v_accvgpr_read_b32 v25, a233
    v_accvgpr_read_b32 v37, a249
    v_accvgpr_read_b32 v26, a234
    v_accvgpr_read_b32 v38, a250
    v_accvgpr_read_b32 v27, a235
    v_accvgpr_read_b32 v39, a251
    v_mov_b32 v5, v24
    v_mov_b32 v6, v24
    v_mov_b32 v7, v36
    v_mov_b32 v8, v36
    s_nop 1
    s_branch L_fb_ret
L_wqf:
    s_cmp_lg_u32 s4, 0
    s_cbranch_scc1 Lfs_51
    s_add_u32 s52, s3, 0
    s_and_b32 s52, s52, 3
    s_mul_i32 s52, s52, 10240
    s_add_u32 s52, s52, s60
    buffer_store_dwordx4 a[0:3], v4, s[8:11], s52 offen sc1
    s_add_u32 s52, s3, 1
    s_and_b32 s52, s52, 3
    s_mul_i32 s52, s52, 10240
    s_add_u32 s52, s52, s60
    buffer_store_dwordx4 a[40:43], v4, s[8:11], s52 offen sc1
    s_add_u32 s52, s3, 2
    s_and_b32 s52, s52, 3
    s_mul_i32 s52, s52, 10240
    s_add_u32 s52, s52, s60
    buffer_store_dwordx4 a[80:83], v4, s[8:11], s52 offen sc1
    s_add_u32 s52, s3, 3
    s_and_b32 s52, s52, 3
    s_mul_i32 s52, s52, 10240
    s_add_u32 s52, s52, s60
    buffer_store_dwordx4 a[120:123], v4, s[8:11], s52 offen sc1
    s_mul_i32 s52, s3, -30720
    s_add_u32 s52, s52, s60
    s_add_u32 s52, s52, 163840
    buffer_store_dwordx4 v[168:171], v4, s[8:11], s52 offen sc1
    s_branch L_wqf_ret
Lfs_51:
    s_cmp_lg_u32 s4, 1
    s_cbranch_scc1 Lfs_52
    s_add_u32 s52, s3, 0
    s_and_b32 s52, s52, 3
    s_mul_i32 s52, s52, 10240
    s_add_u32 s52, s52, s60
    buffer_store_dwordx4 a[4:7], v4, s[8:11], s52 offen sc1
    s_add_u32 s52, s3, 1
    s_and_b32 s52, s52, 3
    s_mul_i32 s52, s52, 10240
    s_add_u32 s52, s52, s60
    buffer_store_dwordx4 a[44:47], v4, s[8:11], s52 offen sc1
    s_add_u32 s52, s3, 2
    s_and_b32 s52, s52, 3
    s_mul_i32 s52, s52, 10240
    s_add_u32 s52, s52, s60
    buffer_store_dwordx4 a[84:87], v4, s[8:11], s52 offen sc1
    s_add_u32 s52, s3, 3
    s_and_b32 s52, s52, 3
    s_mul_i32 s52, s52, 10240
    s_add_u32 s52, s52, s60
    buffer_store_dwordx4 a[124:127], v4, s[8:11], s52 offen sc1
    s_mul_i32 s52, s3, -30720
    s_add_u32 s52, s52, s60
    s_add_u32 s52, s52, 163840
    buffer_store_dwordx4 v[172:175], v4, s[8:11], s52 offen sc1
    s_branch L_wqf_ret
Lfs_52:
    s_cmp_lg_u32 s4, 2
    s_cbranch_scc1 Lfs_53
    s_add_u32 s52, s3, 0
    s_and_b32 s52, s52, 3
    s_mul_i32 s52, s52, 10240
    s_add_u32 s52, s52, s60
    buffer_store_dwordx4 a[8:11], v4, s[8:11], s52 offen sc1
    s_add_u32 s52, s3, 1
    s_and_b32 s52, s52, 3
    s_mul_i32 s52, s52, 10240
    s_add_u32 s52, s52, s60
    buffer_store_dwordx4 a[48:51], v4, s[8:11], s52 offen sc1
    s_add_u32 s52, s3, 2
    s_and_b32 s52, s52, 3
    s_mul_i32 s52, s52, 10240
    s_add_u32 s52, s52, s60
    buffer_store_dwordx4 a[88:91], v4, s[8:11], s52 offen sc1
    s_add_u32 s52, s3, 3
    s_and_b32 s52, s52, 3
    s_mul_i32 s52, s52, 10240
    s_add_u32 s52, s52, s60
    buffer_store_dwordx4 a[128:131], v4, s[8:11], s52 offen sc1
    s_mul_i32 s52, s3, -30720
    s_add_u32 s52, s52, s60
    s_add_u32 s52, s52, 163840
    buffer_store_dwordx4 v[176:179], v4, s[8:11], s52 offen sc1
    s_branch L_wqf_ret
Lfs_53:
    s_cmp_lg_u32 s4, 3
    s_cbranch_scc1 Lfs_54
    s_add_u32 s52, s3, 0
    s_and_b32 s52, s52, 3
    s_mul_i32 s52, s52, 10240
    s_add_u32 s52, s52, s60
    buffer_store_dwordx4 a[12:15], v4, s[8:11], s52 offen sc1
    s_add_u32 s52, s3, 1
    s_and_b32 s52, s52, 3
    s_mul_i32 s52, s52, 10240
    s_add_u32 s52, s52, s60
    buffer_store_dwordx4 a[52:55], v4, s[8:11], s52 offen sc1
    s_add_u32 s52, s3, 2
    s_and_b32 s52, s52, 3
    s_mul_i32 s52, s52, 10240
    s_add_u32 s52, s52, s60
    buffer_store_dwordx4 a[92:95], v4, s[8:11], s52 offen sc1
    s_add_u32 s52, s3, 3
    s_and_b32 s52, s52, 3
    s_mul_i32 s52, s52, 10240
    s_add_u32 s52, s52, s60
    buffer_store_dwordx4 a[132:135], v4, s[8:11], s52 offen sc1
    s_mul_i32 s52, s3, -30720
    s_add_u32 s52, s52, s60
    s_add_u32 s52, s52, 163840
    buffer_store_dwordx4 v[180:183], v4, s[8:11], s52 offen sc1
    s_branch L_wqf_ret
Lfs_54:
    s_cmp_lg_u32 s4, 4
    s_cbranch_scc1 Lfs_55
    s_add_u32 s52, s3, 0
    s_and_b32 s52, s52, 3
    s_mul_i32 s52, s52, 10240
    s_add_u32 s52, s52, s60
    buffer_store_dwordx4 a[16:19], v4, s[8:11], s52 offen sc1
    s_add_u32 s52, s3, 1
    s_and_b32 s52, s52, 3
    s_mul_i32 s52, s52, 10240
    s_add_u32 s52, s52, s60
    buffer_store_dwordx4 a[56:59], v4, s[8:11], s52 offen sc1
    s_add_u32 s52, s3, 2
    s_and_b32 s52, s52, 3
    s_mul_i32 s52, s52, 10240
    s_add_u32 s52, s52, s60
    buffer_store_dwordx4 a[96:99], v4, s[8:11], s52 offen sc1
    s_add_u32 s52, s3, 3
    s_and_b32 s52, s52, 3
    s_mul_i32 s52, s52, 10240
    s_add_u32 s52, s52, s60
    buffer_store_dwordx4 a[136:139], v4, s[8:11], s52 offen sc1
    s_mul_i32 s52, s3, -30720
    s_add_u32 s52, s52, s60
    s_add_u32 s52, s52, 163840
    buffer_store_dwordx4 v[184:187], v4, s[8:11], s52 offen sc1
    s_branch L_wqf_ret
Lfs_55:
    s_cmp_lg_u32 s4, 5
    s_cbranch_scc1 Lfs_56
    s_add_u32 s52, s3, 0
    s_and_b32 s52, s52, 3
    s_mul_i32 s52, s52, 10240
    s_add_u32 s52, s52, s60
    buffer_store_dwordx4 a[20:23], v4, s[8:11], s52 offen sc1
    s_add_u32 s52, s3, 1
    s_and_b32 s52, s52, 3
    s_mul_i32 s52, s52, 10240
    s_add_u32 s52, s52, s60
    buffer_store_dwordx4 a[60:63], v4, s[8:11], s52 offen sc1
    s_add_u32 s52, s3, 2
    s_and_b32 s52, s52, 3
    s_mul_i32 s52, s52, 10240
    s_add_u32 s52, s52, s60
    buffer_store_dwordx4 a[100:103], v4, s[8:11], s52 offen sc1
    s_add_u32 s52, s3, 3
    s_and_b32 s52, s52, 3
    s_mul_i32 s52, s52, 10240
    s_add_u32 s52, s52, s60
    buffer_store_dwordx4 a[140:143], v4, s[8:11], s52 offen sc1
    s_mul_i32 s52, s3, -30720
    s_add_u32 s52, s52, s60
    s_add_u32 s52, s52, 163840
    buffer_store_dwordx4 v[188:191], v4, s[8:11], s52 offen sc1
    s_branch L_wqf_ret
Lfs_56:
    s_cmp_lg_u32 s4, 6
    s_cbranch_scc1 Lfs_57
    s_add_u32 s52, s3, 0
    s_and_b32 s52, s52, 3
    s_mul_i32 s52, s52, 10240
    s_add_u32 s52, s52, s60
    buffer_store_dwordx4 a[24:27], v4, s[8:11], s52 offen sc1
    s_add_u32 s52, s3, 1
    s_and_b32 s52, s52, 3
    s_mul_i32 s52, s52, 10240
    s_add_u32 s52, s52, s60
    buffer_store_dwordx4 a[64:67], v4, s[8:11], s52 offen sc1
    s_add_u32 s52, s3, 2
    s_and_b32 s52, s52, 3
    s_mul_i32 s52, s52, 10240
    s_add_u32 s52, s52, s60
    buffer_store_dwordx4 a[104:107], v4, s[8:11], s52 offen sc1
    s_add_u32 s52, s3, 3
    s_and_b32 s52, s52, 3
    s_mul_i32 s52, s52, 10240
    s_add_u32 s52, s52, s60
    buffer_store_dwordx4 a[144:147], v4, s[8:11], s52 offen sc1
    s_mul_i32 s52, s3, -30720
    s_add_u32 s52, s52, s60
    s_add_u32 s52, s52, 163840
    buffer_store_dwordx4 v[192:195], v4, s[8:11], s52 offen sc1
    s_branch L_wqf_ret
Lfs_57:
    s_cmp_lg_u32 s4, 7
    s_cbranch_scc1 Lfs_58
    s_add_u32 s52, s3, 0
    s_and_b32 s52, s52, 3
    s_mul_i32 s52, s52, 10240
    s_add_u32 s52, s52, s60
    buffer_store_dwordx4 a[28:31], v4, s[8:11], s52 offen sc1
    s_add_u32 s52, s3, 1
    s_and_b32 s52, s52, 3
    s_mul_i32 s52, s52, 10240
    s_add_u32 s52, s52, s60
    buffer_store_dwordx4 a[68:71], v4, s[8:11], s52 offen sc1
    s_add_u32 s52, s3, 2
    s_and_b32 s52, s52, 3
    s_mul_i32 s52, s52, 10240
    s_add_u32 s52, s52, s60
    buffer_store_dwordx4 a[108:111], v4, s[8:11], s52 offen sc1
    s_add_u32 s52, s3, 3
    s_and_b32 s52, s52, 3
    s_mul_i32 s52, s52, 10240
    s_add_u32 s52, s52, s60
    buffer_store_dwordx4 a[148:151], v4, s[8:11], s52 offen sc1
    s_mul_i32 s52, s3, -30720
    s_add_u32 s52, s52, s60
    s_add_u32 s52, s52, 163840
    buffer_store_dwordx4 v[196:199], v4, s[8:11], s52 offen sc1
    s_branch L_wqf_ret
Lfs_58:
    s_cmp_lg_u32 s4, 8
    s_cbranch_scc1 Lfs_59
    s_add_u32 s52, s3, 0
    s_and_b32 s52, s52, 3
    s_mul_i32 s52, s52, 10240
    s_add_u32 s52, s52, s60
    buffer_store_dwordx4 a[32:35], v4, s[8:11], s52 offen sc1
    s_add_u32 s52, s3, 1
    s_and_b32 s52, s52, 3
    s_mul_i32 s52, s52, 10240
    s_add_u32 s52, s52, s60
    buffer_store_dwordx4 a[72:75], v4, s[8:11], s52 offen sc1
    s_add_u32 s52, s3, 2
    s_and_b32 s52, s52, 3
    s_mul_i32 s52, s52, 10240
    s_add_u32 s52, s52, s60
    buffer_store_dwordx4 a[112:115], v4, s[8:11], s52 offen sc1
    s_add_u32 s52, s3, 3
    s_and_b32 s52, s52, 3
    s_mul_i32 s52, s52, 10240
    s_add_u32 s52, s52, s60
    buffer_store_dwordx4 a[152:155], v4, s[8:11], s52 offen sc1
    s_mul_i32 s52, s3, -30720
    s_add_u32 s52, s52, s60
    s_add_u32 s52, s52, 163840
    buffer_store_dwordx4 v[200:203], v4, s[8:11], s52 offen sc1
    s_branch L_wqf_ret
Lfs_59:
    s_cmp_lg_u32 s4, 9
    s_cbranch_scc1 Lfs_60
    s_add_u32 s52, s3, 0
    s_and_b32 s52, s52, 3
    s_mul_i32 s52, s52, 10240
    s_add_u32 s52, s52, s60
    buffer_store_dwordx4 a[36:39], v4, s[8:11], s52 offen sc1
    s_add_u32 s52, s3, 1
    s_and_b32 s52, s52, 3
    s_mul_i32 s52, s52, 10240
    s_add_u32 s52, s52, s60
    buffer_store_dwordx4 a[76:79], v4, s[8:11], s52 offen sc1
    s_add_u32 s52, s3, 2
    s_and_b32 s52, s52, 3
    s_mul_i32 s52, s52, 10240
    s_add_u32 s52, s52, s60
    buffer_store_dwordx4 a[116:119], v4, s[8:11], s52 offen sc1
    s_add_u32 s52, s3, 3
    s_and_b32 s52, s52, 3
    s_mul_i32 s52, s52, 10240
    s_add_u32 s52, s52, s60
    buffer_store_dwordx4 a[156:159], v4, s[8:11], s52 offen sc1
    s_mul_i32 s52, s3, -30720
    s_add_u32 s52, s52, s60
    s_add_u32 s52, s52, 163840
    buffer_store_dwordx4 v[204:207], v4, s[8:11], s52 offen sc1
    s_branch L_wqf_ret
Lfs_60:
    s_branch L_wqf_ret
L_loc:
    s_lshl_b32 s54, s4, 8
    s_add_u32 s54, s54, 69632
    s_lshr_b32 s55, s39, 4
    s_mov_b32 s63, 0x80000
    s_waitcnt vmcnt(7)
L_h10s:
    v_lshrrev_b32 v5, 4, v13
    v_cmp_ne_u32 vcc, s55, v5
    s_sub_u32 s63, s63, 1
    s_cbranch_scc1 L_h10t
    s_nop 2
    s_cbranch_vccz L_h10t
    v_and_b32 v6, 3, v1
    v_lshlrev_b32 v6, 6, v6
    buffer_load_dword v13, v6, s[8:11], s54 offen sc1
    s_waitcnt vmcnt(0)
    s_branch L_h10s
L_h10t:
    v_cmp_ne_u32 vcc, s39, v13
    s_nop 3
    s_cmp_eq_u64 vcc, 0
    s_cselect_b32 s39, 1, 0
    s_branch L_loc_ret
L_hook10:
    v_bfe_u32 v5, v1, 2, 2
    v_lshl_add_u32 v5, v3, 3, v5
    v_lshlrev_b32 v5, 6, v5
    v_bfe_u32 v6, v1, 4, 1
    v_and_b32 v7, 3, v1
    v_lshrrev_b32 v8, 1, v7
    v_and_b32 v9, 1, v7
    v_lshl_add_u32 v8, v9, 1, v8
    s_cmp_eq_u32 s35, 4
    s_cselect_b64 vcc, -1, 0
    s_mul_i32 s52, s3, 36864
    s_add_u32 s52, s52, 33280
    v_cndmask_b32 v7, v8, v7, vcc
    v_lshl_add_u32 v7, v6, 2, v7
    v_lshl_add_u32 v5, v7, 3, v5
    v_add_u32 v5, s52, v5
    ds_read_b64_tr_b16 v[208:209], v5
    ds_read_b64_tr_b16 v[210:211], v5 offset:256
    v_mov_b32 v8, -1
    v_mov_b32 v9, -1
    v_mov_b32 v10, -1
    v_mov_b32 v11, -1
    s_mul_i32 s52, s34, 448
    s_add_u32 s52, s52, 2686976
    s_mov_b64 exec, 0xfffffff
    buffer_store_dwordx4 v[8:11], v4, s[8:11], s52 offen sc1
    s_mov_b64 exec, -1
    s_lshl_b32 s52, s34, 10
    s_add_u32 s52, s52, 1867776
    s_cmp_ge_u32 s34, 800
    s_cselect_b32 s52, 1073741824, s52
    s_waitcnt lgkmcnt(0)
    buffer_store_dwordx4 v[208:211], v4, s[8:11], s52 offen sc1
    s_mul_i32 s52, s5, 204800
    s_mul_i32 s53, s3, 40960
    s_add_u32 s52, s52, 1867776
    s_add_u32 s53, s53, s52
    s_add_u32 s54, s3, 0
    s_and_b32 s54, s54, 3
    s_mul_i32 s54, s54, 10240
    s_add_u32 s34, s54, s53
    s_add_u32 s54, s3, 1
    s_and_b32 s54, s54, 3
    s_mul_i32 s54, s54, 10240
    s_add_u32 s35, s54, s53
    s_add_u32 s54, s3, 2
    s_and_b32 s54, s54, 3
    s_mul_i32 s54, s54, 10240
    s_add_u32 s36, s54, s53
    s_add_u32 s54, s3, 3
    s_and_b32 s54, s54, 3
    s_mul_i32 s54, s54, 10240
    s_add_u32 s37, s54, s53
    s_mul_i32 s54, s3, 10240
    s_add_u32 s52, s52, 163840
    s_add_u32 s38, s52, s54
    s_branch L_hook10_ret
L_idle:
    s_cmp_eq_u32 s7, 0
    s_cbranch_scc1 L_h28a
    s_mov_b32 s18, 0
    s_mov_b32 s22, 0
    s_mov_b32 m0, 163840
    v_mov_b32 v5, 0x3f803f80
    v_cmp_eq_u32 vcc, 2, v2
    s_nop 1
    v_cndmask_b32 v168, 0, v5, vcc
    v_mov_b32 v169, v168
    v_mov_b32 v170, v168
    v_mov_b32 v171, v168
    v_mov_b32 v172, v168
    v_mov_b32 v173, v168
    v_mov_b32 v174, v168
    v_mov_b32 v175, v168
    v_mov_b32 v176, v168
    v_mov_b32 v177, v168
    v_mov_b32 v178, v168
    v_mov_b32 v179, v168
    v_mov_b32 v180, v168
    v_mov_b32 v181, v168
    v_mov_b32 v182, v168
    v_mov_b32 v183, v168
    v_mov_b32 v184, v168
    v_mov_b32 v185, v168
    v_mov_b32 v186, v168
    v_mov_b32 v187, v168
    v_mov_b32 v188, v168
    v_mov_b32 v189, v168
    v_mov_b32 v190, v168
    v_mov_b32 v191, v168
    v_mov_b32 v192, v168
    v_mov_b32 v193, v168
    v_mov_b32 v194, v168
    v_mov_b32 v195, v168
    v_mov_b32 v196, v168
    v_mov_b32 v197, v168
    v_mov_b32 v198, v168
    v_mov_b32 v199, v168
    v_mov_b32 v200, v168
    v_mov_b32 v201, v168
    v_mov_b32 v202, v168
    v_mov_b32 v203, v168
    v_mov_b32 v204, v168
    v_mov_b32 v205, v168
    v_mov_b32 v206, v168
    v_mov_b32 v207, v168
    s_branch L_idle_ret
L_hook28:
    s_lshl_b32 s52, s2, 6
    s_add_u32 s52, s52, s66
    s_add_u32 s52, s52, 0x8000
    v_mov_b32 v5, s6
    v_mov_b32 v6, 0
    s_mov_b64 exec, 1
    buffer_store_dword v5, v6, s[8:11], s52 offen sc1
    s_mov_b64 exec, -1
    s_branch L_hookret28
L_h28a:
    s_mul_i32 s53, s3, 10240
    s_add_u32 m0, s53, 98304
    s_mov_b32 s54, 108
    s_cmp_ge_u32 s2, 128
    s_cbranch_scc1 L_h28d
    s_cmp_lt_u32 s2, s54
    s_cselect_b32 s18, 2211840, 0
    s_mov_b32 s69, 0
    s_mov_b32 s16, s82
    s_mov_b32 s17, s83
    s_mov_b32 s19, 0x20000
    s_mov_b32 s20, s84
    s_mov_b32 s21, s85
    s_mov_b32 s22, s18
    s_mov_b32 s23, 0x20000
    s_mul_i32 s25, s3, 552960
    s_lshl_b32 s53, s2, 5
    s_add_u32 s25, s25, s53
    s_mov_b32 s68, s25
    s_mov_b32 s28, 110592
    v_lshrrev_b32 v12, 1, v1
    v_mul_u32_u24 v12, 3456, v12
    v_and_b32 v6, 1, v1
    v_lshl_add_u32 v12, v6, 4, v12
    s_branch L_idle_ret
L_h28d:
    s_add_u32 s54, s54, 100
    s_cmp_lt_u32 s2, s54
    s_cselect_b32 s18, 2211840, 0
    s_mov_b32 s69, 1073741824
    s_mov_b32 s16, s86
    s_mov_b32 s17, s87
    s_mov_b32 s19, 0x20000
    s_mov_b32 s20, s86
    s_mov_b32 s21, s87
    s_mov_b32 s22, s18
    s_mov_b32 s23, 0x20000
    s_sub_u32 s52, s2, 128
    s_lshl_b32 s52, s52, 4
    s_mul_i32 s25, s3, 573440
    s_add_u32 s25, s25, s52
    s_add_u32 s68, s25, 409600
    s_mov_b32 s28, 81920
    v_mul_u32_u24 v12, 1280, v1
    s_branch L_idle_ret
L_hook47:
    s_mov_b32 s63, 0x80000
L_h46a:
    v_cmp_ne_u32 vcc, 0, v8
    s_sub_u32 s63, s63, 1
    s_cbranch_scc1 L_h46b
    s_nop 2
    s_cbranch_vccz L_h46b
    v_lshlrev_b32 v5, 6, v1
    s_add_u32 s52, s66, 32768
    s_add_u32 s53, s66, 36864
    s_add_u32 s54, s66, 40960
    s_add_u32 s55, s66, 45056
    buffer_load_dword v8, v5, s[8:11], s52 offen sc1
    buffer_load_dword v9, v5, s[8:11], s53 offen sc1
    buffer_load_dword v10, v5, s[8:11], s54 offen sc1
    buffer_load_dword v11, v5, s[8:11], s55 offen sc1
    s_waitcnt vmcnt(0)
    v_xor_b32 v8, s6, v8
    v_xor_b32 v9, s6, v9
    v_xor_b32 v10, s6, v10
    v_xor_b32 v11, s6, v11
    v_or_b32 v8, v8, v9
    v_or3_b32 v8, v8, v10, v11
    s_branch L_h46a
L_h46b:
    s_cmp_lg_u32 s7, 0
    s_cbranch_scc1 L_hookret47
    s_or_b32 s52, s2, s3
    s_cmp_eq_u32 s52, 0
    s_cselect_b32 s52, 0, 1073741824
    v_mov_b32 v5, s6
    v_mov_b32 v6, 0
    s_mov_b64 exec, 1
    buffer_store_dword v5, v6, s[8:11], s52 offen sc1
    s_mov_b64 exec, -1
    s_sub_u32 s52, s34, 819200
    s_sub_u32 s53, s35, 819200
    s_sub_u32 s54, s36, 819200
    s_sub_u32 s55, s37, 819200
    buffer_load_dwordx4 v[208:211], v4, s[8:11], s52 offen offset:0 sc1
    buffer_load_dwordx4 v[212:215], v4, s[8:11], s52 offen offset:1024 sc1
    buffer_load_dwordx4 v[216:219], v4, s[8:11], s52 offen offset:2048 sc1
    buffer_load_dwordx4 v[220:223], v4, s[8:11], s52 offen offset:3072 sc1
    s_branch L_hookret47
L_codeend:
.section .rodata,"a"
.p2align 6
.amdhsa_kernel interleave_layers__grouped_kv_mqa__moe_arch_mod__prompt_kernel
.amdhsa_next_free_vgpr 512
.amdhsa_next_free_sgpr 102
.amdhsa_accum_offset 256
.amdhsa_group_segment_fixed_size 0
.amdhsa_kernarg_size 104
.amdhsa_user_sgpr_count 2
.amdhsa_user_sgpr_kernarg_segment_ptr 1
.amdhsa_system_sgpr_workgroup_id_x 1
.end_amdhsa_kernel
```
